```python
import torch

def _softmax(x, axis=-1):
    return torch.softmax(x, dim=axis)

def _gelu(x):
    return torch.nn.functional.gelu(x, approximate='tanh')

def _silu(x):
    return torch.nn.functional.silu(x)

def _sigmoid(x):
    return torch.sigmoid(x)

def _layernorm(x, axis=-1, eps=1e-05):
    m = x.mean(dim=axis, keepdim=True)
    v = x.var(dim=axis, keepdim=True, unbiased=False)
    return (x - m) / torch.sqrt(v + eps)

def _scatter_add(tgt, idx, src, axis=0):
    return tgt.clone().index_add_(axis, idx, src)

def _segment_sum(src, seg, n):
    out = torch.zeros((n,) + src.shape[1:], dtype=src.dtype)
    return out.index_add_(0, seg, src)

def _pad(x, pw):
    flat = tuple((v for pair in reversed(pw) for v in pair))
    return torch.nn.functional.pad(x, flat)
kernel_name = 'adaLN_cond__memory_aug_recurrent_mem_tr__moe_arch_mod__prompt'

def setup_inputs():

    _w = lambda a: (lambda t: t.to(torch.bfloat16) if t.is_floating_point() else t)(torch.as_tensor(a))

    def _A_setup():
        B, S, Dm = (1, 2048, 512)
        H, Dh = (32, 128)
        M, seg = (8, 32)
        seg = min(seg, S)
        S = S // seg * seg
        return {'x': _w((lambda *s: torch.randn(*s, dtype=torch.bfloat16) * 0.05)(B, S, Dm)), 'mem0': _w((lambda *s: torch.randn(*s, dtype=torch.bfloat16) * 0.4)(B, M, Dm)), 'Wq': _w((lambda *s: torch.randn(*s, dtype=torch.bfloat16) * 3.2)(Dm, H, Dh) * Dm ** (-0.5)), 'Wk': _w((lambda *s: torch.randn(*s, dtype=torch.bfloat16) * 3.2)(Dm, H, Dh) * Dm ** (-0.5)), 'Wv': _w((lambda *s: torch.randn(*s, dtype=torch.bfloat16) * 0.4)(Dm, H, Dh) * Dm ** (-0.5)), 'Wo': _w((lambda *s: torch.randn(*s, dtype=torch.bfloat16) * 0.4)(H, Dh, Dm) * (H * Dh) ** (-0.5)), 'seg_len': seg}
    _A_in = _A_setup()

    def _B_setup():
        B, S, D, F, C = (1, 2048, 512, 1376, 2)
        return {'x': _w((lambda *s: torch.randn(*s, dtype=torch.bfloat16) * 0.05)(B, S, D)), 'w_r': _w((lambda *s: torch.randn(*s, dtype=torch.bfloat16) * 0.05)(D)), 'w_gate': _w((lambda *s: torch.randn(*s, dtype=torch.bfloat16) * 0.05)(D, F)), 'w_up': _w((lambda *s: torch.randn(*s, dtype=torch.bfloat16) * 0.05)(D, F)), 'w_down': _w((lambda *s: torch.randn(*s, dtype=torch.bfloat16) * 0.05)(F, D))}
    _B_in = _B_setup()
    return {'A_x': _A_in['x'], 'A_mem0': _A_in['mem0'], 'A_Wq': _A_in['Wq'], 'A_Wk': _A_in['Wk'], 'A_Wv': _A_in['Wv'], 'A_Wo': _A_in['Wo'], 'A_seg_len': _A_in['seg_len'], 'B_x': _B_in['x'], 'B_w_r': _B_in['w_r'], 'B_w_gate': _B_in['w_gate'], 'B_w_up': _B_in['w_up'], 'B_w_down': _B_in['w_down'], 'c': _w((lambda *s: torch.randn(*s, dtype=torch.bfloat16) * 0.05)(1, 512) * 8.0), 'w_mod': _w((lambda *s: torch.randn(*s, dtype=torch.bfloat16) * 0.05)(512, 6 * 512) * 512 ** (-0.5) * 8.0)}

def reference(A_x, A_mem0, A_Wq, A_Wk, A_Wv, A_Wo, A_seg_len, B_x, B_w_r, B_w_gate, B_w_up, B_w_down, c, w_mod):

    def _A_ref(x, mem0, Wq, Wk, Wv, Wo, seg_len):
        B, S, Dm = x.shape
        H, Dh = (Wq.shape[1], Wq.shape[2])
        M = mem0.shape[1]
        scale = Dh ** (-0.5)
        n_seg = S // seg_len
        L = M + seg_len
        idx = torch.arange(L)
        mask = (idx[:, None] < M) | (idx[:, None] >= idx[None, :])
        mem = mem0
        outs = []
        for s in range(n_seg):
            xs = x[:, s * seg_len:(s + 1) * seg_len, :].clone()
            h = torch.concatenate([mem, xs], axis=1)
            q = torch.einsum('btd,dhe->bhte', h, Wq)
            k = torch.einsum('btd,dhe->bhte', h, Wk)
            v = torch.einsum('btd,dhe->bhte', h, Wv)
            scores = torch.einsum('bhqe,bhke->bhqk', q, k) * scale
            scores = torch.where(mask[None, None], scores, -1000000000.0)
            p = _softmax(scores, axis=-1)
            o = torch.einsum('bhqk,bhke->bhqe', p, v)
            o = torch.einsum('bhte,hed->btd', o, Wo)
            mem = o[:, :M, :].clone()
            outs.append(o[:, M:, :])
        return torch.concatenate(outs, axis=1)

    def _B_ref(x, w_r, w_gate, w_up, w_down):
        B, S, D = x.shape
        C = 2
        r = x @ w_r
        idx = torch.argsort(-r, axis=-1)[:, :C]
        idx_e = (lambda x, n, axis: torch.repeat_interleave(x, n, dim=axis))(idx.reshape(B, C, 1), D, axis=2)
        x_sel = (lambda x, i, axis: torch.take_along_dim(x, i, dim=axis))(x, idx_e, axis=1)
        g = _silu(x_sel @ w_gate)
        u = x_sel @ w_up
        y = g * u @ w_down
        r_sel = _sigmoid((lambda x, i, axis: torch.take_along_dim(x, i, dim=axis))(r, idx, axis=1))
        y = y * r_sel.reshape(B, C, 1)
        b_off = (torch.arange(B) * S).reshape(B, 1)
        flat_idx = (idx + b_off).reshape(B * C)
        zero = (x * 0.0).reshape(B * S, D)
        upd = _scatter_add(zero, flat_idx, y.reshape(B * C, D), axis=0)
        return x + upd.reshape(B, S, D)
    x = A_x
    mod = (_silu(c) @ w_mod).reshape(c.shape[0], 6, 1, -1)
    sa, ca, ga, sb, cb, gb = (mod[:, 0].clone(), mod[:, 1].clone(), mod[:, 2].clone(), mod[:, 3].clone(), mod[:, 4].clone(), mod[:, 5].clone())
    h = _layernorm(x, axis=-1) * (1 + ca) + sa
    x = x + ga * _A_ref(h, A_mem0, A_Wq, A_Wk, A_Wv, A_Wo, A_seg_len)
    h = _layernorm(x, axis=-1) * (1 + cb) + sb
    x = x + gb * _B_ref(h, B_w_r, B_w_gate, B_w_up, B_w_down)
    return x
```

```asm
; @launch grid=(256,1,1) block=(256,1,1) lds=163840
.amdgcn_target "amdgcn-amd-amdhsa--gfx950"
.text
.globl adaLN_cond__memory_aug_recurrent_mem_tr__moe_arch_mod__prompt_kernel
.p2align 8
.type adaLN_cond__memory_aug_recurrent_mem_tr__moe_arch_mod__prompt_kernel,@function
adaLN_cond__memory_aug_recurrent_mem_tr__moe_arch_mod__prompt_kernel:
    s_cmp_ge_u32 s2, 256
    s_cbranch_scc1 L_exit
    s_load_dwordx16 s[4:19], s[0:1], 0
    s_load_dwordx16 s[20:35], s[0:1], 64
    s_load_dwordx2 s[36:37], s[0:1], 128
    s_getreg_b32 s56, hwreg(HW_REG_XCC_ID)
    s_and_b32 s56, s56, 7
    v_mov_b32 v126, v0
    v_and_b32 v125, 63, v0
    v_lshrrev_b32 v1, 6, v0
    s_nop 0
    v_readfirstlane_b32 s49, v1
    s_mov_b32 s60, 0
    s_getpc_b64 s[96:97]
L_pc_0:
    s_mov_b32 s98, L_chain-L_pc_0
    s_mov_b32 s99, L_fast_end-L_pc_0-4
    s_cmp_eq_u32 s56, 0
    s_cselect_b32 s100, s98, 0
    s_cselect_b32 s99, s99, s98
    s_cmp_eq_u32 s49, 0
    s_cbranch_scc1 L_nopf
    v_subrev_u32 v122, 64, v126
    v_lshlrev_b32 v122, 7, v122
    v_add_u32 v122, s100, v122
    v_min_u32 v123, s99, v122
    global_load_dword v127, v123, s[96:97]
    v_add_u32 v122, 0x6000, v122
    v_min_u32 v123, s99, v122
    global_load_dword v127, v123, s[96:97]
    s_nop 0
L_nopf:
    s_waitcnt lgkmcnt(0)
    s_mov_b32 s40, s36
    s_and_b32 s41, s37, 0xffff
    s_mov_b32 s42, 0x10000000
    s_mov_b32 s43, 0x20000
    s_mov_b32 s44, s8
    s_and_b32 s45, s9, 0xffff
    s_mov_b32 s46, 0x400000
    s_mov_b32 s47, 0x20000
    s_mov_b32 s50, 0x05040100
    s_mov_b32 s51, 0x07060302
    s_lshl_b32 s53, s56, 5
    v_mov_b32 v1, 1
    v_mov_b32 v2, s53
    v_mov_b32 v4, 0
    v_cmp_eq_u32 vcc, 0, v126
    s_and_saveexec_b64 s[54:55], vcc
    s_cbranch_execz L_tk1
    global_atomic_add v3, v2, v1, s[34:35] sc0
    s_waitcnt vmcnt(0)
    ds_write_b32 v4, v3
    s_waitcnt lgkmcnt(0)
L_tk1:
    s_mov_b64 exec, s[54:55]
    s_barrier
    ds_read_b32 v3, v4
    s_waitcnt lgkmcnt(0)
    v_readfirstlane_b32 s57, v3
    s_barrier
    s_lshl_b32 s58, s56, 5
    s_add_u32 s58, s58, s57
    s_cmp_lt_u32 s57, 32
    s_cbranch_scc1 L_role_ok
    v_mov_b32 v1, 1
    v_mov_b32 v2, 20
    v_mov_b32 v4, 0
    v_cmp_eq_u32 vcc, 0, v126
    s_and_saveexec_b64 s[54:55], vcc
    s_cbranch_execz L_tk2
    global_atomic_add v3, v2, v1, s[34:35] sc0
    s_waitcnt vmcnt(0)
    ds_write_b32 v4, v3
    s_waitcnt lgkmcnt(0)
L_tk2:
    s_mov_b64 exec, s[54:55]
    s_barrier
    ds_read_b32 v3, v4
    s_waitcnt lgkmcnt(0)
    v_readfirstlane_b32 s57, v3
    s_barrier
    v_min_u32 v5, 7, v125
    v_lshlrev_b32 v6, 5, v5
    s_nop 1
L_census:
    global_load_dword v7, v6, s[34:35] sc1
    s_waitcnt vmcnt(0)
    s_mov_b32 s53, 0
    v_readlane_b32 s68, v7, 0
    s_add_u32 s53, s53, s68
    v_readlane_b32 s69, v7, 1
    s_add_u32 s53, s53, s69
    v_readlane_b32 s70, v7, 2
    s_add_u32 s53, s53, s70
    v_readlane_b32 s71, v7, 3
    s_add_u32 s53, s53, s71
    v_readlane_b32 s72, v7, 4
    s_add_u32 s53, s53, s72
    v_readlane_b32 s73, v7, 5
    s_add_u32 s53, s53, s73
    v_readlane_b32 s74, v7, 6
    s_add_u32 s53, s53, s74
    v_readlane_b32 s75, v7, 7
    s_add_u32 s53, s53, s75
    s_cmp_ge_u32 s53, 256
    s_nop 1
    s_cbranch_scc1 L_census_ok
    s_add_u32 s60, s60, 1
    s_cmp_gt_u32 s60, 0x40000
    s_cbranch_scc1 L_exit
    s_sleep 8
    s_branch L_census
L_census_ok:
    s_mov_b32 s58, 0
    s_min_u32 s53, s68, 32
    s_sub_u32 s54, 32, s53
    s_add_u32 s53, s53, s57
    s_add_u32 s53, s53, 0
    s_cmp_lt_u32 s57, s54
    s_cselect_b32 s58, s53, s58
    s_sub_u32 s54, s57, s54
    s_mov_b32 s57, s54
    s_min_u32 s53, s69, 32
    s_sub_u32 s54, 32, s53
    s_add_u32 s53, s53, s57
    s_add_u32 s53, s53, 32
    s_cmp_lt_u32 s57, s54
    s_cselect_b32 s58, s53, s58
    s_sub_u32 s54, s57, s54
    s_mov_b32 s57, s54
    s_min_u32 s53, s70, 32
    s_sub_u32 s54, 32, s53
    s_add_u32 s53, s53, s57
    s_add_u32 s53, s53, 64
    s_cmp_lt_u32 s57, s54
    s_cselect_b32 s58, s53, s58
    s_sub_u32 s54, s57, s54
    s_mov_b32 s57, s54
    s_min_u32 s53, s71, 32
    s_sub_u32 s54, 32, s53
    s_add_u32 s53, s53, s57
    s_add_u32 s53, s53, 96
    s_cmp_lt_u32 s57, s54
    s_cselect_b32 s58, s53, s58
    s_sub_u32 s54, s57, s54
    s_mov_b32 s57, s54
    s_min_u32 s53, s72, 32
    s_sub_u32 s54, 32, s53
    s_add_u32 s53, s53, s57
    s_add_u32 s53, s53, 128
    s_cmp_lt_u32 s57, s54
    s_cselect_b32 s58, s53, s58
    s_sub_u32 s54, s57, s54
    s_mov_b32 s57, s54
    s_min_u32 s53, s73, 32
    s_sub_u32 s54, 32, s53
    s_add_u32 s53, s53, s57
    s_add_u32 s53, s53, 160
    s_cmp_lt_u32 s57, s54
    s_cselect_b32 s58, s53, s58
    s_sub_u32 s54, s57, s54
    s_mov_b32 s57, s54
    s_min_u32 s53, s74, 32
    s_sub_u32 s54, 32, s53
    s_add_u32 s53, s53, s57
    s_add_u32 s53, s53, 192
    s_cmp_lt_u32 s57, s54
    s_cselect_b32 s58, s53, s58
    s_sub_u32 s54, s57, s54
    s_mov_b32 s57, s54
    s_min_u32 s53, s75, 32
    s_sub_u32 s54, 32, s53
    s_add_u32 s53, s53, s57
    s_add_u32 s53, s53, 224
    s_cmp_lt_u32 s57, s54
    s_cselect_b32 s58, s53, s58
    s_sub_u32 s54, s57, s54
    s_mov_b32 s57, s54
    s_mov_b32 s56, 8
L_role_ok:
    s_and_b32 s58, s58, 255
    s_cmp_lt_u32 s58, 32
    s_cbranch_scc1 L_chain
L_bulk:
    s_sub_u32 s64, s58, 32
    s_mul_i32 s48, s64, 9363
    s_lshr_b32 s48, s48, 16
    s_mul_i32 s53, s48, 7
    s_sub_u32 s65, s64, s53
    s_lshl_b32 s79, s65, 5
    s_add_u32 s79, s79, s48
    s_cmp_lt_u32 s79, 128
    s_cbranch_scc1 L_mskip1
    s_sub_u32 s73, s79, 128
    v_lshlrev_b32 v1, 2, v126
    global_load_dword v2, v1, s[28:29]
    s_mov_b32 s44, s30
    s_and_b32 s45, s31, 0xffff
    s_mov_b32 s46, 0x300000
    s_mov_b32 s47, 0x20000
    v_lshrrev_b32 v3, 4, v126
    s_mov_b32 s68, 196608
    v_mul_lo_u32 v4, s68, v3
    v_and_b32 v5, 15, v126
    v_lshl_add_u32 v4, v5, 2, v4
    s_lshl_b32 s68, s73, 6
    v_add_u32 v4, s68, v4
    s_mov_b32 s68, 0
    buffer_load_dword v32, v4, s[44:47], s68 offen
    s_mov_b32 s68, 6144
    buffer_load_dword v33, v4, s[44:47], s68 offen
    s_mov_b32 s68, 12288
    buffer_load_dword v34, v4, s[44:47], s68 offen
    s_mov_b32 s68, 18432
    buffer_load_dword v35, v4, s[44:47], s68 offen
    s_mov_b32 s68, 24576
    buffer_load_dword v36, v4, s[44:47], s68 offen
    s_mov_b32 s68, 30720
    buffer_load_dword v37, v4, s[44:47], s68 offen
    s_mov_b32 s68, 36864
    buffer_load_dword v38, v4, s[44:47], s68 offen
    s_mov_b32 s68, 43008
    buffer_load_dword v39, v4, s[44:47], s68 offen
    s_mov_b32 s68, 49152
    buffer_load_dword v40, v4, s[44:47], s68 offen
    s_mov_b32 s68, 55296
    buffer_load_dword v41, v4, s[44:47], s68 offen
    s_mov_b32 s68, 61440
    buffer_load_dword v42, v4, s[44:47], s68 offen
    s_mov_b32 s68, 67584
    buffer_load_dword v43, v4, s[44:47], s68 offen
    s_mov_b32 s68, 73728
    buffer_load_dword v44, v4, s[44:47], s68 offen
    s_mov_b32 s68, 79872
    buffer_load_dword v45, v4, s[44:47], s68 offen
    s_mov_b32 s68, 86016
    buffer_load_dword v46, v4, s[44:47], s68 offen
    s_mov_b32 s68, 92160
    buffer_load_dword v47, v4, s[44:47], s68 offen
    s_mov_b32 s68, 98304
    buffer_load_dword v48, v4, s[44:47], s68 offen
    s_mov_b32 s68, 104448
    buffer_load_dword v49, v4, s[44:47], s68 offen
    s_mov_b32 s68, 110592
    buffer_load_dword v50, v4, s[44:47], s68 offen
    s_mov_b32 s68, 116736
    buffer_load_dword v51, v4, s[44:47], s68 offen
    s_mov_b32 s68, 122880
    buffer_load_dword v52, v4, s[44:47], s68 offen
    s_mov_b32 s68, 129024
    buffer_load_dword v53, v4, s[44:47], s68 offen
    s_mov_b32 s68, 135168
    buffer_load_dword v54, v4, s[44:47], s68 offen
    s_mov_b32 s68, 141312
    buffer_load_dword v55, v4, s[44:47], s68 offen
    s_mov_b32 s68, 147456
    buffer_load_dword v56, v4, s[44:47], s68 offen
    s_mov_b32 s68, 153600
    buffer_load_dword v57, v4, s[44:47], s68 offen
    s_mov_b32 s68, 159744
    buffer_load_dword v58, v4, s[44:47], s68 offen
    s_mov_b32 s68, 165888
    buffer_load_dword v59, v4, s[44:47], s68 offen
    s_mov_b32 s68, 172032
    buffer_load_dword v60, v4, s[44:47], s68 offen
    s_mov_b32 s68, 178176
    buffer_load_dword v61, v4, s[44:47], s68 offen
    s_mov_b32 s68, 184320
    buffer_load_dword v62, v4, s[44:47], s68 offen
    s_mov_b32 s68, 190464
    buffer_load_dword v63, v4, s[44:47], s68 offen
    s_mov_b32 s69, 0xbfb8aa3b
    s_waitcnt vmcnt(32)
    v_and_b32 v7, 0xffff0000, v2
    v_lshlrev_b32 v6, 16, v2
    v_mul_f32 v8, s69, v6
    v_exp_f32 v8, v8
    s_nop 0
    v_add_f32 v8, 1.0, v8
    v_rcp_f32 v8, v8
    s_nop 0
    v_mul_f32 v6, v6, v8
    v_mul_f32 v8, s69, v7
    v_exp_f32 v8, v8
    s_nop 0
    v_add_f32 v8, 1.0, v8
    v_rcp_f32 v8, v8
    s_nop 0
    v_mul_f32 v7, v7, v8
    v_cvt_pk_bf16_f32 v8, v6, v7
    v_lshlrev_b32 v6, 16, v8
    v_and_b32 v7, 0xffff0000, v8
    v_lshlrev_b32 v9, 3, v126
    ds_write_b64 v9, v[6:7]
    s_waitcnt lgkmcnt(0)
    s_barrier
    v_lshlrev_b32 v9, 7, v3
    ds_read_b128 v[64:67], v9 offset:0
    ds_read_b128 v[68:71], v9 offset:16
    ds_read_b128 v[72:75], v9 offset:32
    ds_read_b128 v[76:79], v9 offset:48
    ds_read_b128 v[80:83], v9 offset:64
    ds_read_b128 v[84:87], v9 offset:80
    ds_read_b128 v[88:91], v9 offset:96
    ds_read_b128 v[92:95], v9 offset:112
    v_mov_b32 v10, 0
    v_mov_b32 v11, 0
    s_waitcnt vmcnt(31)
    v_and_b32 v13, 0xffff0000, v32
    v_lshlrev_b32 v12, 16, v32
    s_waitcnt lgkmcnt(7)
    v_fmac_f32 v10, v64, v12
    v_fmac_f32 v11, v64, v13
    s_waitcnt vmcnt(30)
    v_and_b32 v13, 0xffff0000, v33
    v_lshlrev_b32 v12, 16, v33
    v_fmac_f32 v10, v65, v12
    v_fmac_f32 v11, v65, v13
    s_waitcnt vmcnt(29)
    v_and_b32 v13, 0xffff0000, v34
    v_lshlrev_b32 v12, 16, v34
    v_fmac_f32 v10, v66, v12
    v_fmac_f32 v11, v66, v13
    s_waitcnt vmcnt(28)
    v_and_b32 v13, 0xffff0000, v35
    v_lshlrev_b32 v12, 16, v35
    v_fmac_f32 v10, v67, v12
    v_fmac_f32 v11, v67, v13
    s_waitcnt vmcnt(27)
    v_and_b32 v13, 0xffff0000, v36
    v_lshlrev_b32 v12, 16, v36
    s_waitcnt lgkmcnt(6)
    v_fmac_f32 v10, v68, v12
    v_fmac_f32 v11, v68, v13
    s_waitcnt vmcnt(26)
    v_and_b32 v13, 0xffff0000, v37
    v_lshlrev_b32 v12, 16, v37
    v_fmac_f32 v10, v69, v12
    v_fmac_f32 v11, v69, v13
    s_waitcnt vmcnt(25)
    v_and_b32 v13, 0xffff0000, v38
    v_lshlrev_b32 v12, 16, v38
    v_fmac_f32 v10, v70, v12
    v_fmac_f32 v11, v70, v13
    s_waitcnt vmcnt(24)
    v_and_b32 v13, 0xffff0000, v39
    v_lshlrev_b32 v12, 16, v39
    v_fmac_f32 v10, v71, v12
    v_fmac_f32 v11, v71, v13
    s_waitcnt vmcnt(23)
    v_and_b32 v13, 0xffff0000, v40
    v_lshlrev_b32 v12, 16, v40
    s_waitcnt lgkmcnt(5)
    v_fmac_f32 v10, v72, v12
    v_fmac_f32 v11, v72, v13
    s_waitcnt vmcnt(22)
    v_and_b32 v13, 0xffff0000, v41
    v_lshlrev_b32 v12, 16, v41
    v_fmac_f32 v10, v73, v12
    v_fmac_f32 v11, v73, v13
    s_waitcnt vmcnt(21)
    v_and_b32 v13, 0xffff0000, v42
    v_lshlrev_b32 v12, 16, v42
    v_fmac_f32 v10, v74, v12
    v_fmac_f32 v11, v74, v13
    s_waitcnt vmcnt(20)
    v_and_b32 v13, 0xffff0000, v43
    v_lshlrev_b32 v12, 16, v43
    v_fmac_f32 v10, v75, v12
    v_fmac_f32 v11, v75, v13
    s_waitcnt vmcnt(19)
    v_and_b32 v13, 0xffff0000, v44
    v_lshlrev_b32 v12, 16, v44
    s_waitcnt lgkmcnt(4)
    v_fmac_f32 v10, v76, v12
    v_fmac_f32 v11, v76, v13
    s_waitcnt vmcnt(18)
    v_and_b32 v13, 0xffff0000, v45
    v_lshlrev_b32 v12, 16, v45
    v_fmac_f32 v10, v77, v12
    v_fmac_f32 v11, v77, v13
    s_waitcnt vmcnt(17)
    v_and_b32 v13, 0xffff0000, v46
    v_lshlrev_b32 v12, 16, v46
    v_fmac_f32 v10, v78, v12
    v_fmac_f32 v11, v78, v13
    s_waitcnt vmcnt(16)
    v_and_b32 v13, 0xffff0000, v47
    v_lshlrev_b32 v12, 16, v47
    v_fmac_f32 v10, v79, v12
    v_fmac_f32 v11, v79, v13
    s_waitcnt vmcnt(15)
    v_and_b32 v13, 0xffff0000, v48
    v_lshlrev_b32 v12, 16, v48
    s_waitcnt lgkmcnt(3)
    v_fmac_f32 v10, v80, v12
    v_fmac_f32 v11, v80, v13
    s_waitcnt vmcnt(14)
    v_and_b32 v13, 0xffff0000, v49
    v_lshlrev_b32 v12, 16, v49
    v_fmac_f32 v10, v81, v12
    v_fmac_f32 v11, v81, v13
    s_waitcnt vmcnt(13)
    v_and_b32 v13, 0xffff0000, v50
    v_lshlrev_b32 v12, 16, v50
    v_fmac_f32 v10, v82, v12
    v_fmac_f32 v11, v82, v13
    s_waitcnt vmcnt(12)
    v_and_b32 v13, 0xffff0000, v51
    v_lshlrev_b32 v12, 16, v51
    v_fmac_f32 v10, v83, v12
    v_fmac_f32 v11, v83, v13
    s_waitcnt vmcnt(11)
    v_and_b32 v13, 0xffff0000, v52
    v_lshlrev_b32 v12, 16, v52
    s_waitcnt lgkmcnt(2)
    v_fmac_f32 v10, v84, v12
    v_fmac_f32 v11, v84, v13
    s_waitcnt vmcnt(10)
    v_and_b32 v13, 0xffff0000, v53
    v_lshlrev_b32 v12, 16, v53
    v_fmac_f32 v10, v85, v12
    v_fmac_f32 v11, v85, v13
    s_waitcnt vmcnt(9)
    v_and_b32 v13, 0xffff0000, v54
    v_lshlrev_b32 v12, 16, v54
    v_fmac_f32 v10, v86, v12
    v_fmac_f32 v11, v86, v13
    s_waitcnt vmcnt(8)
    v_and_b32 v13, 0xffff0000, v55
    v_lshlrev_b32 v12, 16, v55
    v_fmac_f32 v10, v87, v12
    v_fmac_f32 v11, v87, v13
    s_waitcnt vmcnt(7)
    v_and_b32 v13, 0xffff0000, v56
    v_lshlrev_b32 v12, 16, v56
    s_waitcnt lgkmcnt(1)
    v_fmac_f32 v10, v88, v12
    v_fmac_f32 v11, v88, v13
    s_waitcnt vmcnt(6)
    v_and_b32 v13, 0xffff0000, v57
    v_lshlrev_b32 v12, 16, v57
    v_fmac_f32 v10, v89, v12
    v_fmac_f32 v11, v89, v13
    s_waitcnt vmcnt(5)
    v_and_b32 v13, 0xffff0000, v58
    v_lshlrev_b32 v12, 16, v58
    v_fmac_f32 v10, v90, v12
    v_fmac_f32 v11, v90, v13
    s_waitcnt vmcnt(4)
    v_and_b32 v13, 0xffff0000, v59
    v_lshlrev_b32 v12, 16, v59
    v_fmac_f32 v10, v91, v12
    v_fmac_f32 v11, v91, v13
    s_waitcnt vmcnt(3)
    v_and_b32 v13, 0xffff0000, v60
    v_lshlrev_b32 v12, 16, v60
    s_waitcnt lgkmcnt(0)
    v_fmac_f32 v10, v92, v12
    v_fmac_f32 v11, v92, v13
    s_waitcnt vmcnt(2)
    v_and_b32 v13, 0xffff0000, v61
    v_lshlrev_b32 v12, 16, v61
    v_fmac_f32 v10, v93, v12
    v_fmac_f32 v11, v93, v13
    s_waitcnt vmcnt(1)
    v_and_b32 v13, 0xffff0000, v62
    v_lshlrev_b32 v12, 16, v62
    v_fmac_f32 v10, v94, v12
    v_fmac_f32 v11, v94, v13
    s_waitcnt vmcnt(0)
    v_and_b32 v13, 0xffff0000, v63
    v_lshlrev_b32 v12, 16, v63
    v_fmac_f32 v10, v95, v12
    v_fmac_f32 v11, v95, v13
    v_lshl_add_u32 v9, v5, 3, v9
    ds_write_b64 v9, v[10:11] offset:4096
    s_waitcnt lgkmcnt(0)
    s_barrier
    v_and_b32 v9, 31, v126
    v_lshlrev_b32 v9, 2, v9
    ds_read_b32 v64, v9 offset:4096
    ds_read_b32 v65, v9 offset:4224
    ds_read_b32 v66, v9 offset:4352
    ds_read_b32 v67, v9 offset:4480
    ds_read_b32 v68, v9 offset:4608
    ds_read_b32 v69, v9 offset:4736
    ds_read_b32 v70, v9 offset:4864
    ds_read_b32 v71, v9 offset:4992
    ds_read_b32 v72, v9 offset:5120
    ds_read_b32 v73, v9 offset:5248
    ds_read_b32 v74, v9 offset:5376
    ds_read_b32 v75, v9 offset:5504
    ds_read_b32 v76, v9 offset:5632
    ds_read_b32 v77, v9 offset:5760
    ds_read_b32 v78, v9 offset:5888
    ds_read_b32 v79, v9 offset:6016
    s_waitcnt lgkmcnt(14)
    v_add_f32 v64, v64, v65
    s_waitcnt lgkmcnt(13)
    v_add_f32 v64, v64, v66
    s_waitcnt lgkmcnt(12)
    v_add_f32 v64, v64, v67
    s_waitcnt lgkmcnt(11)
    v_add_f32 v64, v64, v68
    s_waitcnt lgkmcnt(10)
    v_add_f32 v64, v64, v69
    s_waitcnt lgkmcnt(9)
    v_add_f32 v64, v64, v70
    s_waitcnt lgkmcnt(8)
    v_add_f32 v64, v64, v71
    s_waitcnt lgkmcnt(7)
    v_add_f32 v64, v64, v72
    s_waitcnt lgkmcnt(6)
    v_add_f32 v64, v64, v73
    s_waitcnt lgkmcnt(5)
    v_add_f32 v64, v64, v74
    s_waitcnt lgkmcnt(4)
    v_add_f32 v64, v64, v75
    s_waitcnt lgkmcnt(3)
    v_add_f32 v64, v64, v76
    s_waitcnt lgkmcnt(2)
    v_add_f32 v64, v64, v77
    s_waitcnt lgkmcnt(1)
    v_add_f32 v64, v64, v78
    s_waitcnt lgkmcnt(0)
    v_add_f32 v64, v64, v79
    v_cvt_pk_bf16_f32 v8, v64, v64
    v_lshlrev_b32 v64, 16, v8
    s_cmp_lg_u32 s49, 0
    s_cbranch_scc1 L_mdone2
    s_lshl_b32 s68, s73, 7
    s_add_u32 s68, s68, 0x220000
    v_mov_b32 v14, 16
    s_nop 1
L_fi3:
    global_load_dword v15, v14, s[34:35] sc1
    s_waitcnt vmcnt(0)
    v_readfirstlane_b32 s54, v15
    s_and_b32 s53, s54, 0xffff
    s_cmp_ge_u32 s53, 32
    s_nop 1
    s_cbranch_scc1 L_fd4
    s_add_u32 s60, s60, 1
    s_cmp_gt_u32 s60, 0x40000
    s_cbranch_scc1 L_exit
    s_sleep 2
    s_branch L_fi3
L_fd4:
    v_min_u32 v64, 0xfffffffe, v64
    s_mov_b32 exec_hi, 0
    buffer_store_dword v64, v9, s[40:43], s68 offen sc1
    s_mov_b64 exec, -1
L_mdone2:
    s_barrier
L_mskip1:
    s_cmp_lt_u32 s79, 128
    s_cbranch_scc1 L_lndone5
    s_sub_u32 s78, s79, 128
    s_mov_b32 s44, s4
    s_and_b32 s45, s5, 0xffff
    s_mov_b32 s46, 0x200000
    s_mov_b32 s47, 0x20000
    v_lshlrev_b32 v72, 4, v125
    s_lshl_b32 s69, s78, 2
    s_add_u32 s69, s69, s49
    s_lshl_b32 s69, s69, 12
    buffer_load_dwordx4 v[0:3], v72, s[44:47], s69 offen offset:0
    buffer_load_dwordx4 v[4:7], v72, s[44:47], s69 offen offset:1024
    buffer_load_dwordx4 v[8:11], v72, s[44:47], s69 offen offset:2048
    buffer_load_dwordx4 v[12:15], v72, s[44:47], s69 offen offset:3072
    s_waitcnt vmcnt(3)
    v_and_b32 v129, 0xffff0000, v0
    v_lshlrev_b32 v128, 16, v0
    v_and_b32 v131, 0xffff0000, v1
    v_lshlrev_b32 v130, 16, v1
    v_and_b32 v133, 0xffff0000, v2
    v_lshlrev_b32 v132, 16, v2
    v_and_b32 v135, 0xffff0000, v3
    v_lshlrev_b32 v134, 16, v3
    v_add_f32 v56, v128, v129
    v_add_f32 v56, v56, v130
    v_add_f32 v56, v56, v131
    v_add_f32 v56, v56, v132
    v_add_f32 v56, v56, v133
    v_add_f32 v56, v56, v134
    v_add_f32 v56, v56, v135
    s_nop 1
    v_add_f32_dpp v56, v56, v56 row_ror:8 row_mask:0xf bank_mask:0xf
    s_nop 1
    v_add_f32_dpp v56, v56, v56 row_ror:4 row_mask:0xf bank_mask:0xf
    s_nop 1
    v_add_f32_dpp v56, v56, v56 row_ror:2 row_mask:0xf bank_mask:0xf
    s_nop 1
    v_add_f32_dpp v56, v56, v56 row_ror:1 row_mask:0xf bank_mask:0xf
    v_mov_b32 v57, v56
    s_nop 1
    v_permlane16_swap_b32 v56, v57
    v_add_f32 v56, v56, v57
    v_mov_b32 v57, v56
    s_nop 1
    v_permlane32_swap_b32 v56, v57
    v_add_f32 v56, v56, v57
    v_mul_f32 v56, 0x3b000000, v56
    v_sub_f32 v58, v128, v56
    v_mul_f32 v59, v58, v58
    v_sub_f32 v58, v129, v56
    v_fmac_f32 v59, v58, v58
    v_sub_f32 v58, v130, v56
    v_fmac_f32 v59, v58, v58
    v_sub_f32 v58, v131, v56
    v_fmac_f32 v59, v58, v58
    v_sub_f32 v58, v132, v56
    v_fmac_f32 v59, v58, v58
    v_sub_f32 v58, v133, v56
    v_fmac_f32 v59, v58, v58
    v_sub_f32 v58, v134, v56
    v_fmac_f32 v59, v58, v58
    v_sub_f32 v58, v135, v56
    v_fmac_f32 v59, v58, v58
    s_nop 1
    v_add_f32_dpp v59, v59, v59 row_ror:8 row_mask:0xf bank_mask:0xf
    s_nop 1
    v_add_f32_dpp v59, v59, v59 row_ror:4 row_mask:0xf bank_mask:0xf
    s_nop 1
    v_add_f32_dpp v59, v59, v59 row_ror:2 row_mask:0xf bank_mask:0xf
    s_nop 1
    v_add_f32_dpp v59, v59, v59 row_ror:1 row_mask:0xf bank_mask:0xf
    v_mov_b32 v57, v59
    s_nop 1
    v_permlane16_swap_b32 v59, v57
    v_add_f32 v59, v59, v57
    v_mov_b32 v57, v59
    s_nop 1
    v_permlane32_swap_b32 v59, v57
    v_add_f32 v59, v59, v57
    v_mul_f32 v59, 0x3b000000, v59
    v_cvt_pk_bf16_f32 v57, v56, v59
    v_lshlrev_b32 v56, 16, v57
    v_and_b32 v59, 0xffff0000, v57
    v_add_f32 v59, 0x3727c5ac, v59
    v_cvt_pk_bf16_f32 v57, v59, v59
    v_lshlrev_b32 v59, 16, v57
    v_sqrt_f32 v59, v59
    s_nop 0
    v_cvt_pk_bf16_f32 v57, v59, v59
    v_lshlrev_b32 v59, 16, v57
    v_rcp_f32 v59, v59
    v_sub_f32 v128, v128, v56
    v_sub_f32 v129, v129, v56
    v_sub_f32 v130, v130, v56
    v_sub_f32 v131, v131, v56
    v_sub_f32 v132, v132, v56
    v_sub_f32 v133, v133, v56
    v_sub_f32 v134, v134, v56
    v_sub_f32 v135, v135, v56
    v_cvt_pk_bf16_f32 v57, v128, v129
    v_lshlrev_b32 v128, 16, v57
    v_and_b32 v129, 0xffff0000, v57
    v_cvt_pk_bf16_f32 v57, v130, v131
    v_lshlrev_b32 v130, 16, v57
    v_and_b32 v131, 0xffff0000, v57
    v_cvt_pk_bf16_f32 v57, v132, v133
    v_lshlrev_b32 v132, 16, v57
    v_and_b32 v133, 0xffff0000, v57
    v_cvt_pk_bf16_f32 v57, v134, v135
    v_lshlrev_b32 v134, 16, v57
    v_and_b32 v135, 0xffff0000, v57
    v_mul_f32 v128, v128, v59
    v_mul_f32 v129, v129, v59
    v_mul_f32 v130, v130, v59
    v_mul_f32 v131, v131, v59
    v_mul_f32 v132, v132, v59
    v_mul_f32 v133, v133, v59
    v_mul_f32 v134, v134, v59
    v_mul_f32 v135, v135, v59
    v_cvt_pk_bf16_f32 v57, v128, v129
    v_lshlrev_b32 v128, 16, v57
    v_and_b32 v129, 0xffff0000, v57
    v_cvt_pk_bf16_f32 v57, v130, v131
    v_lshlrev_b32 v130, 16, v57
    v_and_b32 v131, 0xffff0000, v57
    v_cvt_pk_bf16_f32 v57, v132, v133
    v_lshlrev_b32 v132, 16, v57
    v_and_b32 v133, 0xffff0000, v57
    v_cvt_pk_bf16_f32 v57, v134, v135
    v_lshlrev_b32 v134, 16, v57
    v_and_b32 v135, 0xffff0000, v57
    s_waitcnt vmcnt(2)
    v_and_b32 v137, 0xffff0000, v4
    v_lshlrev_b32 v136, 16, v4
    v_and_b32 v139, 0xffff0000, v5
    v_lshlrev_b32 v138, 16, v5
    v_and_b32 v141, 0xffff0000, v6
    v_lshlrev_b32 v140, 16, v6
    v_and_b32 v143, 0xffff0000, v7
    v_lshlrev_b32 v142, 16, v7
    v_add_f32 v56, v136, v137
    v_add_f32 v56, v56, v138
    v_add_f32 v56, v56, v139
    v_add_f32 v56, v56, v140
    v_add_f32 v56, v56, v141
    v_add_f32 v56, v56, v142
    v_add_f32 v56, v56, v143
    s_nop 1
    v_add_f32_dpp v56, v56, v56 row_ror:8 row_mask:0xf bank_mask:0xf
    s_nop 1
    v_add_f32_dpp v56, v56, v56 row_ror:4 row_mask:0xf bank_mask:0xf
    s_nop 1
    v_add_f32_dpp v56, v56, v56 row_ror:2 row_mask:0xf bank_mask:0xf
    s_nop 1
    v_add_f32_dpp v56, v56, v56 row_ror:1 row_mask:0xf bank_mask:0xf
    v_mov_b32 v57, v56
    s_nop 1
    v_permlane16_swap_b32 v56, v57
    v_add_f32 v56, v56, v57
    v_mov_b32 v57, v56
    s_nop 1
    v_permlane32_swap_b32 v56, v57
    v_add_f32 v56, v56, v57
    v_mul_f32 v56, 0x3b000000, v56
    v_sub_f32 v58, v136, v56
    v_mul_f32 v59, v58, v58
    v_sub_f32 v58, v137, v56
    v_fmac_f32 v59, v58, v58
    v_sub_f32 v58, v138, v56
    v_fmac_f32 v59, v58, v58
    v_sub_f32 v58, v139, v56
    v_fmac_f32 v59, v58, v58
    v_sub_f32 v58, v140, v56
    v_fmac_f32 v59, v58, v58
    v_sub_f32 v58, v141, v56
    v_fmac_f32 v59, v58, v58
    v_sub_f32 v58, v142, v56
    v_fmac_f32 v59, v58, v58
    v_sub_f32 v58, v143, v56
    v_fmac_f32 v59, v58, v58
    s_nop 1
    v_add_f32_dpp v59, v59, v59 row_ror:8 row_mask:0xf bank_mask:0xf
    s_nop 1
    v_add_f32_dpp v59, v59, v59 row_ror:4 row_mask:0xf bank_mask:0xf
    s_nop 1
    v_add_f32_dpp v59, v59, v59 row_ror:2 row_mask:0xf bank_mask:0xf
    s_nop 1
    v_add_f32_dpp v59, v59, v59 row_ror:1 row_mask:0xf bank_mask:0xf
    v_mov_b32 v57, v59
    s_nop 1
    v_permlane16_swap_b32 v59, v57
    v_add_f32 v59, v59, v57
    v_mov_b32 v57, v59
    s_nop 1
    v_permlane32_swap_b32 v59, v57
    v_add_f32 v59, v59, v57
    v_mul_f32 v59, 0x3b000000, v59
    v_cvt_pk_bf16_f32 v57, v56, v59
    v_lshlrev_b32 v56, 16, v57
    v_and_b32 v59, 0xffff0000, v57
    v_add_f32 v59, 0x3727c5ac, v59
    v_cvt_pk_bf16_f32 v57, v59, v59
    v_lshlrev_b32 v59, 16, v57
    v_sqrt_f32 v59, v59
    s_nop 0
    v_cvt_pk_bf16_f32 v57, v59, v59
    v_lshlrev_b32 v59, 16, v57
    v_rcp_f32 v59, v59
    v_sub_f32 v136, v136, v56
    v_sub_f32 v137, v137, v56
    v_sub_f32 v138, v138, v56
    v_sub_f32 v139, v139, v56
    v_sub_f32 v140, v140, v56
    v_sub_f32 v141, v141, v56
    v_sub_f32 v142, v142, v56
    v_sub_f32 v143, v143, v56
    v_cvt_pk_bf16_f32 v57, v136, v137
    v_lshlrev_b32 v136, 16, v57
    v_and_b32 v137, 0xffff0000, v57
    v_cvt_pk_bf16_f32 v57, v138, v139
    v_lshlrev_b32 v138, 16, v57
    v_and_b32 v139, 0xffff0000, v57
    v_cvt_pk_bf16_f32 v57, v140, v141
    v_lshlrev_b32 v140, 16, v57
    v_and_b32 v141, 0xffff0000, v57
    v_cvt_pk_bf16_f32 v57, v142, v143
    v_lshlrev_b32 v142, 16, v57
    v_and_b32 v143, 0xffff0000, v57
    v_mul_f32 v136, v136, v59
    v_mul_f32 v137, v137, v59
    v_mul_f32 v138, v138, v59
    v_mul_f32 v139, v139, v59
    v_mul_f32 v140, v140, v59
    v_mul_f32 v141, v141, v59
    v_mul_f32 v142, v142, v59
    v_mul_f32 v143, v143, v59
    v_cvt_pk_bf16_f32 v57, v136, v137
    v_lshlrev_b32 v136, 16, v57
    v_and_b32 v137, 0xffff0000, v57
    v_cvt_pk_bf16_f32 v57, v138, v139
    v_lshlrev_b32 v138, 16, v57
    v_and_b32 v139, 0xffff0000, v57
    v_cvt_pk_bf16_f32 v57, v140, v141
    v_lshlrev_b32 v140, 16, v57
    v_and_b32 v141, 0xffff0000, v57
    v_cvt_pk_bf16_f32 v57, v142, v143
    v_lshlrev_b32 v142, 16, v57
    v_and_b32 v143, 0xffff0000, v57
    s_waitcnt vmcnt(1)
    v_and_b32 v145, 0xffff0000, v8
    v_lshlrev_b32 v144, 16, v8
    v_and_b32 v147, 0xffff0000, v9
    v_lshlrev_b32 v146, 16, v9
    v_and_b32 v149, 0xffff0000, v10
    v_lshlrev_b32 v148, 16, v10
    v_and_b32 v151, 0xffff0000, v11
    v_lshlrev_b32 v150, 16, v11
    v_add_f32 v56, v144, v145
    v_add_f32 v56, v56, v146
    v_add_f32 v56, v56, v147
    v_add_f32 v56, v56, v148
    v_add_f32 v56, v56, v149
    v_add_f32 v56, v56, v150
    v_add_f32 v56, v56, v151
    s_nop 1
    v_add_f32_dpp v56, v56, v56 row_ror:8 row_mask:0xf bank_mask:0xf
    s_nop 1
    v_add_f32_dpp v56, v56, v56 row_ror:4 row_mask:0xf bank_mask:0xf
    s_nop 1
    v_add_f32_dpp v56, v56, v56 row_ror:2 row_mask:0xf bank_mask:0xf
    s_nop 1
    v_add_f32_dpp v56, v56, v56 row_ror:1 row_mask:0xf bank_mask:0xf
    v_mov_b32 v57, v56
    s_nop 1
    v_permlane16_swap_b32 v56, v57
    v_add_f32 v56, v56, v57
    v_mov_b32 v57, v56
    s_nop 1
    v_permlane32_swap_b32 v56, v57
    v_add_f32 v56, v56, v57
    v_mul_f32 v56, 0x3b000000, v56
    v_sub_f32 v58, v144, v56
    v_mul_f32 v59, v58, v58
    v_sub_f32 v58, v145, v56
    v_fmac_f32 v59, v58, v58
    v_sub_f32 v58, v146, v56
    v_fmac_f32 v59, v58, v58
    v_sub_f32 v58, v147, v56
    v_fmac_f32 v59, v58, v58
    v_sub_f32 v58, v148, v56
    v_fmac_f32 v59, v58, v58
    v_sub_f32 v58, v149, v56
    v_fmac_f32 v59, v58, v58
    v_sub_f32 v58, v150, v56
    v_fmac_f32 v59, v58, v58
    v_sub_f32 v58, v151, v56
    v_fmac_f32 v59, v58, v58
    s_nop 1
    v_add_f32_dpp v59, v59, v59 row_ror:8 row_mask:0xf bank_mask:0xf
    s_nop 1
    v_add_f32_dpp v59, v59, v59 row_ror:4 row_mask:0xf bank_mask:0xf
    s_nop 1
    v_add_f32_dpp v59, v59, v59 row_ror:2 row_mask:0xf bank_mask:0xf
    s_nop 1
    v_add_f32_dpp v59, v59, v59 row_ror:1 row_mask:0xf bank_mask:0xf
    v_mov_b32 v57, v59
    s_nop 1
    v_permlane16_swap_b32 v59, v57
    v_add_f32 v59, v59, v57
    v_mov_b32 v57, v59
    s_nop 1
    v_permlane32_swap_b32 v59, v57
    v_add_f32 v59, v59, v57
    v_mul_f32 v59, 0x3b000000, v59
    v_cvt_pk_bf16_f32 v57, v56, v59
    v_lshlrev_b32 v56, 16, v57
    v_and_b32 v59, 0xffff0000, v57
    v_add_f32 v59, 0x3727c5ac, v59
    v_cvt_pk_bf16_f32 v57, v59, v59
    v_lshlrev_b32 v59, 16, v57
    v_sqrt_f32 v59, v59
    s_nop 0
    v_cvt_pk_bf16_f32 v57, v59, v59
    v_lshlrev_b32 v59, 16, v57
    v_rcp_f32 v59, v59
    v_sub_f32 v144, v144, v56
    v_sub_f32 v145, v145, v56
    v_sub_f32 v146, v146, v56
    v_sub_f32 v147, v147, v56
    v_sub_f32 v148, v148, v56
    v_sub_f32 v149, v149, v56
    v_sub_f32 v150, v150, v56
    v_sub_f32 v151, v151, v56
    v_cvt_pk_bf16_f32 v57, v144, v145
    v_lshlrev_b32 v144, 16, v57
    v_and_b32 v145, 0xffff0000, v57
    v_cvt_pk_bf16_f32 v57, v146, v147
    v_lshlrev_b32 v146, 16, v57
    v_and_b32 v147, 0xffff0000, v57
    v_cvt_pk_bf16_f32 v57, v148, v149
    v_lshlrev_b32 v148, 16, v57
    v_and_b32 v149, 0xffff0000, v57
    v_cvt_pk_bf16_f32 v57, v150, v151
    v_lshlrev_b32 v150, 16, v57
    v_and_b32 v151, 0xffff0000, v57
    v_mul_f32 v144, v144, v59
    v_mul_f32 v145, v145, v59
    v_mul_f32 v146, v146, v59
    v_mul_f32 v147, v147, v59
    v_mul_f32 v148, v148, v59
    v_mul_f32 v149, v149, v59
    v_mul_f32 v150, v150, v59
    v_mul_f32 v151, v151, v59
    v_cvt_pk_bf16_f32 v57, v144, v145
    v_lshlrev_b32 v144, 16, v57
    v_and_b32 v145, 0xffff0000, v57
    v_cvt_pk_bf16_f32 v57, v146, v147
    v_lshlrev_b32 v146, 16, v57
    v_and_b32 v147, 0xffff0000, v57
    v_cvt_pk_bf16_f32 v57, v148, v149
    v_lshlrev_b32 v148, 16, v57
    v_and_b32 v149, 0xffff0000, v57
    v_cvt_pk_bf16_f32 v57, v150, v151
    v_lshlrev_b32 v150, 16, v57
    v_and_b32 v151, 0xffff0000, v57
    s_waitcnt vmcnt(0)
    v_and_b32 v153, 0xffff0000, v12
    v_lshlrev_b32 v152, 16, v12
    v_and_b32 v155, 0xffff0000, v13
    v_lshlrev_b32 v154, 16, v13
    v_and_b32 v157, 0xffff0000, v14
    v_lshlrev_b32 v156, 16, v14
    v_and_b32 v159, 0xffff0000, v15
    v_lshlrev_b32 v158, 16, v15
    v_add_f32 v56, v152, v153
    v_add_f32 v56, v56, v154
    v_add_f32 v56, v56, v155
    v_add_f32 v56, v56, v156
    v_add_f32 v56, v56, v157
    v_add_f32 v56, v56, v158
    v_add_f32 v56, v56, v159
    s_nop 1
    v_add_f32_dpp v56, v56, v56 row_ror:8 row_mask:0xf bank_mask:0xf
    s_nop 1
    v_add_f32_dpp v56, v56, v56 row_ror:4 row_mask:0xf bank_mask:0xf
    s_nop 1
    v_add_f32_dpp v56, v56, v56 row_ror:2 row_mask:0xf bank_mask:0xf
    s_nop 1
    v_add_f32_dpp v56, v56, v56 row_ror:1 row_mask:0xf bank_mask:0xf
    v_mov_b32 v57, v56
    s_nop 1
    v_permlane16_swap_b32 v56, v57
    v_add_f32 v56, v56, v57
    v_mov_b32 v57, v56
    s_nop 1
    v_permlane32_swap_b32 v56, v57
    v_add_f32 v56, v56, v57
    v_mul_f32 v56, 0x3b000000, v56
    v_sub_f32 v58, v152, v56
    v_mul_f32 v59, v58, v58
    v_sub_f32 v58, v153, v56
    v_fmac_f32 v59, v58, v58
    v_sub_f32 v58, v154, v56
    v_fmac_f32 v59, v58, v58
    v_sub_f32 v58, v155, v56
    v_fmac_f32 v59, v58, v58
    v_sub_f32 v58, v156, v56
    v_fmac_f32 v59, v58, v58
    v_sub_f32 v58, v157, v56
    v_fmac_f32 v59, v58, v58
    v_sub_f32 v58, v158, v56
    v_fmac_f32 v59, v58, v58
    v_sub_f32 v58, v159, v56
    v_fmac_f32 v59, v58, v58
    s_nop 1
    v_add_f32_dpp v59, v59, v59 row_ror:8 row_mask:0xf bank_mask:0xf
    s_nop 1
    v_add_f32_dpp v59, v59, v59 row_ror:4 row_mask:0xf bank_mask:0xf
    s_nop 1
    v_add_f32_dpp v59, v59, v59 row_ror:2 row_mask:0xf bank_mask:0xf
    s_nop 1
    v_add_f32_dpp v59, v59, v59 row_ror:1 row_mask:0xf bank_mask:0xf
    v_mov_b32 v57, v59
    s_nop 1
    v_permlane16_swap_b32 v59, v57
    v_add_f32 v59, v59, v57
    v_mov_b32 v57, v59
    s_nop 1
    v_permlane32_swap_b32 v59, v57
    v_add_f32 v59, v59, v57
    v_mul_f32 v59, 0x3b000000, v59
    v_cvt_pk_bf16_f32 v57, v56, v59
    v_lshlrev_b32 v56, 16, v57
    v_and_b32 v59, 0xffff0000, v57
    v_add_f32 v59, 0x3727c5ac, v59
    v_cvt_pk_bf16_f32 v57, v59, v59
    v_lshlrev_b32 v59, 16, v57
    v_sqrt_f32 v59, v59
    s_nop 0
    v_cvt_pk_bf16_f32 v57, v59, v59
    v_lshlrev_b32 v59, 16, v57
    v_rcp_f32 v59, v59
    v_sub_f32 v152, v152, v56
    v_sub_f32 v153, v153, v56
    v_sub_f32 v154, v154, v56
    v_sub_f32 v155, v155, v56
    v_sub_f32 v156, v156, v56
    v_sub_f32 v157, v157, v56
    v_sub_f32 v158, v158, v56
    v_sub_f32 v159, v159, v56
    v_cvt_pk_bf16_f32 v57, v152, v153
    v_lshlrev_b32 v152, 16, v57
    v_and_b32 v153, 0xffff0000, v57
    v_cvt_pk_bf16_f32 v57, v154, v155
    v_lshlrev_b32 v154, 16, v57
    v_and_b32 v155, 0xffff0000, v57
    v_cvt_pk_bf16_f32 v57, v156, v157
    v_lshlrev_b32 v156, 16, v57
    v_and_b32 v157, 0xffff0000, v57
    v_cvt_pk_bf16_f32 v57, v158, v159
    v_lshlrev_b32 v158, 16, v57
    v_and_b32 v159, 0xffff0000, v57
    v_mul_f32 v152, v152, v59
    v_mul_f32 v153, v153, v59
    v_mul_f32 v154, v154, v59
    v_mul_f32 v155, v155, v59
    v_mul_f32 v156, v156, v59
    v_mul_f32 v157, v157, v59
    v_mul_f32 v158, v158, v59
    v_mul_f32 v159, v159, v59
    v_cvt_pk_bf16_f32 v57, v152, v153
    v_lshlrev_b32 v152, 16, v57
    v_and_b32 v153, 0xffff0000, v57
    v_cvt_pk_bf16_f32 v57, v154, v155
    v_lshlrev_b32 v154, 16, v57
    v_and_b32 v155, 0xffff0000, v57
    v_cvt_pk_bf16_f32 v57, v156, v157
    v_lshlrev_b32 v156, 16, v57
    v_and_b32 v157, 0xffff0000, v57
    v_cvt_pk_bf16_f32 v57, v158, v159
    v_lshlrev_b32 v158, 16, v57
    v_and_b32 v159, 0xffff0000, v57
    s_nop 1
L_lna6:
    v_mov_b32 v56, 16
    s_nop 1
L_fi8:
    global_load_dword v57, v56, s[34:35] sc1
    s_waitcnt vmcnt(0)
    v_readfirstlane_b32 s54, v57
    s_and_b32 s53, s54, 0xffff
    s_cmp_ge_u32 s53, 32
    s_nop 1
    s_cbranch_scc1 L_fd9
    s_add_u32 s60, s60, 1
    s_cmp_gt_u32 s60, 0x40000
    s_cbranch_scc1 L_exit
    s_sleep 2
    s_branch L_fi8
L_fd9:
    v_lshlrev_b32 v58, 5, v125
    s_nop 1
L_lm10:
    s_mov_b32 s69, 0x220000
    buffer_load_dwordx4 v[16:19], v58, s[40:43], s69 offen sc1
    buffer_load_dwordx4 v[20:23], v58, s[40:43], s69 offen offset:16 sc1
    s_mov_b32 s69, 0x220800
    buffer_load_dwordx4 v[24:27], v58, s[40:43], s69 offen sc1
    buffer_load_dwordx4 v[28:31], v58, s[40:43], s69 offen offset:16 sc1
    s_waitcnt vmcnt(0)
    v_max_u32 v56, v16, v17
    v_max3_u32 v56, v56, v18, v19
    v_max3_u32 v56, v56, v20, v21
    v_max3_u32 v56, v56, v22, v23
    v_max3_u32 v56, v56, v24, v25
    v_max3_u32 v56, v56, v26, v27
    v_max3_u32 v56, v56, v28, v29
    v_max3_u32 v56, v56, v30, v31
    v_cmp_eq_u32 vcc, -1, v56
    s_nop 0
    s_cbranch_vccz L_lmd11
    s_add_u32 s60, s60, 1
    s_cmp_gt_u32 s60, 0x40000
    s_cbranch_scc1 L_exit
    s_sleep 4
    s_branch L_lm10
L_lmd11:
    v_add_f32 v24, 1.0, v24
    v_add_f32 v25, 1.0, v25
    v_add_f32 v26, 1.0, v26
    v_add_f32 v27, 1.0, v27
    v_add_f32 v28, 1.0, v28
    v_add_f32 v29, 1.0, v29
    v_add_f32 v30, 1.0, v30
    v_add_f32 v31, 1.0, v31
    v_cvt_pk_bf16_f32 v57, v24, v25
    v_lshlrev_b32 v24, 16, v57
    v_and_b32 v25, 0xffff0000, v57
    v_cvt_pk_bf16_f32 v57, v26, v27
    v_lshlrev_b32 v26, 16, v57
    v_and_b32 v27, 0xffff0000, v57
    v_cvt_pk_bf16_f32 v57, v28, v29
    v_lshlrev_b32 v28, 16, v57
    v_and_b32 v29, 0xffff0000, v57
    v_cvt_pk_bf16_f32 v57, v30, v31
    v_lshlrev_b32 v30, 16, v57
    v_and_b32 v31, 0xffff0000, v57
    v_lshlrev_b32 v76, 8, v125
    s_lshl_b32 s69, s49, 6
    v_add_u32 v76, s69, v76
    v_mul_f32 v128, v128, v24
    v_mul_f32 v129, v129, v25
    v_mul_f32 v130, v130, v26
    v_mul_f32 v131, v131, v27
    v_mul_f32 v132, v132, v28
    v_mul_f32 v133, v133, v29
    v_mul_f32 v134, v134, v30
    v_mul_f32 v135, v135, v31
    v_cvt_pk_bf16_f32 v56, v128, v129
    v_lshlrev_b32 v128, 16, v56
    v_and_b32 v129, 0xffff0000, v56
    v_cvt_pk_bf16_f32 v56, v130, v131
    v_lshlrev_b32 v130, 16, v56
    v_and_b32 v131, 0xffff0000, v56
    v_cvt_pk_bf16_f32 v56, v132, v133
    v_lshlrev_b32 v132, 16, v56
    v_and_b32 v133, 0xffff0000, v56
    v_cvt_pk_bf16_f32 v56, v134, v135
    v_lshlrev_b32 v134, 16, v56
    v_and_b32 v135, 0xffff0000, v56
    v_add_f32 v128, v128, v16
    v_add_f32 v129, v129, v17
    v_add_f32 v130, v130, v18
    v_add_f32 v131, v131, v19
    v_add_f32 v132, v132, v20
    v_add_f32 v133, v133, v21
    v_add_f32 v134, v134, v22
    v_add_f32 v135, v135, v23
    v_cvt_pk_bf16_f32 v60, v128, v129
    v_cvt_pk_bf16_f32 v61, v130, v131
    v_cvt_pk_bf16_f32 v62, v132, v133
    v_cvt_pk_bf16_f32 v63, v134, v135
    ds_write_b128 v76, v[60:63] offset:0
    v_mul_f32 v136, v136, v24
    v_mul_f32 v137, v137, v25
    v_mul_f32 v138, v138, v26
    v_mul_f32 v139, v139, v27
    v_mul_f32 v140, v140, v28
    v_mul_f32 v141, v141, v29
    v_mul_f32 v142, v142, v30
    v_mul_f32 v143, v143, v31
    v_cvt_pk_bf16_f32 v56, v136, v137
    v_lshlrev_b32 v136, 16, v56
    v_and_b32 v137, 0xffff0000, v56
    v_cvt_pk_bf16_f32 v56, v138, v139
    v_lshlrev_b32 v138, 16, v56
    v_and_b32 v139, 0xffff0000, v56
    v_cvt_pk_bf16_f32 v56, v140, v141
    v_lshlrev_b32 v140, 16, v56
    v_and_b32 v141, 0xffff0000, v56
    v_cvt_pk_bf16_f32 v56, v142, v143
    v_lshlrev_b32 v142, 16, v56
    v_and_b32 v143, 0xffff0000, v56
    v_add_f32 v136, v136, v16
    v_add_f32 v137, v137, v17
    v_add_f32 v138, v138, v18
    v_add_f32 v139, v139, v19
    v_add_f32 v140, v140, v20
    v_add_f32 v141, v141, v21
    v_add_f32 v142, v142, v22
    v_add_f32 v143, v143, v23
    v_cvt_pk_bf16_f32 v64, v136, v137
    v_cvt_pk_bf16_f32 v65, v138, v139
    v_cvt_pk_bf16_f32 v66, v140, v141
    v_cvt_pk_bf16_f32 v67, v142, v143
    ds_write_b128 v76, v[64:67] offset:16
    v_mul_f32 v144, v144, v24
    v_mul_f32 v145, v145, v25
    v_mul_f32 v146, v146, v26
    v_mul_f32 v147, v147, v27
    v_mul_f32 v148, v148, v28
    v_mul_f32 v149, v149, v29
    v_mul_f32 v150, v150, v30
    v_mul_f32 v151, v151, v31
    v_cvt_pk_bf16_f32 v56, v144, v145
    v_lshlrev_b32 v144, 16, v56
    v_and_b32 v145, 0xffff0000, v56
    v_cvt_pk_bf16_f32 v56, v146, v147
    v_lshlrev_b32 v146, 16, v56
    v_and_b32 v147, 0xffff0000, v56
    v_cvt_pk_bf16_f32 v56, v148, v149
    v_lshlrev_b32 v148, 16, v56
    v_and_b32 v149, 0xffff0000, v56
    v_cvt_pk_bf16_f32 v56, v150, v151
    v_lshlrev_b32 v150, 16, v56
    v_and_b32 v151, 0xffff0000, v56
    v_add_f32 v144, v144, v16
    v_add_f32 v145, v145, v17
    v_add_f32 v146, v146, v18
    v_add_f32 v147, v147, v19
    v_add_f32 v148, v148, v20
    v_add_f32 v149, v149, v21
    v_add_f32 v150, v150, v22
    v_add_f32 v151, v151, v23
    v_cvt_pk_bf16_f32 v68, v144, v145
    v_cvt_pk_bf16_f32 v69, v146, v147
    v_cvt_pk_bf16_f32 v70, v148, v149
    v_cvt_pk_bf16_f32 v71, v150, v151
    ds_write_b128 v76, v[68:71] offset:32
    v_mul_f32 v152, v152, v24
    v_mul_f32 v153, v153, v25
    v_mul_f32 v154, v154, v26
    v_mul_f32 v155, v155, v27
    v_mul_f32 v156, v156, v28
    v_mul_f32 v157, v157, v29
    v_mul_f32 v158, v158, v30
    v_mul_f32 v159, v159, v31
    v_cvt_pk_bf16_f32 v56, v152, v153
    v_lshlrev_b32 v152, 16, v56
    v_and_b32 v153, 0xffff0000, v56
    v_cvt_pk_bf16_f32 v56, v154, v155
    v_lshlrev_b32 v154, 16, v56
    v_and_b32 v155, 0xffff0000, v56
    v_cvt_pk_bf16_f32 v56, v156, v157
    v_lshlrev_b32 v156, 16, v56
    v_and_b32 v157, 0xffff0000, v56
    v_cvt_pk_bf16_f32 v56, v158, v159
    v_lshlrev_b32 v158, 16, v56
    v_and_b32 v159, 0xffff0000, v56
    v_add_f32 v152, v152, v16
    v_add_f32 v153, v153, v17
    v_add_f32 v154, v154, v18
    v_add_f32 v155, v155, v19
    v_add_f32 v156, v156, v20
    v_add_f32 v157, v157, v21
    v_add_f32 v158, v158, v22
    v_add_f32 v159, v159, v23
    v_cvt_pk_bf16_f32 v72, v152, v153
    v_cvt_pk_bf16_f32 v73, v154, v155
    v_cvt_pk_bf16_f32 v74, v156, v157
    v_cvt_pk_bf16_f32 v75, v158, v159
    ds_write_b128 v76, v[72:75] offset:48
    s_waitcnt lgkmcnt(0)
    s_barrier
    v_lshlrev_b32 v72, 4, v125
    s_lshl_b32 s69, s49, 12
    v_add_u32 v77, s69, v72
    ds_read_b128 v[0:3], v77 offset:0
    ds_read_b128 v[4:7], v77 offset:1024
    ds_read_b128 v[8:11], v77 offset:2048
    ds_read_b128 v[12:15], v77 offset:3072
    s_lshl_b32 s69, s78, 14
    s_add_u32 s69, s69, 0x400000
    s_waitcnt lgkmcnt(3)
    buffer_store_dwordx4 v[0:3], v77, s[40:43], s69 offen offset:0 sc1
    s_waitcnt lgkmcnt(2)
    buffer_store_dwordx4 v[4:7], v77, s[40:43], s69 offen offset:1024 sc1
    s_waitcnt lgkmcnt(1)
    buffer_store_dwordx4 v[8:11], v77, s[40:43], s69 offen offset:2048 sc1
    s_waitcnt lgkmcnt(0)
    buffer_store_dwordx4 v[12:15], v77, s[40:43], s69 offen offset:3072 sc1
    s_waitcnt vmcnt(0)
    s_barrier
    s_cmp_lg_u32 s49, 0
    s_cbranch_scc1 L_lnb7
    s_lshr_b32 s69, s78, 1
    s_lshl_b32 s69, s69, 6
    s_add_u32 s69, s69, 0x200000
    v_mov_b32 v56, 0
    v_mov_b32 v57, 1
    s_mov_b64 exec, 1
    buffer_atomic_add v57, v56, s[40:43], s69 offen
    s_mov_b64 exec, -1
L_lnb7:
L_lndone5:
    v_lshrrev_b32 v101, 4, v125
    v_lshlrev_b32 v100, 13, v101
    v_lshlrev_b32 v102, 11, v101
    v_and_b32 v101, 15, v125
    v_lshl_add_u32 v100, v101, 4, v100
    v_lshl_add_u32 v102, v101, 2, v102
    s_lshl_b32 s53, s48, 8
    s_lshl_b32 s54, s49, 17
    s_add_u32 s53, s53, s54
    v_add_u32 v100, s53, v100
    s_lshl_b32 s53, s49, 6
    v_add_u32 v102, s53, v102
    s_lshl_b32 s55, s49, 12
    s_waitcnt vmcnt(0) lgkmcnt(0)
    s_barrier
    s_mov_b32 s44, s10
    s_and_b32 s45, s11, 0xffff
    s_mov_b32 s46, 0x400000
    s_mov_b32 s47, 0x20000
    s_add_u32 m0, s55, 0
    s_mov_b32 s54, 0x0
    buffer_load_dwordx4 v100, s[44:47], s54 offen lds
    s_add_u32 m0, s55, 1024
    s_mov_b32 s54, 0x8000
    buffer_load_dwordx4 v100, s[44:47], s54 offen lds
    s_add_u32 m0, s55, 2048
    s_mov_b32 s54, 0x10000
    buffer_load_dwordx4 v100, s[44:47], s54 offen lds
    s_add_u32 m0, s55, 3072
    s_mov_b32 s54, 0x18000
    buffer_load_dwordx4 v100, s[44:47], s54 offen lds
    s_add_u32 m0, s55, 16384
    s_mov_b32 s54, 0x80000
    buffer_load_dwordx4 v100, s[44:47], s54 offen lds
    s_add_u32 m0, s55, 17408
    s_mov_b32 s54, 0x88000
    buffer_load_dwordx4 v100, s[44:47], s54 offen lds
    s_add_u32 m0, s55, 18432
    s_mov_b32 s54, 0x90000
    buffer_load_dwordx4 v100, s[44:47], s54 offen lds
    s_add_u32 m0, s55, 19456
    s_mov_b32 s54, 0x98000
    buffer_load_dwordx4 v100, s[44:47], s54 offen lds
    s_add_u32 m0, s55, 32768
    s_mov_b32 s54, 0x100000
    buffer_load_dwordx4 v100, s[44:47], s54 offen lds
    s_add_u32 m0, s55, 33792
    s_mov_b32 s54, 0x108000
    buffer_load_dwordx4 v100, s[44:47], s54 offen lds
    s_add_u32 m0, s55, 34816
    s_mov_b32 s54, 0x110000
    buffer_load_dwordx4 v100, s[44:47], s54 offen lds
    s_add_u32 m0, s55, 35840
    s_mov_b32 s54, 0x118000
    buffer_load_dwordx4 v100, s[44:47], s54 offen lds
    s_add_u32 m0, s55, 49152
    s_mov_b32 s54, 0x180000
    buffer_load_dwordx4 v100, s[44:47], s54 offen lds
    s_add_u32 m0, s55, 50176
    s_mov_b32 s54, 0x188000
    buffer_load_dwordx4 v100, s[44:47], s54 offen lds
    s_add_u32 m0, s55, 51200
    s_mov_b32 s54, 0x190000
    buffer_load_dwordx4 v100, s[44:47], s54 offen lds
    s_add_u32 m0, s55, 52224
    s_mov_b32 s54, 0x198000
    buffer_load_dwordx4 v100, s[44:47], s54 offen lds
    s_add_u32 m0, s55, 65536
    s_mov_b32 s54, 0x200000
    buffer_load_dwordx4 v100, s[44:47], s54 offen lds
    s_add_u32 m0, s55, 66560
    s_mov_b32 s54, 0x208000
    buffer_load_dwordx4 v100, s[44:47], s54 offen lds
    s_add_u32 m0, s55, 67584
    s_mov_b32 s54, 0x210000
    buffer_load_dwordx4 v100, s[44:47], s54 offen lds
    s_add_u32 m0, s55, 68608
    s_mov_b32 s54, 0x218000
    buffer_load_dwordx4 v100, s[44:47], s54 offen lds
    s_add_u32 m0, s55, 81920
    s_mov_b32 s54, 0x280000
    buffer_load_dwordx4 v100, s[44:47], s54 offen lds
    s_add_u32 m0, s55, 82944
    s_mov_b32 s54, 0x288000
    buffer_load_dwordx4 v100, s[44:47], s54 offen lds
    s_add_u32 m0, s55, 83968
    s_mov_b32 s54, 0x290000
    buffer_load_dwordx4 v100, s[44:47], s54 offen lds
    s_add_u32 m0, s55, 84992
    s_mov_b32 s54, 0x298000
    buffer_load_dwordx4 v100, s[44:47], s54 offen lds
    s_add_u32 m0, s55, 98304
    s_mov_b32 s54, 0x300000
    buffer_load_dwordx4 v100, s[44:47], s54 offen lds
    s_add_u32 m0, s55, 99328
    s_mov_b32 s54, 0x308000
    buffer_load_dwordx4 v100, s[44:47], s54 offen lds
    s_add_u32 m0, s55, 100352
    s_mov_b32 s54, 0x310000
    buffer_load_dwordx4 v100, s[44:47], s54 offen lds
    s_add_u32 m0, s55, 101376
    s_mov_b32 s54, 0x318000
    buffer_load_dwordx4 v100, s[44:47], s54 offen lds
    s_add_u32 m0, s55, 114688
    s_mov_b32 s54, 0x380000
    buffer_load_dwordx4 v100, s[44:47], s54 offen lds
    s_add_u32 m0, s55, 115712
    s_mov_b32 s54, 0x388000
    buffer_load_dwordx4 v100, s[44:47], s54 offen lds
    s_add_u32 m0, s55, 116736
    s_mov_b32 s54, 0x390000
    buffer_load_dwordx4 v100, s[44:47], s54 offen lds
    s_add_u32 m0, s55, 117760
    s_mov_b32 s54, 0x398000
    buffer_load_dwordx4 v100, s[44:47], s54 offen lds
    s_waitcnt vmcnt(28) lgkmcnt(0)
    s_barrier
    s_mov_b32 s44, s12
    s_and_b32 s45, s13, 0xffff
    s_mov_b32 s46, 0x400000
    s_mov_b32 s47, 0x20000
    s_add_u32 m0, s55, 131072
    s_mov_b32 s54, 0x0
    buffer_load_dwordx4 v100, s[44:47], s54 offen lds
    s_add_u32 m0, s55, 132096
    s_mov_b32 s54, 0x8000
    buffer_load_dwordx4 v100, s[44:47], s54 offen lds
    s_add_u32 m0, s55, 133120
    s_mov_b32 s54, 0x10000
    buffer_load_dwordx4 v100, s[44:47], s54 offen lds
    s_add_u32 m0, s55, 134144
    s_mov_b32 s54, 0x18000
    buffer_load_dwordx4 v100, s[44:47], s54 offen lds
    v_add_u32 v101, 0, v102
    ds_read2st64_b32 v[0:1], v101 offset0:0 offset1:1
    ds_read2st64_b32 v[2:3], v101 offset0:2 offset1:3
    ds_read2st64_b32 v[4:5], v101 offset0:4 offset1:5
    ds_read2st64_b32 v[6:7], v101 offset0:6 offset1:7
    ds_read2st64_b32 v[8:9], v101 offset0:32 offset1:33
    ds_read2st64_b32 v[10:11], v101 offset0:34 offset1:35
    ds_read2st64_b32 v[12:13], v101 offset0:36 offset1:37
    ds_read2st64_b32 v[14:15], v101 offset0:38 offset1:39
    s_waitcnt lgkmcnt(7)
    v_perm_b32 v64, v1, v0, s50
    s_waitcnt lgkmcnt(6)
    v_perm_b32 v65, v3, v2, s50
    s_waitcnt lgkmcnt(5)
    v_perm_b32 v66, v5, v4, s50
    s_waitcnt lgkmcnt(4)
    v_perm_b32 v67, v7, v6, s50
    s_waitcnt lgkmcnt(3)
    v_perm_b32 v68, v9, v8, s50
    s_waitcnt lgkmcnt(2)
    v_perm_b32 v69, v11, v10, s50
    s_waitcnt lgkmcnt(1)
    v_perm_b32 v70, v13, v12, s50
    s_waitcnt lgkmcnt(0)
    v_perm_b32 v71, v15, v14, s50
    v_accvgpr_write_b32 a0, v64
    v_accvgpr_write_b32 a1, v65
    v_accvgpr_write_b32 a2, v66
    v_accvgpr_write_b32 a3, v67
    v_accvgpr_write_b32 a4, v68
    v_accvgpr_write_b32 a5, v69
    v_accvgpr_write_b32 a6, v70
    v_accvgpr_write_b32 a7, v71
    v_perm_b32 v72, v1, v0, s51
    v_perm_b32 v73, v3, v2, s51
    v_perm_b32 v74, v5, v4, s51
    v_perm_b32 v75, v7, v6, s51
    v_perm_b32 v76, v9, v8, s51
    v_perm_b32 v77, v11, v10, s51
    v_perm_b32 v78, v13, v12, s51
    v_perm_b32 v79, v15, v14, s51
    v_accvgpr_write_b32 a8, v72
    v_accvgpr_write_b32 a9, v73
    v_accvgpr_write_b32 a10, v74
    v_accvgpr_write_b32 a11, v75
    v_accvgpr_write_b32 a12, v76
    v_accvgpr_write_b32 a13, v77
    v_accvgpr_write_b32 a14, v78
    v_accvgpr_write_b32 a15, v79
    s_waitcnt vmcnt(28) lgkmcnt(0)
    s_barrier
    s_add_u32 m0, s55, 0
    s_mov_b32 s54, 0x80000
    buffer_load_dwordx4 v100, s[44:47], s54 offen lds
    s_add_u32 m0, s55, 1024
    s_mov_b32 s54, 0x88000
    buffer_load_dwordx4 v100, s[44:47], s54 offen lds
    s_add_u32 m0, s55, 2048
    s_mov_b32 s54, 0x90000
    buffer_load_dwordx4 v100, s[44:47], s54 offen lds
    s_add_u32 m0, s55, 3072
    s_mov_b32 s54, 0x98000
    buffer_load_dwordx4 v100, s[44:47], s54 offen lds
    v_add_u32 v101, 16384, v102
    ds_read2st64_b32 v[0:1], v101 offset0:0 offset1:1
    ds_read2st64_b32 v[2:3], v101 offset0:2 offset1:3
    ds_read2st64_b32 v[4:5], v101 offset0:4 offset1:5
    ds_read2st64_b32 v[6:7], v101 offset0:6 offset1:7
    ds_read2st64_b32 v[8:9], v101 offset0:32 offset1:33
    ds_read2st64_b32 v[10:11], v101 offset0:34 offset1:35
    ds_read2st64_b32 v[12:13], v101 offset0:36 offset1:37
    ds_read2st64_b32 v[14:15], v101 offset0:38 offset1:39
    s_waitcnt lgkmcnt(7)
    v_perm_b32 v64, v1, v0, s50
    s_waitcnt lgkmcnt(6)
    v_perm_b32 v65, v3, v2, s50
    s_waitcnt lgkmcnt(5)
    v_perm_b32 v66, v5, v4, s50
    s_waitcnt lgkmcnt(4)
    v_perm_b32 v67, v7, v6, s50
    s_waitcnt lgkmcnt(3)
    v_perm_b32 v68, v9, v8, s50
    s_waitcnt lgkmcnt(2)
    v_perm_b32 v69, v11, v10, s50
    s_waitcnt lgkmcnt(1)
    v_perm_b32 v70, v13, v12, s50
    s_waitcnt lgkmcnt(0)
    v_perm_b32 v71, v15, v14, s50
    v_accvgpr_write_b32 a16, v64
    v_accvgpr_write_b32 a17, v65
    v_accvgpr_write_b32 a18, v66
    v_accvgpr_write_b32 a19, v67
    v_accvgpr_write_b32 a20, v68
    v_accvgpr_write_b32 a21, v69
    v_accvgpr_write_b32 a22, v70
    v_accvgpr_write_b32 a23, v71
    v_perm_b32 v72, v1, v0, s51
    v_perm_b32 v73, v3, v2, s51
    v_perm_b32 v74, v5, v4, s51
    v_perm_b32 v75, v7, v6, s51
    v_perm_b32 v76, v9, v8, s51
    v_perm_b32 v77, v11, v10, s51
    v_perm_b32 v78, v13, v12, s51
    v_perm_b32 v79, v15, v14, s51
    v_accvgpr_write_b32 a24, v72
    v_accvgpr_write_b32 a25, v73
    v_accvgpr_write_b32 a26, v74
    v_accvgpr_write_b32 a27, v75
    v_accvgpr_write_b32 a28, v76
    v_accvgpr_write_b32 a29, v77
    v_accvgpr_write_b32 a30, v78
    v_accvgpr_write_b32 a31, v79
    s_waitcnt vmcnt(28) lgkmcnt(0)
    s_barrier
    s_add_u32 m0, s55, 16384
    s_mov_b32 s54, 0x100000
    buffer_load_dwordx4 v100, s[44:47], s54 offen lds
    s_add_u32 m0, s55, 17408
    s_mov_b32 s54, 0x108000
    buffer_load_dwordx4 v100, s[44:47], s54 offen lds
    s_add_u32 m0, s55, 18432
    s_mov_b32 s54, 0x110000
    buffer_load_dwordx4 v100, s[44:47], s54 offen lds
    s_add_u32 m0, s55, 19456
    s_mov_b32 s54, 0x118000
    buffer_load_dwordx4 v100, s[44:47], s54 offen lds
    v_add_u32 v101, 32768, v102
    ds_read2st64_b32 v[0:1], v101 offset0:0 offset1:1
    ds_read2st64_b32 v[2:3], v101 offset0:2 offset1:3
    ds_read2st64_b32 v[4:5], v101 offset0:4 offset1:5
    ds_read2st64_b32 v[6:7], v101 offset0:6 offset1:7
    ds_read2st64_b32 v[8:9], v101 offset0:32 offset1:33
    ds_read2st64_b32 v[10:11], v101 offset0:34 offset1:35
    ds_read2st64_b32 v[12:13], v101 offset0:36 offset1:37
    ds_read2st64_b32 v[14:15], v101 offset0:38 offset1:39
    s_waitcnt lgkmcnt(7)
    v_perm_b32 v64, v1, v0, s50
    s_waitcnt lgkmcnt(6)
    v_perm_b32 v65, v3, v2, s50
    s_waitcnt lgkmcnt(5)
    v_perm_b32 v66, v5, v4, s50
    s_waitcnt lgkmcnt(4)
    v_perm_b32 v67, v7, v6, s50
    s_waitcnt lgkmcnt(3)
    v_perm_b32 v68, v9, v8, s50
    s_waitcnt lgkmcnt(2)
    v_perm_b32 v69, v11, v10, s50
    s_waitcnt lgkmcnt(1)
    v_perm_b32 v70, v13, v12, s50
    s_waitcnt lgkmcnt(0)
    v_perm_b32 v71, v15, v14, s50
    v_accvgpr_write_b32 a32, v64
    v_accvgpr_write_b32 a33, v65
    v_accvgpr_write_b32 a34, v66
    v_accvgpr_write_b32 a35, v67
    v_accvgpr_write_b32 a36, v68
    v_accvgpr_write_b32 a37, v69
    v_accvgpr_write_b32 a38, v70
    v_accvgpr_write_b32 a39, v71
    v_perm_b32 v72, v1, v0, s51
    v_perm_b32 v73, v3, v2, s51
    v_perm_b32 v74, v5, v4, s51
    v_perm_b32 v75, v7, v6, s51
    v_perm_b32 v76, v9, v8, s51
    v_perm_b32 v77, v11, v10, s51
    v_perm_b32 v78, v13, v12, s51
    v_perm_b32 v79, v15, v14, s51
    v_accvgpr_write_b32 a40, v72
    v_accvgpr_write_b32 a41, v73
    v_accvgpr_write_b32 a42, v74
    v_accvgpr_write_b32 a43, v75
    v_accvgpr_write_b32 a44, v76
    v_accvgpr_write_b32 a45, v77
    v_accvgpr_write_b32 a46, v78
    v_accvgpr_write_b32 a47, v79
    s_waitcnt vmcnt(28) lgkmcnt(0)
    s_barrier
    s_add_u32 m0, s55, 32768
    s_mov_b32 s54, 0x180000
    buffer_load_dwordx4 v100, s[44:47], s54 offen lds
    s_add_u32 m0, s55, 33792
    s_mov_b32 s54, 0x188000
    buffer_load_dwordx4 v100, s[44:47], s54 offen lds
    s_add_u32 m0, s55, 34816
    s_mov_b32 s54, 0x190000
    buffer_load_dwordx4 v100, s[44:47], s54 offen lds
    s_add_u32 m0, s55, 35840
    s_mov_b32 s54, 0x198000
    buffer_load_dwordx4 v100, s[44:47], s54 offen lds
    v_add_u32 v101, 49152, v102
    ds_read2st64_b32 v[0:1], v101 offset0:0 offset1:1
    ds_read2st64_b32 v[2:3], v101 offset0:2 offset1:3
    ds_read2st64_b32 v[4:5], v101 offset0:4 offset1:5
    ds_read2st64_b32 v[6:7], v101 offset0:6 offset1:7
    ds_read2st64_b32 v[8:9], v101 offset0:32 offset1:33
    ds_read2st64_b32 v[10:11], v101 offset0:34 offset1:35
    ds_read2st64_b32 v[12:13], v101 offset0:36 offset1:37
    ds_read2st64_b32 v[14:15], v101 offset0:38 offset1:39
    s_waitcnt lgkmcnt(7)
    v_perm_b32 v64, v1, v0, s50
    s_waitcnt lgkmcnt(6)
    v_perm_b32 v65, v3, v2, s50
    s_waitcnt lgkmcnt(5)
    v_perm_b32 v66, v5, v4, s50
    s_waitcnt lgkmcnt(4)
    v_perm_b32 v67, v7, v6, s50
    s_waitcnt lgkmcnt(3)
    v_perm_b32 v68, v9, v8, s50
    s_waitcnt lgkmcnt(2)
    v_perm_b32 v69, v11, v10, s50
    s_waitcnt lgkmcnt(1)
    v_perm_b32 v70, v13, v12, s50
    s_waitcnt lgkmcnt(0)
    v_perm_b32 v71, v15, v14, s50
    v_accvgpr_write_b32 a48, v64
    v_accvgpr_write_b32 a49, v65
    v_accvgpr_write_b32 a50, v66
    v_accvgpr_write_b32 a51, v67
    v_accvgpr_write_b32 a52, v68
    v_accvgpr_write_b32 a53, v69
    v_accvgpr_write_b32 a54, v70
    v_accvgpr_write_b32 a55, v71
    v_perm_b32 v72, v1, v0, s51
    v_perm_b32 v73, v3, v2, s51
    v_perm_b32 v74, v5, v4, s51
    v_perm_b32 v75, v7, v6, s51
    v_perm_b32 v76, v9, v8, s51
    v_perm_b32 v77, v11, v10, s51
    v_perm_b32 v78, v13, v12, s51
    v_perm_b32 v79, v15, v14, s51
    v_accvgpr_write_b32 a56, v72
    v_accvgpr_write_b32 a57, v73
    v_accvgpr_write_b32 a58, v74
    v_accvgpr_write_b32 a59, v75
    v_accvgpr_write_b32 a60, v76
    v_accvgpr_write_b32 a61, v77
    v_accvgpr_write_b32 a62, v78
    v_accvgpr_write_b32 a63, v79
    s_waitcnt vmcnt(28) lgkmcnt(0)
    s_barrier
    s_add_u32 m0, s55, 49152
    s_mov_b32 s54, 0x200000
    buffer_load_dwordx4 v100, s[44:47], s54 offen lds
    s_add_u32 m0, s55, 50176
    s_mov_b32 s54, 0x208000
    buffer_load_dwordx4 v100, s[44:47], s54 offen lds
    s_add_u32 m0, s55, 51200
    s_mov_b32 s54, 0x210000
    buffer_load_dwordx4 v100, s[44:47], s54 offen lds
    s_add_u32 m0, s55, 52224
    s_mov_b32 s54, 0x218000
    buffer_load_dwordx4 v100, s[44:47], s54 offen lds
    v_add_u32 v101, 65536, v102
    ds_read2st64_b32 v[0:1], v101 offset0:0 offset1:1
    ds_read2st64_b32 v[2:3], v101 offset0:2 offset1:3
    ds_read2st64_b32 v[4:5], v101 offset0:4 offset1:5
    ds_read2st64_b32 v[6:7], v101 offset0:6 offset1:7
    ds_read2st64_b32 v[8:9], v101 offset0:32 offset1:33
    ds_read2st64_b32 v[10:11], v101 offset0:34 offset1:35
    ds_read2st64_b32 v[12:13], v101 offset0:36 offset1:37
    ds_read2st64_b32 v[14:15], v101 offset0:38 offset1:39
    s_waitcnt lgkmcnt(7)
    v_perm_b32 v64, v1, v0, s50
    s_waitcnt lgkmcnt(6)
    v_perm_b32 v65, v3, v2, s50
    s_waitcnt lgkmcnt(5)
    v_perm_b32 v66, v5, v4, s50
    s_waitcnt lgkmcnt(4)
    v_perm_b32 v67, v7, v6, s50
    s_waitcnt lgkmcnt(3)
    v_perm_b32 v68, v9, v8, s50
    s_waitcnt lgkmcnt(2)
    v_perm_b32 v69, v11, v10, s50
    s_waitcnt lgkmcnt(1)
    v_perm_b32 v70, v13, v12, s50
    s_waitcnt lgkmcnt(0)
    v_perm_b32 v71, v15, v14, s50
    v_accvgpr_write_b32 a64, v64
    v_accvgpr_write_b32 a65, v65
    v_accvgpr_write_b32 a66, v66
    v_accvgpr_write_b32 a67, v67
    v_accvgpr_write_b32 a68, v68
    v_accvgpr_write_b32 a69, v69
    v_accvgpr_write_b32 a70, v70
    v_accvgpr_write_b32 a71, v71
    v_perm_b32 v72, v1, v0, s51
    v_perm_b32 v73, v3, v2, s51
    v_perm_b32 v74, v5, v4, s51
    v_perm_b32 v75, v7, v6, s51
    v_perm_b32 v76, v9, v8, s51
    v_perm_b32 v77, v11, v10, s51
    v_perm_b32 v78, v13, v12, s51
    v_perm_b32 v79, v15, v14, s51
    v_accvgpr_write_b32 a72, v72
    v_accvgpr_write_b32 a73, v73
    v_accvgpr_write_b32 a74, v74
    v_accvgpr_write_b32 a75, v75
    v_accvgpr_write_b32 a76, v76
    v_accvgpr_write_b32 a77, v77
    v_accvgpr_write_b32 a78, v78
    v_accvgpr_write_b32 a79, v79
    s_waitcnt vmcnt(28) lgkmcnt(0)
    s_barrier
    s_add_u32 m0, s55, 65536
    s_mov_b32 s54, 0x280000
    buffer_load_dwordx4 v100, s[44:47], s54 offen lds
    s_add_u32 m0, s55, 66560
    s_mov_b32 s54, 0x288000
    buffer_load_dwordx4 v100, s[44:47], s54 offen lds
    s_add_u32 m0, s55, 67584
    s_mov_b32 s54, 0x290000
    buffer_load_dwordx4 v100, s[44:47], s54 offen lds
    s_add_u32 m0, s55, 68608
    s_mov_b32 s54, 0x298000
    buffer_load_dwordx4 v100, s[44:47], s54 offen lds
    v_add_u32 v101, 81920, v102
    ds_read2st64_b32 v[0:1], v101 offset0:0 offset1:1
    ds_read2st64_b32 v[2:3], v101 offset0:2 offset1:3
    ds_read2st64_b32 v[4:5], v101 offset0:4 offset1:5
    ds_read2st64_b32 v[6:7], v101 offset0:6 offset1:7
    ds_read2st64_b32 v[8:9], v101 offset0:32 offset1:33
    ds_read2st64_b32 v[10:11], v101 offset0:34 offset1:35
    ds_read2st64_b32 v[12:13], v101 offset0:36 offset1:37
    ds_read2st64_b32 v[14:15], v101 offset0:38 offset1:39
    s_waitcnt lgkmcnt(7)
    v_perm_b32 v64, v1, v0, s50
    s_waitcnt lgkmcnt(6)
    v_perm_b32 v65, v3, v2, s50
    s_waitcnt lgkmcnt(5)
    v_perm_b32 v66, v5, v4, s50
    s_waitcnt lgkmcnt(4)
    v_perm_b32 v67, v7, v6, s50
    s_waitcnt lgkmcnt(3)
    v_perm_b32 v68, v9, v8, s50
    s_waitcnt lgkmcnt(2)
    v_perm_b32 v69, v11, v10, s50
    s_waitcnt lgkmcnt(1)
    v_perm_b32 v70, v13, v12, s50
    s_waitcnt lgkmcnt(0)
    v_perm_b32 v71, v15, v14, s50
    v_accvgpr_write_b32 a80, v64
    v_accvgpr_write_b32 a81, v65
    v_accvgpr_write_b32 a82, v66
    v_accvgpr_write_b32 a83, v67
    v_accvgpr_write_b32 a84, v68
    v_accvgpr_write_b32 a85, v69
    v_accvgpr_write_b32 a86, v70
    v_accvgpr_write_b32 a87, v71
    v_perm_b32 v72, v1, v0, s51
    v_perm_b32 v73, v3, v2, s51
    v_perm_b32 v74, v5, v4, s51
    v_perm_b32 v75, v7, v6, s51
    v_perm_b32 v76, v9, v8, s51
    v_perm_b32 v77, v11, v10, s51
    v_perm_b32 v78, v13, v12, s51
    v_perm_b32 v79, v15, v14, s51
    v_accvgpr_write_b32 a88, v72
    v_accvgpr_write_b32 a89, v73
    v_accvgpr_write_b32 a90, v74
    v_accvgpr_write_b32 a91, v75
    v_accvgpr_write_b32 a92, v76
    v_accvgpr_write_b32 a93, v77
    v_accvgpr_write_b32 a94, v78
    v_accvgpr_write_b32 a95, v79
    s_waitcnt vmcnt(28) lgkmcnt(0)
    s_barrier
    s_add_u32 m0, s55, 81920
    s_mov_b32 s54, 0x300000
    buffer_load_dwordx4 v100, s[44:47], s54 offen lds
    s_add_u32 m0, s55, 82944
    s_mov_b32 s54, 0x308000
    buffer_load_dwordx4 v100, s[44:47], s54 offen lds
    s_add_u32 m0, s55, 83968
    s_mov_b32 s54, 0x310000
    buffer_load_dwordx4 v100, s[44:47], s54 offen lds
    s_add_u32 m0, s55, 84992
    s_mov_b32 s54, 0x318000
    buffer_load_dwordx4 v100, s[44:47], s54 offen lds
    v_add_u32 v101, 98304, v102
    ds_read2st64_b32 v[0:1], v101 offset0:0 offset1:1
    ds_read2st64_b32 v[2:3], v101 offset0:2 offset1:3
    ds_read2st64_b32 v[4:5], v101 offset0:4 offset1:5
    ds_read2st64_b32 v[6:7], v101 offset0:6 offset1:7
    ds_read2st64_b32 v[8:9], v101 offset0:32 offset1:33
    ds_read2st64_b32 v[10:11], v101 offset0:34 offset1:35
    ds_read2st64_b32 v[12:13], v101 offset0:36 offset1:37
    ds_read2st64_b32 v[14:15], v101 offset0:38 offset1:39
    s_waitcnt lgkmcnt(7)
    v_perm_b32 v64, v1, v0, s50
    s_waitcnt lgkmcnt(6)
    v_perm_b32 v65, v3, v2, s50
    s_waitcnt lgkmcnt(5)
    v_perm_b32 v66, v5, v4, s50
    s_waitcnt lgkmcnt(4)
    v_perm_b32 v67, v7, v6, s50
    s_waitcnt lgkmcnt(3)
    v_perm_b32 v68, v9, v8, s50
    s_waitcnt lgkmcnt(2)
    v_perm_b32 v69, v11, v10, s50
    s_waitcnt lgkmcnt(1)
    v_perm_b32 v70, v13, v12, s50
    s_waitcnt lgkmcnt(0)
    v_perm_b32 v71, v15, v14, s50
    v_accvgpr_write_b32 a96, v64
    v_accvgpr_write_b32 a97, v65
    v_accvgpr_write_b32 a98, v66
    v_accvgpr_write_b32 a99, v67
    v_accvgpr_write_b32 a100, v68
    v_accvgpr_write_b32 a101, v69
    v_accvgpr_write_b32 a102, v70
    v_accvgpr_write_b32 a103, v71
    v_perm_b32 v72, v1, v0, s51
    v_perm_b32 v73, v3, v2, s51
    v_perm_b32 v74, v5, v4, s51
    v_perm_b32 v75, v7, v6, s51
    v_perm_b32 v76, v9, v8, s51
    v_perm_b32 v77, v11, v10, s51
    v_perm_b32 v78, v13, v12, s51
    v_perm_b32 v79, v15, v14, s51
    v_accvgpr_write_b32 a104, v72
    v_accvgpr_write_b32 a105, v73
    v_accvgpr_write_b32 a106, v74
    v_accvgpr_write_b32 a107, v75
    v_accvgpr_write_b32 a108, v76
    v_accvgpr_write_b32 a109, v77
    v_accvgpr_write_b32 a110, v78
    v_accvgpr_write_b32 a111, v79
    s_waitcnt vmcnt(28) lgkmcnt(0)
    s_barrier
    s_add_u32 m0, s55, 98304
    s_mov_b32 s54, 0x380000
    buffer_load_dwordx4 v100, s[44:47], s54 offen lds
    s_add_u32 m0, s55, 99328
    s_mov_b32 s54, 0x388000
    buffer_load_dwordx4 v100, s[44:47], s54 offen lds
    s_add_u32 m0, s55, 100352
    s_mov_b32 s54, 0x390000
    buffer_load_dwordx4 v100, s[44:47], s54 offen lds
    s_add_u32 m0, s55, 101376
    s_mov_b32 s54, 0x398000
    buffer_load_dwordx4 v100, s[44:47], s54 offen lds
    v_add_u32 v101, 114688, v102
    ds_read2st64_b32 v[0:1], v101 offset0:0 offset1:1
    ds_read2st64_b32 v[2:3], v101 offset0:2 offset1:3
    ds_read2st64_b32 v[4:5], v101 offset0:4 offset1:5
    ds_read2st64_b32 v[6:7], v101 offset0:6 offset1:7
    ds_read2st64_b32 v[8:9], v101 offset0:32 offset1:33
    ds_read2st64_b32 v[10:11], v101 offset0:34 offset1:35
    ds_read2st64_b32 v[12:13], v101 offset0:36 offset1:37
    ds_read2st64_b32 v[14:15], v101 offset0:38 offset1:39
    s_waitcnt lgkmcnt(7)
    v_perm_b32 v64, v1, v0, s50
    s_waitcnt lgkmcnt(6)
    v_perm_b32 v65, v3, v2, s50
    s_waitcnt lgkmcnt(5)
    v_perm_b32 v66, v5, v4, s50
    s_waitcnt lgkmcnt(4)
    v_perm_b32 v67, v7, v6, s50
    s_waitcnt lgkmcnt(3)
    v_perm_b32 v68, v9, v8, s50
    s_waitcnt lgkmcnt(2)
    v_perm_b32 v69, v11, v10, s50
    s_waitcnt lgkmcnt(1)
    v_perm_b32 v70, v13, v12, s50
    s_waitcnt lgkmcnt(0)
    v_perm_b32 v71, v15, v14, s50
    v_accvgpr_write_b32 a112, v64
    v_accvgpr_write_b32 a113, v65
    v_accvgpr_write_b32 a114, v66
    v_accvgpr_write_b32 a115, v67
    v_accvgpr_write_b32 a116, v68
    v_accvgpr_write_b32 a117, v69
    v_accvgpr_write_b32 a118, v70
    v_accvgpr_write_b32 a119, v71
    v_perm_b32 v72, v1, v0, s51
    v_perm_b32 v73, v3, v2, s51
    v_perm_b32 v74, v5, v4, s51
    v_perm_b32 v75, v7, v6, s51
    v_perm_b32 v76, v9, v8, s51
    v_perm_b32 v77, v11, v10, s51
    v_perm_b32 v78, v13, v12, s51
    v_perm_b32 v79, v15, v14, s51
    v_accvgpr_write_b32 a120, v72
    v_accvgpr_write_b32 a121, v73
    v_accvgpr_write_b32 a122, v74
    v_accvgpr_write_b32 a123, v75
    v_accvgpr_write_b32 a124, v76
    v_accvgpr_write_b32 a125, v77
    v_accvgpr_write_b32 a126, v78
    v_accvgpr_write_b32 a127, v79
    s_waitcnt vmcnt(28) lgkmcnt(0)
    s_barrier
    v_add_u32 v101, 131072, v102
    ds_read2st64_b32 v[0:1], v101 offset0:0 offset1:1
    ds_read2st64_b32 v[2:3], v101 offset0:2 offset1:3
    ds_read2st64_b32 v[4:5], v101 offset0:4 offset1:5
    ds_read2st64_b32 v[6:7], v101 offset0:6 offset1:7
    ds_read2st64_b32 v[8:9], v101 offset0:32 offset1:33
    ds_read2st64_b32 v[10:11], v101 offset0:34 offset1:35
    ds_read2st64_b32 v[12:13], v101 offset0:36 offset1:37
    ds_read2st64_b32 v[14:15], v101 offset0:38 offset1:39
    s_waitcnt lgkmcnt(7)
    v_perm_b32 v64, v1, v0, s50
    s_waitcnt lgkmcnt(6)
    v_perm_b32 v65, v3, v2, s50
    s_waitcnt lgkmcnt(5)
    v_perm_b32 v66, v5, v4, s50
    s_waitcnt lgkmcnt(4)
    v_perm_b32 v67, v7, v6, s50
    s_waitcnt lgkmcnt(3)
    v_perm_b32 v68, v9, v8, s50
    s_waitcnt lgkmcnt(2)
    v_perm_b32 v69, v11, v10, s50
    s_waitcnt lgkmcnt(1)
    v_perm_b32 v70, v13, v12, s50
    s_waitcnt lgkmcnt(0)
    v_perm_b32 v71, v15, v14, s50
    v_accvgpr_write_b32 a128, v64
    v_accvgpr_write_b32 a129, v65
    v_accvgpr_write_b32 a130, v66
    v_accvgpr_write_b32 a131, v67
    v_accvgpr_write_b32 a132, v68
    v_accvgpr_write_b32 a133, v69
    v_accvgpr_write_b32 a134, v70
    v_accvgpr_write_b32 a135, v71
    v_perm_b32 v72, v1, v0, s51
    v_perm_b32 v73, v3, v2, s51
    v_perm_b32 v74, v5, v4, s51
    v_perm_b32 v75, v7, v6, s51
    v_perm_b32 v76, v9, v8, s51
    v_perm_b32 v77, v11, v10, s51
    v_perm_b32 v78, v13, v12, s51
    v_perm_b32 v79, v15, v14, s51
    v_accvgpr_write_b32 a136, v72
    v_accvgpr_write_b32 a137, v73
    v_accvgpr_write_b32 a138, v74
    v_accvgpr_write_b32 a139, v75
    v_accvgpr_write_b32 a140, v76
    v_accvgpr_write_b32 a141, v77
    v_accvgpr_write_b32 a142, v78
    v_accvgpr_write_b32 a143, v79
    s_waitcnt vmcnt(24) lgkmcnt(0)
    s_barrier
    v_add_u32 v101, 0, v102
    ds_read2st64_b32 v[0:1], v101 offset0:0 offset1:1
    ds_read2st64_b32 v[2:3], v101 offset0:2 offset1:3
    ds_read2st64_b32 v[4:5], v101 offset0:4 offset1:5
    ds_read2st64_b32 v[6:7], v101 offset0:6 offset1:7
    ds_read2st64_b32 v[8:9], v101 offset0:32 offset1:33
    ds_read2st64_b32 v[10:11], v101 offset0:34 offset1:35
    ds_read2st64_b32 v[12:13], v101 offset0:36 offset1:37
    ds_read2st64_b32 v[14:15], v101 offset0:38 offset1:39
    s_waitcnt lgkmcnt(7)
    v_perm_b32 v64, v1, v0, s50
    s_waitcnt lgkmcnt(6)
    v_perm_b32 v65, v3, v2, s50
    s_waitcnt lgkmcnt(5)
    v_perm_b32 v66, v5, v4, s50
    s_waitcnt lgkmcnt(4)
    v_perm_b32 v67, v7, v6, s50
    s_waitcnt lgkmcnt(3)
    v_perm_b32 v68, v9, v8, s50
    s_waitcnt lgkmcnt(2)
    v_perm_b32 v69, v11, v10, s50
    s_waitcnt lgkmcnt(1)
    v_perm_b32 v70, v13, v12, s50
    s_waitcnt lgkmcnt(0)
    v_perm_b32 v71, v15, v14, s50
    v_accvgpr_write_b32 a144, v64
    v_accvgpr_write_b32 a145, v65
    v_accvgpr_write_b32 a146, v66
    v_accvgpr_write_b32 a147, v67
    v_accvgpr_write_b32 a148, v68
    v_accvgpr_write_b32 a149, v69
    v_accvgpr_write_b32 a150, v70
    v_accvgpr_write_b32 a151, v71
    v_perm_b32 v72, v1, v0, s51
    v_perm_b32 v73, v3, v2, s51
    v_perm_b32 v74, v5, v4, s51
    v_perm_b32 v75, v7, v6, s51
    v_perm_b32 v76, v9, v8, s51
    v_perm_b32 v77, v11, v10, s51
    v_perm_b32 v78, v13, v12, s51
    v_perm_b32 v79, v15, v14, s51
    v_accvgpr_write_b32 a152, v72
    v_accvgpr_write_b32 a153, v73
    v_accvgpr_write_b32 a154, v74
    v_accvgpr_write_b32 a155, v75
    v_accvgpr_write_b32 a156, v76
    v_accvgpr_write_b32 a157, v77
    v_accvgpr_write_b32 a158, v78
    v_accvgpr_write_b32 a159, v79
    s_waitcnt vmcnt(20) lgkmcnt(0)
    s_barrier
    v_add_u32 v101, 16384, v102
    ds_read2st64_b32 v[0:1], v101 offset0:0 offset1:1
    ds_read2st64_b32 v[2:3], v101 offset0:2 offset1:3
    ds_read2st64_b32 v[4:5], v101 offset0:4 offset1:5
    ds_read2st64_b32 v[6:7], v101 offset0:6 offset1:7
    ds_read2st64_b32 v[8:9], v101 offset0:32 offset1:33
    ds_read2st64_b32 v[10:11], v101 offset0:34 offset1:35
    ds_read2st64_b32 v[12:13], v101 offset0:36 offset1:37
    ds_read2st64_b32 v[14:15], v101 offset0:38 offset1:39
    s_waitcnt lgkmcnt(7)
    v_perm_b32 v64, v1, v0, s50
    s_waitcnt lgkmcnt(6)
    v_perm_b32 v65, v3, v2, s50
    s_waitcnt lgkmcnt(5)
    v_perm_b32 v66, v5, v4, s50
    s_waitcnt lgkmcnt(4)
    v_perm_b32 v67, v7, v6, s50
    s_waitcnt lgkmcnt(3)
    v_perm_b32 v68, v9, v8, s50
    s_waitcnt lgkmcnt(2)
    v_perm_b32 v69, v11, v10, s50
    s_waitcnt lgkmcnt(1)
    v_perm_b32 v70, v13, v12, s50
    s_waitcnt lgkmcnt(0)
    v_perm_b32 v71, v15, v14, s50
    v_accvgpr_write_b32 a160, v64
    v_accvgpr_write_b32 a161, v65
    v_accvgpr_write_b32 a162, v66
    v_accvgpr_write_b32 a163, v67
    v_accvgpr_write_b32 a164, v68
    v_accvgpr_write_b32 a165, v69
    v_accvgpr_write_b32 a166, v70
    v_accvgpr_write_b32 a167, v71
    v_perm_b32 v72, v1, v0, s51
    v_perm_b32 v73, v3, v2, s51
    v_perm_b32 v74, v5, v4, s51
    v_perm_b32 v75, v7, v6, s51
    v_perm_b32 v76, v9, v8, s51
    v_perm_b32 v77, v11, v10, s51
    v_perm_b32 v78, v13, v12, s51
    v_perm_b32 v79, v15, v14, s51
    v_accvgpr_write_b32 a168, v72
    v_accvgpr_write_b32 a169, v73
    v_accvgpr_write_b32 a170, v74
    v_accvgpr_write_b32 a171, v75
    v_accvgpr_write_b32 a172, v76
    v_accvgpr_write_b32 a173, v77
    v_accvgpr_write_b32 a174, v78
    v_accvgpr_write_b32 a175, v79
    s_waitcnt vmcnt(16) lgkmcnt(0)
    s_barrier
    v_add_u32 v101, 32768, v102
    ds_read2st64_b32 v[0:1], v101 offset0:0 offset1:1
    ds_read2st64_b32 v[2:3], v101 offset0:2 offset1:3
    ds_read2st64_b32 v[4:5], v101 offset0:4 offset1:5
    ds_read2st64_b32 v[6:7], v101 offset0:6 offset1:7
    ds_read2st64_b32 v[8:9], v101 offset0:32 offset1:33
    ds_read2st64_b32 v[10:11], v101 offset0:34 offset1:35
    ds_read2st64_b32 v[12:13], v101 offset0:36 offset1:37
    ds_read2st64_b32 v[14:15], v101 offset0:38 offset1:39
    s_waitcnt lgkmcnt(7)
    v_perm_b32 v64, v1, v0, s50
    s_waitcnt lgkmcnt(6)
    v_perm_b32 v65, v3, v2, s50
    s_waitcnt lgkmcnt(5)
    v_perm_b32 v66, v5, v4, s50
    s_waitcnt lgkmcnt(4)
    v_perm_b32 v67, v7, v6, s50
    s_waitcnt lgkmcnt(3)
    v_perm_b32 v68, v9, v8, s50
    s_waitcnt lgkmcnt(2)
    v_perm_b32 v69, v11, v10, s50
    s_waitcnt lgkmcnt(1)
    v_perm_b32 v70, v13, v12, s50
    s_waitcnt lgkmcnt(0)
    v_perm_b32 v71, v15, v14, s50
    v_accvgpr_write_b32 a176, v64
    v_accvgpr_write_b32 a177, v65
    v_accvgpr_write_b32 a178, v66
    v_accvgpr_write_b32 a179, v67
    v_accvgpr_write_b32 a180, v68
    v_accvgpr_write_b32 a181, v69
    v_accvgpr_write_b32 a182, v70
    v_accvgpr_write_b32 a183, v71
    v_perm_b32 v72, v1, v0, s51
    v_perm_b32 v73, v3, v2, s51
    v_perm_b32 v74, v5, v4, s51
    v_perm_b32 v75, v7, v6, s51
    v_perm_b32 v76, v9, v8, s51
    v_perm_b32 v77, v11, v10, s51
    v_perm_b32 v78, v13, v12, s51
    v_perm_b32 v79, v15, v14, s51
    v_accvgpr_write_b32 a184, v72
    v_accvgpr_write_b32 a185, v73
    v_accvgpr_write_b32 a186, v74
    v_accvgpr_write_b32 a187, v75
    v_accvgpr_write_b32 a188, v76
    v_accvgpr_write_b32 a189, v77
    v_accvgpr_write_b32 a190, v78
    v_accvgpr_write_b32 a191, v79
    s_waitcnt vmcnt(12) lgkmcnt(0)
    s_barrier
    v_add_u32 v101, 49152, v102
    ds_read2st64_b32 v[0:1], v101 offset0:0 offset1:1
    ds_read2st64_b32 v[2:3], v101 offset0:2 offset1:3
    ds_read2st64_b32 v[4:5], v101 offset0:4 offset1:5
    ds_read2st64_b32 v[6:7], v101 offset0:6 offset1:7
    ds_read2st64_b32 v[8:9], v101 offset0:32 offset1:33
    ds_read2st64_b32 v[10:11], v101 offset0:34 offset1:35
    ds_read2st64_b32 v[12:13], v101 offset0:36 offset1:37
    ds_read2st64_b32 v[14:15], v101 offset0:38 offset1:39
    s_waitcnt lgkmcnt(7)
    v_perm_b32 v64, v1, v0, s50
    s_waitcnt lgkmcnt(6)
    v_perm_b32 v65, v3, v2, s50
    s_waitcnt lgkmcnt(5)
    v_perm_b32 v66, v5, v4, s50
    s_waitcnt lgkmcnt(4)
    v_perm_b32 v67, v7, v6, s50
    s_waitcnt lgkmcnt(3)
    v_perm_b32 v68, v9, v8, s50
    s_waitcnt lgkmcnt(2)
    v_perm_b32 v69, v11, v10, s50
    s_waitcnt lgkmcnt(1)
    v_perm_b32 v70, v13, v12, s50
    s_waitcnt lgkmcnt(0)
    v_perm_b32 v71, v15, v14, s50
    v_accvgpr_write_b32 a192, v64
    v_accvgpr_write_b32 a193, v65
    v_accvgpr_write_b32 a194, v66
    v_accvgpr_write_b32 a195, v67
    v_accvgpr_write_b32 a196, v68
    v_accvgpr_write_b32 a197, v69
    v_accvgpr_write_b32 a198, v70
    v_accvgpr_write_b32 a199, v71
    v_perm_b32 v72, v1, v0, s51
    v_perm_b32 v73, v3, v2, s51
    v_perm_b32 v74, v5, v4, s51
    v_perm_b32 v75, v7, v6, s51
    v_perm_b32 v76, v9, v8, s51
    v_perm_b32 v77, v11, v10, s51
    v_perm_b32 v78, v13, v12, s51
    v_perm_b32 v79, v15, v14, s51
    v_accvgpr_write_b32 a200, v72
    v_accvgpr_write_b32 a201, v73
    v_accvgpr_write_b32 a202, v74
    v_accvgpr_write_b32 a203, v75
    v_accvgpr_write_b32 a204, v76
    v_accvgpr_write_b32 a205, v77
    v_accvgpr_write_b32 a206, v78
    v_accvgpr_write_b32 a207, v79
    s_waitcnt vmcnt(8) lgkmcnt(0)
    s_barrier
    v_add_u32 v101, 65536, v102
    ds_read2st64_b32 v[0:1], v101 offset0:0 offset1:1
    ds_read2st64_b32 v[2:3], v101 offset0:2 offset1:3
    ds_read2st64_b32 v[4:5], v101 offset0:4 offset1:5
    ds_read2st64_b32 v[6:7], v101 offset0:6 offset1:7
    ds_read2st64_b32 v[8:9], v101 offset0:32 offset1:33
    ds_read2st64_b32 v[10:11], v101 offset0:34 offset1:35
    ds_read2st64_b32 v[12:13], v101 offset0:36 offset1:37
    ds_read2st64_b32 v[14:15], v101 offset0:38 offset1:39
    s_waitcnt lgkmcnt(7)
    v_perm_b32 v64, v1, v0, s50
    s_waitcnt lgkmcnt(6)
    v_perm_b32 v65, v3, v2, s50
    s_waitcnt lgkmcnt(5)
    v_perm_b32 v66, v5, v4, s50
    s_waitcnt lgkmcnt(4)
    v_perm_b32 v67, v7, v6, s50
    s_waitcnt lgkmcnt(3)
    v_perm_b32 v68, v9, v8, s50
    s_waitcnt lgkmcnt(2)
    v_perm_b32 v69, v11, v10, s50
    s_waitcnt lgkmcnt(1)
    v_perm_b32 v70, v13, v12, s50
    s_waitcnt lgkmcnt(0)
    v_perm_b32 v71, v15, v14, s50
    v_accvgpr_write_b32 a208, v64
    v_accvgpr_write_b32 a209, v65
    v_accvgpr_write_b32 a210, v66
    v_accvgpr_write_b32 a211, v67
    v_accvgpr_write_b32 a212, v68
    v_accvgpr_write_b32 a213, v69
    v_accvgpr_write_b32 a214, v70
    v_accvgpr_write_b32 a215, v71
    v_perm_b32 v72, v1, v0, s51
    v_perm_b32 v73, v3, v2, s51
    v_perm_b32 v74, v5, v4, s51
    v_perm_b32 v75, v7, v6, s51
    v_perm_b32 v76, v9, v8, s51
    v_perm_b32 v77, v11, v10, s51
    v_perm_b32 v78, v13, v12, s51
    v_perm_b32 v79, v15, v14, s51
    v_accvgpr_write_b32 a216, v72
    v_accvgpr_write_b32 a217, v73
    v_accvgpr_write_b32 a218, v74
    v_accvgpr_write_b32 a219, v75
    v_accvgpr_write_b32 a220, v76
    v_accvgpr_write_b32 a221, v77
    v_accvgpr_write_b32 a222, v78
    v_accvgpr_write_b32 a223, v79
    s_waitcnt vmcnt(4) lgkmcnt(0)
    s_barrier
    v_add_u32 v101, 81920, v102
    ds_read2st64_b32 v[0:1], v101 offset0:0 offset1:1
    ds_read2st64_b32 v[2:3], v101 offset0:2 offset1:3
    ds_read2st64_b32 v[4:5], v101 offset0:4 offset1:5
    ds_read2st64_b32 v[6:7], v101 offset0:6 offset1:7
    ds_read2st64_b32 v[8:9], v101 offset0:32 offset1:33
    ds_read2st64_b32 v[10:11], v101 offset0:34 offset1:35
    ds_read2st64_b32 v[12:13], v101 offset0:36 offset1:37
    ds_read2st64_b32 v[14:15], v101 offset0:38 offset1:39
    s_waitcnt lgkmcnt(7)
    v_perm_b32 v64, v1, v0, s50
    s_waitcnt lgkmcnt(6)
    v_perm_b32 v65, v3, v2, s50
    s_waitcnt lgkmcnt(5)
    v_perm_b32 v66, v5, v4, s50
    s_waitcnt lgkmcnt(4)
    v_perm_b32 v67, v7, v6, s50
    s_waitcnt lgkmcnt(3)
    v_perm_b32 v68, v9, v8, s50
    s_waitcnt lgkmcnt(2)
    v_perm_b32 v69, v11, v10, s50
    s_waitcnt lgkmcnt(1)
    v_perm_b32 v70, v13, v12, s50
    s_waitcnt lgkmcnt(0)
    v_perm_b32 v71, v15, v14, s50
    v_accvgpr_write_b32 a224, v64
    v_accvgpr_write_b32 a225, v65
    v_accvgpr_write_b32 a226, v66
    v_accvgpr_write_b32 a227, v67
    v_accvgpr_write_b32 a228, v68
    v_accvgpr_write_b32 a229, v69
    v_accvgpr_write_b32 a230, v70
    v_accvgpr_write_b32 a231, v71
    v_perm_b32 v72, v1, v0, s51
    v_perm_b32 v73, v3, v2, s51
    v_perm_b32 v74, v5, v4, s51
    v_perm_b32 v75, v7, v6, s51
    v_perm_b32 v76, v9, v8, s51
    v_perm_b32 v77, v11, v10, s51
    v_perm_b32 v78, v13, v12, s51
    v_perm_b32 v79, v15, v14, s51
    v_accvgpr_write_b32 a232, v72
    v_accvgpr_write_b32 a233, v73
    v_accvgpr_write_b32 a234, v74
    v_accvgpr_write_b32 a235, v75
    v_accvgpr_write_b32 a236, v76
    v_accvgpr_write_b32 a237, v77
    v_accvgpr_write_b32 a238, v78
    v_accvgpr_write_b32 a239, v79
    s_waitcnt vmcnt(0) lgkmcnt(0)
    s_barrier
    v_add_u32 v101, 98304, v102
    ds_read2st64_b32 v[0:1], v101 offset0:0 offset1:1
    ds_read2st64_b32 v[2:3], v101 offset0:2 offset1:3
    ds_read2st64_b32 v[4:5], v101 offset0:4 offset1:5
    ds_read2st64_b32 v[6:7], v101 offset0:6 offset1:7
    ds_read2st64_b32 v[8:9], v101 offset0:32 offset1:33
    ds_read2st64_b32 v[10:11], v101 offset0:34 offset1:35
    ds_read2st64_b32 v[12:13], v101 offset0:36 offset1:37
    ds_read2st64_b32 v[14:15], v101 offset0:38 offset1:39
    s_waitcnt lgkmcnt(7)
    v_perm_b32 v64, v1, v0, s50
    s_waitcnt lgkmcnt(6)
    v_perm_b32 v65, v3, v2, s50
    s_waitcnt lgkmcnt(5)
    v_perm_b32 v66, v5, v4, s50
    s_waitcnt lgkmcnt(4)
    v_perm_b32 v67, v7, v6, s50
    s_waitcnt lgkmcnt(3)
    v_perm_b32 v68, v9, v8, s50
    s_waitcnt lgkmcnt(2)
    v_perm_b32 v69, v11, v10, s50
    s_waitcnt lgkmcnt(1)
    v_perm_b32 v70, v13, v12, s50
    s_waitcnt lgkmcnt(0)
    v_perm_b32 v71, v15, v14, s50
    v_accvgpr_write_b32 a240, v64
    v_accvgpr_write_b32 a241, v65
    v_accvgpr_write_b32 a242, v66
    v_accvgpr_write_b32 a243, v67
    v_accvgpr_write_b32 a244, v68
    v_accvgpr_write_b32 a245, v69
    v_accvgpr_write_b32 a246, v70
    v_accvgpr_write_b32 a247, v71
    v_perm_b32 v72, v1, v0, s51
    v_perm_b32 v73, v3, v2, s51
    v_perm_b32 v74, v5, v4, s51
    v_perm_b32 v75, v7, v6, s51
    v_perm_b32 v76, v9, v8, s51
    v_perm_b32 v77, v11, v10, s51
    v_perm_b32 v78, v13, v12, s51
    v_perm_b32 v79, v15, v14, s51
    v_accvgpr_write_b32 a248, v72
    v_accvgpr_write_b32 a249, v73
    v_accvgpr_write_b32 a250, v74
    v_accvgpr_write_b32 a251, v75
    v_accvgpr_write_b32 a252, v76
    v_accvgpr_write_b32 a253, v77
    v_accvgpr_write_b32 a254, v78
    v_accvgpr_write_b32 a255, v79
    s_waitcnt vmcnt(0) lgkmcnt(0)
    s_barrier
    v_lshlrev_b32 v1, 4, v125
    s_lshl_b32 s68, s49, 10
    v_add_u32 v1, s68, v1
    v_mov_b32 v4, -1
    v_mov_b32 v5, -1
    v_mov_b32 v6, -1
    v_mov_b32 v7, -1
    s_lshl_b32 s68, s65, 17
    s_lshl_b32 s69, s48, 12
    s_add_u32 s68, s68, s69
    s_add_u32 s68, s68, 0x4100000
    buffer_store_dwordx4 v[4:7], v1, s[40:43], s68 offen sc1
    s_add_u32 s68, s68, 0xe0000
    buffer_store_dwordx4 v[4:7], v1, s[40:43], s68 offen sc1
    s_add_u32 s68, s68, 0xe0000
    buffer_store_dwordx4 v[4:7], v1, s[40:43], s68 offen sc1
    s_add_u32 s68, s68, 0xe0000
    buffer_store_dwordx4 v[4:7], v1, s[40:43], s68 offen sc1
    s_add_u32 s68, s68, 0xe0000
    buffer_store_dwordx4 v[4:7], v1, s[40:43], s68 offen sc1
    s_add_u32 s68, s68, 0xe0000
    buffer_store_dwordx4 v[4:7], v1, s[40:43], s68 offen sc1
    s_add_u32 s68, s68, 0xe0000
    buffer_store_dwordx4 v[4:7], v1, s[40:43], s68 offen sc1
    s_add_u32 s68, s68, 0xe0000
    buffer_store_dwordx4 v[4:7], v1, s[40:43], s68 offen sc1
    s_add_u32 s68, s68, 0xe0000
    buffer_store_dwordx4 v[4:7], v1, s[40:43], s68 offen sc1
    s_add_u32 s68, s68, 0xe0000
    buffer_store_dwordx4 v[4:7], v1, s[40:43], s68 offen sc1
    v_lshlrev_b32 v112, 4, v125
    s_lshl_b32 s53, s49, 11
    v_add_u32 v113, s53, v112
    s_mov_b32 s66, s65
    s_mov_b32 s67, 0
    s_lshl_b32 s71, s48, 3
    s_add_u32 s71, s71, s65
    s_lshl_b32 s71, s71, 6
    s_add_u32 s71, s71, 0x201000
    s_lshl_b32 s68, s66, 15
    s_add_u32 s68, s68, 0x400000
    s_lshl_b32 s70, s66, 6
    s_add_u32 s70, s70, 0x200000
    s_cmp_lg_u32 s49, 0
    s_cbranch_scc1 L_fd13
    v_mov_b32 v114, 16
    s_nop 1
L_fi12:
    global_load_dword v115, v114, s[34:35] sc1
    s_waitcnt vmcnt(0)
    v_readfirstlane_b32 s54, v115
    s_and_b32 s53, s54, 0xffff
    s_cmp_ge_u32 s53, 32
    s_nop 1
    s_cbranch_scc1 L_fd13
    s_add_u32 s60, s60, 1
    s_cmp_gt_u32 s60, 0x40000
    s_cbranch_scc1 L_exit
    s_sleep 2
    s_branch L_fi12
L_fd13:
    s_cmp_lg_u32 s49, 0
    s_cbranch_scc1 L_wd15
    v_mov_b32 v114, 0
    s_nop 1
L_w14:
    buffer_load_dword v115, v114, s[40:43], s70 offen sc1
    s_waitcnt vmcnt(0)
    v_readfirstlane_b32 s53, v115
    s_cmp_ge_u32 s53, 2
    s_nop 2
    s_cbranch_scc1 L_wd15
    s_add_u32 s60, s60, 1
    s_cmp_gt_u32 s60, 0x40000
    s_cbranch_scc1 L_exit
    s_sleep 2
    s_branch L_w14
L_wd15:
    s_waitcnt vmcnt(0)
    s_barrier
    s_add_u32 s69, s68, 0x0
    buffer_load_dwordx4 v[128:131], v112, s[40:43], s69 offen offset:0
    buffer_load_dwordx4 v[132:135], v112, s[40:43], s69 offen offset:1024
    buffer_load_dwordx4 v[136:139], v112, s[40:43], s69 offen offset:2048
    buffer_load_dwordx4 v[140:143], v112, s[40:43], s69 offen offset:3072
    s_add_u32 s69, s68, 0x1000
    buffer_load_dwordx4 v[144:147], v112, s[40:43], s69 offen offset:0
    buffer_load_dwordx4 v[148:151], v112, s[40:43], s69 offen offset:1024
    buffer_load_dwordx4 v[152:155], v112, s[40:43], s69 offen offset:2048
    buffer_load_dwordx4 v[156:159], v112, s[40:43], s69 offen offset:3072
    s_add_u32 s69, s68, 0x4000
    buffer_load_dwordx4 v[160:163], v112, s[40:43], s69 offen offset:0
    buffer_load_dwordx4 v[164:167], v112, s[40:43], s69 offen offset:1024
    buffer_load_dwordx4 v[168:171], v112, s[40:43], s69 offen offset:2048
    buffer_load_dwordx4 v[172:175], v112, s[40:43], s69 offen offset:3072
    s_add_u32 s69, s68, 0x5000
    buffer_load_dwordx4 v[176:179], v112, s[40:43], s69 offen offset:0
    buffer_load_dwordx4 v[180:183], v112, s[40:43], s69 offen offset:1024
    buffer_load_dwordx4 v[184:187], v112, s[40:43], s69 offen offset:2048
    buffer_load_dwordx4 v[188:191], v112, s[40:43], s69 offen offset:3072
    s_waitcnt vmcnt(0)
L_gtop16:
    s_add_u32 s69, s68, 0x2000
    buffer_load_dwordx4 v[192:195], v112, s[40:43], s69 offen offset:0
    buffer_load_dwordx4 v[196:199], v112, s[40:43], s69 offen offset:1024
    buffer_load_dwordx4 v[200:203], v112, s[40:43], s69 offen offset:2048
    buffer_load_dwordx4 v[204:207], v112, s[40:43], s69 offen offset:3072
    s_add_u32 s69, s68, 0x3000
    buffer_load_dwordx4 v[208:211], v112, s[40:43], s69 offen offset:0
    buffer_load_dwordx4 v[212:215], v112, s[40:43], s69 offen offset:1024
    buffer_load_dwordx4 v[216:219], v112, s[40:43], s69 offen offset:2048
    buffer_load_dwordx4 v[220:223], v112, s[40:43], s69 offen offset:3072
    s_add_u32 s69, s68, 0x6000
    buffer_load_dwordx4 v[224:227], v112, s[40:43], s69 offen offset:0
    buffer_load_dwordx4 v[228:231], v112, s[40:43], s69 offen offset:1024
    buffer_load_dwordx4 v[232:235], v112, s[40:43], s69 offen offset:2048
    buffer_load_dwordx4 v[236:239], v112, s[40:43], s69 offen offset:3072
    s_add_u32 s69, s68, 0x7000
    buffer_load_dwordx4 v[240:243], v112, s[40:43], s69 offen offset:0
    buffer_load_dwordx4 v[244:247], v112, s[40:43], s69 offen offset:1024
    buffer_load_dwordx4 v[248:251], v112, s[40:43], s69 offen offset:2048
    buffer_load_dwordx4 v[252:255], v112, s[40:43], s69 offen offset:3072
    s_waitcnt vmcnt(20)
    v_mfma_f32_16x16x32_bf16 v[0:3], a[0:3], v[128:131], 0
    v_mfma_f32_16x16x32_bf16 v[8:11], a[8:11], v[128:131], 0
    v_mfma_f32_16x16x32_bf16 v[16:19], v[128:131], a[128:131], 0
    v_mfma_f32_16x16x32_bf16 v[24:27], v[128:131], a[136:139], 0
    v_mfma_f32_16x16x32_bf16 v[4:7], a[0:3], v[160:163], 0
    v_mfma_f32_16x16x32_bf16 v[12:15], a[8:11], v[160:163], 0
    v_mfma_f32_16x16x32_bf16 v[20:23], v[160:163], a[128:131], 0
    v_mfma_f32_16x16x32_bf16 v[28:31], v[160:163], a[136:139], 0
    v_mfma_f32_16x16x32_bf16 v[0:3], a[4:7], v[132:135], v[0:3]
    v_mfma_f32_16x16x32_bf16 v[8:11], a[12:15], v[132:135], v[8:11]
    v_mfma_f32_16x16x32_bf16 v[16:19], v[132:135], a[132:135], v[16:19]
    v_mfma_f32_16x16x32_bf16 v[24:27], v[132:135], a[140:143], v[24:27]
    v_mfma_f32_16x16x32_bf16 v[4:7], a[4:7], v[164:167], v[4:7]
    v_mfma_f32_16x16x32_bf16 v[12:15], a[12:15], v[164:167], v[12:15]
    v_mfma_f32_16x16x32_bf16 v[20:23], v[164:167], a[132:135], v[20:23]
    v_mfma_f32_16x16x32_bf16 v[28:31], v[164:167], a[140:143], v[28:31]
    v_mfma_f32_16x16x32_bf16 v[0:3], a[16:19], v[136:139], v[0:3]
    v_mfma_f32_16x16x32_bf16 v[8:11], a[24:27], v[136:139], v[8:11]
    v_mfma_f32_16x16x32_bf16 v[16:19], v[136:139], a[144:147], v[16:19]
    v_mfma_f32_16x16x32_bf16 v[24:27], v[136:139], a[152:155], v[24:27]
    v_mfma_f32_16x16x32_bf16 v[4:7], a[16:19], v[168:171], v[4:7]
    v_mfma_f32_16x16x32_bf16 v[12:15], a[24:27], v[168:171], v[12:15]
    v_mfma_f32_16x16x32_bf16 v[20:23], v[168:171], a[144:147], v[20:23]
    v_mfma_f32_16x16x32_bf16 v[28:31], v[168:171], a[152:155], v[28:31]
    v_mfma_f32_16x16x32_bf16 v[0:3], a[20:23], v[140:143], v[0:3]
    v_mfma_f32_16x16x32_bf16 v[8:11], a[28:31], v[140:143], v[8:11]
    v_mfma_f32_16x16x32_bf16 v[16:19], v[140:143], a[148:151], v[16:19]
    v_mfma_f32_16x16x32_bf16 v[24:27], v[140:143], a[156:159], v[24:27]
    v_mfma_f32_16x16x32_bf16 v[4:7], a[20:23], v[172:175], v[4:7]
    v_mfma_f32_16x16x32_bf16 v[12:15], a[28:31], v[172:175], v[12:15]
    v_mfma_f32_16x16x32_bf16 v[20:23], v[172:175], a[148:151], v[20:23]
    v_mfma_f32_16x16x32_bf16 v[28:31], v[172:175], a[156:159], v[28:31]
    v_mfma_f32_16x16x32_bf16 v[0:3], a[32:35], v[144:147], v[0:3]
    v_mfma_f32_16x16x32_bf16 v[8:11], a[40:43], v[144:147], v[8:11]
    v_mfma_f32_16x16x32_bf16 v[16:19], v[144:147], a[160:163], v[16:19]
    v_mfma_f32_16x16x32_bf16 v[24:27], v[144:147], a[168:171], v[24:27]
    v_mfma_f32_16x16x32_bf16 v[4:7], a[32:35], v[176:179], v[4:7]
    v_mfma_f32_16x16x32_bf16 v[12:15], a[40:43], v[176:179], v[12:15]
    v_mfma_f32_16x16x32_bf16 v[20:23], v[176:179], a[160:163], v[20:23]
    v_mfma_f32_16x16x32_bf16 v[28:31], v[176:179], a[168:171], v[28:31]
    v_mfma_f32_16x16x32_bf16 v[0:3], a[36:39], v[148:151], v[0:3]
    v_mfma_f32_16x16x32_bf16 v[8:11], a[44:47], v[148:151], v[8:11]
    v_mfma_f32_16x16x32_bf16 v[16:19], v[148:151], a[164:167], v[16:19]
    v_mfma_f32_16x16x32_bf16 v[24:27], v[148:151], a[172:175], v[24:27]
    v_mfma_f32_16x16x32_bf16 v[4:7], a[36:39], v[180:183], v[4:7]
    v_mfma_f32_16x16x32_bf16 v[12:15], a[44:47], v[180:183], v[12:15]
    v_mfma_f32_16x16x32_bf16 v[20:23], v[180:183], a[164:167], v[20:23]
    v_mfma_f32_16x16x32_bf16 v[28:31], v[180:183], a[172:175], v[28:31]
    v_mfma_f32_16x16x32_bf16 v[0:3], a[48:51], v[152:155], v[0:3]
    v_mfma_f32_16x16x32_bf16 v[8:11], a[56:59], v[152:155], v[8:11]
    v_mfma_f32_16x16x32_bf16 v[16:19], v[152:155], a[176:179], v[16:19]
    v_mfma_f32_16x16x32_bf16 v[24:27], v[152:155], a[184:187], v[24:27]
    v_mfma_f32_16x16x32_bf16 v[4:7], a[48:51], v[184:187], v[4:7]
    v_mfma_f32_16x16x32_bf16 v[12:15], a[56:59], v[184:187], v[12:15]
    v_mfma_f32_16x16x32_bf16 v[20:23], v[184:187], a[176:179], v[20:23]
    v_mfma_f32_16x16x32_bf16 v[28:31], v[184:187], a[184:187], v[28:31]
    v_mfma_f32_16x16x32_bf16 v[0:3], a[52:55], v[156:159], v[0:3]
    v_mfma_f32_16x16x32_bf16 v[8:11], a[60:63], v[156:159], v[8:11]
    v_mfma_f32_16x16x32_bf16 v[16:19], v[156:159], a[180:183], v[16:19]
    v_mfma_f32_16x16x32_bf16 v[24:27], v[156:159], a[188:191], v[24:27]
    v_mfma_f32_16x16x32_bf16 v[4:7], a[52:55], v[188:191], v[4:7]
    v_mfma_f32_16x16x32_bf16 v[12:15], a[60:63], v[188:191], v[12:15]
    v_mfma_f32_16x16x32_bf16 v[20:23], v[188:191], a[180:183], v[20:23]
    v_mfma_f32_16x16x32_bf16 v[28:31], v[188:191], a[188:191], v[28:31]
    s_waitcnt vmcnt(16)
    s_barrier
    v_mov_b32 v114, 0
    v_mov_b32 v115, s67
    s_mov_b64 exec, 1
    buffer_store_dword v115, v114, s[40:43], s71 offen sc1
    s_mov_b64 exec, -1
    s_waitcnt vmcnt(1)
    s_cmp_eq_u32 s67, 0
    s_cbranch_scc1 L_gnp17
    s_cmp_lg_u32 s67, 5
    s_cbranch_scc1 L_gnl18
    v_min_u32 v114, 63, v125
    v_lshlrev_b32 v114, 6, v114
    s_mov_b32 s70, 0x200000
    s_nop 0
L_gal20:
    buffer_load_dword v115, v114, s[40:43], s70 offen sc1
    s_waitcnt vmcnt(0)
    v_cmp_gt_u32 vcc, 2, v115
    s_nop 0
    s_cbranch_vccz L_gall19
    s_add_u32 s60, s60, 1
    s_cmp_gt_u32 s60, 0x40000
    s_cbranch_scc1 L_exit
    s_sleep 8
    s_branch L_gal20
L_gall19:
L_gnl18:
    s_add_u32 s69, s68, 0x38000
    buffer_load_dwordx4 v[128:131], v112, s[40:43], s69 offen offset:0
    buffer_load_dwordx4 v[132:135], v112, s[40:43], s69 offen offset:1024
    buffer_load_dwordx4 v[136:139], v112, s[40:43], s69 offen offset:2048
    buffer_load_dwordx4 v[140:143], v112, s[40:43], s69 offen offset:3072
    s_add_u32 s69, s68, 0x39000
    buffer_load_dwordx4 v[144:147], v112, s[40:43], s69 offen offset:0
    buffer_load_dwordx4 v[148:151], v112, s[40:43], s69 offen offset:1024
    buffer_load_dwordx4 v[152:155], v112, s[40:43], s69 offen offset:2048
    buffer_load_dwordx4 v[156:159], v112, s[40:43], s69 offen offset:3072
    s_add_u32 s69, s68, 0x3c000
    buffer_load_dwordx4 v[160:163], v112, s[40:43], s69 offen offset:0
    buffer_load_dwordx4 v[164:167], v112, s[40:43], s69 offen offset:1024
    buffer_load_dwordx4 v[168:171], v112, s[40:43], s69 offen offset:2048
    buffer_load_dwordx4 v[172:175], v112, s[40:43], s69 offen offset:3072
    s_add_u32 s69, s68, 0x3d000
    buffer_load_dwordx4 v[176:179], v112, s[40:43], s69 offen offset:0
    buffer_load_dwordx4 v[180:183], v112, s[40:43], s69 offen offset:1024
    buffer_load_dwordx4 v[184:187], v112, s[40:43], s69 offen offset:2048
    buffer_load_dwordx4 v[188:191], v112, s[40:43], s69 offen offset:3072
L_gnp17:
    v_mfma_f32_16x16x32_bf16 v[0:3], a[64:67], v[192:195], v[0:3]
    v_mfma_f32_16x16x32_bf16 v[8:11], a[72:75], v[192:195], v[8:11]
    v_mfma_f32_16x16x32_bf16 v[16:19], v[192:195], a[192:195], v[16:19]
    v_mfma_f32_16x16x32_bf16 v[24:27], v[192:195], a[200:203], v[24:27]
    v_mfma_f32_16x16x32_bf16 v[4:7], a[64:67], v[224:227], v[4:7]
    v_mfma_f32_16x16x32_bf16 v[12:15], a[72:75], v[224:227], v[12:15]
    v_mfma_f32_16x16x32_bf16 v[20:23], v[224:227], a[192:195], v[20:23]
    v_mfma_f32_16x16x32_bf16 v[28:31], v[224:227], a[200:203], v[28:31]
    v_mfma_f32_16x16x32_bf16 v[0:3], a[68:71], v[196:199], v[0:3]
    v_mfma_f32_16x16x32_bf16 v[8:11], a[76:79], v[196:199], v[8:11]
    v_mfma_f32_16x16x32_bf16 v[16:19], v[196:199], a[196:199], v[16:19]
    v_mfma_f32_16x16x32_bf16 v[24:27], v[196:199], a[204:207], v[24:27]
    v_mfma_f32_16x16x32_bf16 v[4:7], a[68:71], v[228:231], v[4:7]
    v_mfma_f32_16x16x32_bf16 v[12:15], a[76:79], v[228:231], v[12:15]
    v_mfma_f32_16x16x32_bf16 v[20:23], v[228:231], a[196:199], v[20:23]
    v_mfma_f32_16x16x32_bf16 v[28:31], v[228:231], a[204:207], v[28:31]
    v_mfma_f32_16x16x32_bf16 v[0:3], a[80:83], v[200:203], v[0:3]
    v_mfma_f32_16x16x32_bf16 v[8:11], a[88:91], v[200:203], v[8:11]
    v_mfma_f32_16x16x32_bf16 v[16:19], v[200:203], a[208:211], v[16:19]
    v_mfma_f32_16x16x32_bf16 v[24:27], v[200:203], a[216:219], v[24:27]
    v_mfma_f32_16x16x32_bf16 v[4:7], a[80:83], v[232:235], v[4:7]
    v_mfma_f32_16x16x32_bf16 v[12:15], a[88:91], v[232:235], v[12:15]
    v_mfma_f32_16x16x32_bf16 v[20:23], v[232:235], a[208:211], v[20:23]
    v_mfma_f32_16x16x32_bf16 v[28:31], v[232:235], a[216:219], v[28:31]
    v_mfma_f32_16x16x32_bf16 v[0:3], a[84:87], v[204:207], v[0:3]
    v_mfma_f32_16x16x32_bf16 v[8:11], a[92:95], v[204:207], v[8:11]
    v_mfma_f32_16x16x32_bf16 v[16:19], v[204:207], a[212:215], v[16:19]
    v_mfma_f32_16x16x32_bf16 v[24:27], v[204:207], a[220:223], v[24:27]
    v_mfma_f32_16x16x32_bf16 v[4:7], a[84:87], v[236:239], v[4:7]
    v_mfma_f32_16x16x32_bf16 v[12:15], a[92:95], v[236:239], v[12:15]
    v_mfma_f32_16x16x32_bf16 v[20:23], v[236:239], a[212:215], v[20:23]
    v_mfma_f32_16x16x32_bf16 v[28:31], v[236:239], a[220:223], v[28:31]
    v_mfma_f32_16x16x32_bf16 v[0:3], a[96:99], v[208:211], v[0:3]
    v_mfma_f32_16x16x32_bf16 v[8:11], a[104:107], v[208:211], v[8:11]
    v_mfma_f32_16x16x32_bf16 v[16:19], v[208:211], a[224:227], v[16:19]
    v_mfma_f32_16x16x32_bf16 v[24:27], v[208:211], a[232:235], v[24:27]
    v_mfma_f32_16x16x32_bf16 v[4:7], a[96:99], v[240:243], v[4:7]
    v_mfma_f32_16x16x32_bf16 v[12:15], a[104:107], v[240:243], v[12:15]
    v_mfma_f32_16x16x32_bf16 v[20:23], v[240:243], a[224:227], v[20:23]
    v_mfma_f32_16x16x32_bf16 v[28:31], v[240:243], a[232:235], v[28:31]
    v_mfma_f32_16x16x32_bf16 v[0:3], a[100:103], v[212:215], v[0:3]
    v_mfma_f32_16x16x32_bf16 v[8:11], a[108:111], v[212:215], v[8:11]
    v_mfma_f32_16x16x32_bf16 v[16:19], v[212:215], a[228:231], v[16:19]
    v_mfma_f32_16x16x32_bf16 v[24:27], v[212:215], a[236:239], v[24:27]
    v_mfma_f32_16x16x32_bf16 v[4:7], a[100:103], v[244:247], v[4:7]
    v_mfma_f32_16x16x32_bf16 v[12:15], a[108:111], v[244:247], v[12:15]
    v_mfma_f32_16x16x32_bf16 v[20:23], v[244:247], a[228:231], v[20:23]
    v_mfma_f32_16x16x32_bf16 v[28:31], v[244:247], a[236:239], v[28:31]
    v_mfma_f32_16x16x32_bf16 v[0:3], a[112:115], v[216:219], v[0:3]
    v_mfma_f32_16x16x32_bf16 v[8:11], a[120:123], v[216:219], v[8:11]
    v_mfma_f32_16x16x32_bf16 v[16:19], v[216:219], a[240:243], v[16:19]
    v_mfma_f32_16x16x32_bf16 v[24:27], v[216:219], a[248:251], v[24:27]
    v_mfma_f32_16x16x32_bf16 v[4:7], a[112:115], v[248:251], v[4:7]
    v_mfma_f32_16x16x32_bf16 v[12:15], a[120:123], v[248:251], v[12:15]
    v_mfma_f32_16x16x32_bf16 v[20:23], v[248:251], a[240:243], v[20:23]
    v_mfma_f32_16x16x32_bf16 v[28:31], v[248:251], a[248:251], v[28:31]
    v_mfma_f32_16x16x32_bf16 v[0:3], a[116:119], v[220:223], v[0:3]
    v_mfma_f32_16x16x32_bf16 v[8:11], a[124:127], v[220:223], v[8:11]
    v_mfma_f32_16x16x32_bf16 v[16:19], v[220:223], a[244:247], v[16:19]
    v_mfma_f32_16x16x32_bf16 v[24:27], v[220:223], a[252:255], v[24:27]
    v_mfma_f32_16x16x32_bf16 v[4:7], a[116:119], v[252:255], v[4:7]
    v_mfma_f32_16x16x32_bf16 v[12:15], a[124:127], v[252:255], v[12:15]
    v_mfma_f32_16x16x32_bf16 v[20:23], v[252:255], a[244:247], v[20:23]
    v_mfma_f32_16x16x32_bf16 v[28:31], v[252:255], a[252:255], v[28:31]
    s_lshl_b32 s69, s66, 18
    s_lshl_b32 s70, s48, 13
    s_add_u32 s69, s69, s70
    s_add_u32 s70, s69, 0x1000000
    v_cvt_pk_bf16_f32 v32, v0, v8
    v_cvt_pk_bf16_f32 v33, v1, v9
    v_cvt_pk_bf16_f32 v34, v2, v10
    v_cvt_pk_bf16_f32 v35, v3, v11
    buffer_store_dwordx4 v[32:35], v113, s[40:43], s70 offen offset:0 sc1
    v_cvt_pk_bf16_f32 v36, v4, v12
    v_cvt_pk_bf16_f32 v37, v5, v13
    v_cvt_pk_bf16_f32 v38, v6, v14
    v_cvt_pk_bf16_f32 v39, v7, v15
    buffer_store_dwordx4 v[36:39], v113, s[40:43], s70 offen offset:1024 sc1
    s_add_u32 s70, s69, 0x2000000
    v_cvt_pk_bf16_f32 v40, v16, v17
    v_cvt_pk_bf16_f32 v41, v18, v19
    v_cvt_pk_bf16_f32 v42, v20, v21
    v_cvt_pk_bf16_f32 v43, v22, v23
    buffer_store_dwordx4 v[40:43], v113, s[40:43], s70 offen offset:0 sc1
    v_cvt_pk_bf16_f32 v44, v24, v25
    v_cvt_pk_bf16_f32 v45, v26, v27
    v_cvt_pk_bf16_f32 v46, v28, v29
    v_cvt_pk_bf16_f32 v47, v30, v31
    buffer_store_dwordx4 v[44:47], v113, s[40:43], s70 offen offset:1024 sc1
    s_add_u32 s67, s67, 1
    s_cmp_lg_u32 s67, 1
    s_cbranch_scc1 L_gnf21
    s_waitcnt vmcnt(0)
    s_barrier
    v_mov_b32 v114, 0
    v_mov_b32 v115, s67
    s_mov_b64 exec, 1
    buffer_store_dword v115, v114, s[40:43], s71 offen sc1
    s_mov_b64 exec, -1
    s_cmp_lg_u32 s65, 3
    s_cbranch_scc1 L_lndone22
    s_mov_b32 s78, s79
    s_mov_b32 s44, s4
    s_and_b32 s45, s5, 0xffff
    s_mov_b32 s46, 0x200000
    s_mov_b32 s47, 0x20000
    v_lshlrev_b32 v72, 4, v125
    s_lshl_b32 s69, s78, 2
    s_add_u32 s69, s69, s49
    s_lshl_b32 s69, s69, 12
    buffer_load_dwordx4 v[0:3], v72, s[44:47], s69 offen offset:0
    buffer_load_dwordx4 v[4:7], v72, s[44:47], s69 offen offset:1024
    buffer_load_dwordx4 v[8:11], v72, s[44:47], s69 offen offset:2048
    buffer_load_dwordx4 v[12:15], v72, s[44:47], s69 offen offset:3072
    s_waitcnt vmcnt(3)
    v_and_b32 v129, 0xffff0000, v0
    v_lshlrev_b32 v128, 16, v0
    v_and_b32 v131, 0xffff0000, v1
    v_lshlrev_b32 v130, 16, v1
    v_and_b32 v133, 0xffff0000, v2
    v_lshlrev_b32 v132, 16, v2
    v_and_b32 v135, 0xffff0000, v3
    v_lshlrev_b32 v134, 16, v3
    v_add_f32 v56, v128, v129
    v_add_f32 v56, v56, v130
    v_add_f32 v56, v56, v131
    v_add_f32 v56, v56, v132
    v_add_f32 v56, v56, v133
    v_add_f32 v56, v56, v134
    v_add_f32 v56, v56, v135
    s_nop 1
    v_add_f32_dpp v56, v56, v56 row_ror:8 row_mask:0xf bank_mask:0xf
    s_nop 1
    v_add_f32_dpp v56, v56, v56 row_ror:4 row_mask:0xf bank_mask:0xf
    s_nop 1
    v_add_f32_dpp v56, v56, v56 row_ror:2 row_mask:0xf bank_mask:0xf
    s_nop 1
    v_add_f32_dpp v56, v56, v56 row_ror:1 row_mask:0xf bank_mask:0xf
    v_mov_b32 v57, v56
    s_nop 1
    v_permlane16_swap_b32 v56, v57
    v_add_f32 v56, v56, v57
    v_mov_b32 v57, v56
    s_nop 1
    v_permlane32_swap_b32 v56, v57
    v_add_f32 v56, v56, v57
    v_mul_f32 v56, 0x3b000000, v56
    v_sub_f32 v58, v128, v56
    v_mul_f32 v59, v58, v58
    v_sub_f32 v58, v129, v56
    v_fmac_f32 v59, v58, v58
    v_sub_f32 v58, v130, v56
    v_fmac_f32 v59, v58, v58
    v_sub_f32 v58, v131, v56
    v_fmac_f32 v59, v58, v58
    v_sub_f32 v58, v132, v56
    v_fmac_f32 v59, v58, v58
    v_sub_f32 v58, v133, v56
    v_fmac_f32 v59, v58, v58
    v_sub_f32 v58, v134, v56
    v_fmac_f32 v59, v58, v58
    v_sub_f32 v58, v135, v56
    v_fmac_f32 v59, v58, v58
    s_nop 1
    v_add_f32_dpp v59, v59, v59 row_ror:8 row_mask:0xf bank_mask:0xf
    s_nop 1
    v_add_f32_dpp v59, v59, v59 row_ror:4 row_mask:0xf bank_mask:0xf
    s_nop 1
    v_add_f32_dpp v59, v59, v59 row_ror:2 row_mask:0xf bank_mask:0xf
    s_nop 1
    v_add_f32_dpp v59, v59, v59 row_ror:1 row_mask:0xf bank_mask:0xf
    v_mov_b32 v57, v59
    s_nop 1
    v_permlane16_swap_b32 v59, v57
    v_add_f32 v59, v59, v57
    v_mov_b32 v57, v59
    s_nop 1
    v_permlane32_swap_b32 v59, v57
    v_add_f32 v59, v59, v57
    v_mul_f32 v59, 0x3b000000, v59
    v_cvt_pk_bf16_f32 v57, v56, v59
    v_lshlrev_b32 v56, 16, v57
    v_and_b32 v59, 0xffff0000, v57
    v_add_f32 v59, 0x3727c5ac, v59
    v_cvt_pk_bf16_f32 v57, v59, v59
    v_lshlrev_b32 v59, 16, v57
    v_sqrt_f32 v59, v59
    s_nop 0
    v_cvt_pk_bf16_f32 v57, v59, v59
    v_lshlrev_b32 v59, 16, v57
    v_rcp_f32 v59, v59
    v_sub_f32 v128, v128, v56
    v_sub_f32 v129, v129, v56
    v_sub_f32 v130, v130, v56
    v_sub_f32 v131, v131, v56
    v_sub_f32 v132, v132, v56
    v_sub_f32 v133, v133, v56
    v_sub_f32 v134, v134, v56
    v_sub_f32 v135, v135, v56
    v_cvt_pk_bf16_f32 v57, v128, v129
    v_lshlrev_b32 v128, 16, v57
    v_and_b32 v129, 0xffff0000, v57
    v_cvt_pk_bf16_f32 v57, v130, v131
    v_lshlrev_b32 v130, 16, v57
    v_and_b32 v131, 0xffff0000, v57
    v_cvt_pk_bf16_f32 v57, v132, v133
    v_lshlrev_b32 v132, 16, v57
    v_and_b32 v133, 0xffff0000, v57
    v_cvt_pk_bf16_f32 v57, v134, v135
    v_lshlrev_b32 v134, 16, v57
    v_and_b32 v135, 0xffff0000, v57
    v_mul_f32 v128, v128, v59
    v_mul_f32 v129, v129, v59
    v_mul_f32 v130, v130, v59
    v_mul_f32 v131, v131, v59
    v_mul_f32 v132, v132, v59
    v_mul_f32 v133, v133, v59
    v_mul_f32 v134, v134, v59
    v_mul_f32 v135, v135, v59
    v_cvt_pk_bf16_f32 v57, v128, v129
    v_lshlrev_b32 v128, 16, v57
    v_and_b32 v129, 0xffff0000, v57
    v_cvt_pk_bf16_f32 v57, v130, v131
    v_lshlrev_b32 v130, 16, v57
    v_and_b32 v131, 0xffff0000, v57
    v_cvt_pk_bf16_f32 v57, v132, v133
    v_lshlrev_b32 v132, 16, v57
    v_and_b32 v133, 0xffff0000, v57
    v_cvt_pk_bf16_f32 v57, v134, v135
    v_lshlrev_b32 v134, 16, v57
    v_and_b32 v135, 0xffff0000, v57
    s_waitcnt vmcnt(2)
    v_and_b32 v137, 0xffff0000, v4
    v_lshlrev_b32 v136, 16, v4
    v_and_b32 v139, 0xffff0000, v5
    v_lshlrev_b32 v138, 16, v5
    v_and_b32 v141, 0xffff0000, v6
    v_lshlrev_b32 v140, 16, v6
    v_and_b32 v143, 0xffff0000, v7
    v_lshlrev_b32 v142, 16, v7
    v_add_f32 v56, v136, v137
    v_add_f32 v56, v56, v138
    v_add_f32 v56, v56, v139
    v_add_f32 v56, v56, v140
    v_add_f32 v56, v56, v141
    v_add_f32 v56, v56, v142
    v_add_f32 v56, v56, v143
    s_nop 1
    v_add_f32_dpp v56, v56, v56 row_ror:8 row_mask:0xf bank_mask:0xf
    s_nop 1
    v_add_f32_dpp v56, v56, v56 row_ror:4 row_mask:0xf bank_mask:0xf
    s_nop 1
    v_add_f32_dpp v56, v56, v56 row_ror:2 row_mask:0xf bank_mask:0xf
    s_nop 1
    v_add_f32_dpp v56, v56, v56 row_ror:1 row_mask:0xf bank_mask:0xf
    v_mov_b32 v57, v56
    s_nop 1
    v_permlane16_swap_b32 v56, v57
    v_add_f32 v56, v56, v57
    v_mov_b32 v57, v56
    s_nop 1
    v_permlane32_swap_b32 v56, v57
    v_add_f32 v56, v56, v57
    v_mul_f32 v56, 0x3b000000, v56
    v_sub_f32 v58, v136, v56
    v_mul_f32 v59, v58, v58
    v_sub_f32 v58, v137, v56
    v_fmac_f32 v59, v58, v58
    v_sub_f32 v58, v138, v56
    v_fmac_f32 v59, v58, v58
    v_sub_f32 v58, v139, v56
    v_fmac_f32 v59, v58, v58
    v_sub_f32 v58, v140, v56
    v_fmac_f32 v59, v58, v58
    v_sub_f32 v58, v141, v56
    v_fmac_f32 v59, v58, v58
    v_sub_f32 v58, v142, v56
    v_fmac_f32 v59, v58, v58
    v_sub_f32 v58, v143, v56
    v_fmac_f32 v59, v58, v58
    s_nop 1
    v_add_f32_dpp v59, v59, v59 row_ror:8 row_mask:0xf bank_mask:0xf
    s_nop 1
    v_add_f32_dpp v59, v59, v59 row_ror:4 row_mask:0xf bank_mask:0xf
    s_nop 1
    v_add_f32_dpp v59, v59, v59 row_ror:2 row_mask:0xf bank_mask:0xf
    s_nop 1
    v_add_f32_dpp v59, v59, v59 row_ror:1 row_mask:0xf bank_mask:0xf
    v_mov_b32 v57, v59
    s_nop 1
    v_permlane16_swap_b32 v59, v57
    v_add_f32 v59, v59, v57
    v_mov_b32 v57, v59
    s_nop 1
    v_permlane32_swap_b32 v59, v57
    v_add_f32 v59, v59, v57
    v_mul_f32 v59, 0x3b000000, v59
    v_cvt_pk_bf16_f32 v57, v56, v59
    v_lshlrev_b32 v56, 16, v57
    v_and_b32 v59, 0xffff0000, v57
    v_add_f32 v59, 0x3727c5ac, v59
    v_cvt_pk_bf16_f32 v57, v59, v59
    v_lshlrev_b32 v59, 16, v57
    v_sqrt_f32 v59, v59
    s_nop 0
    v_cvt_pk_bf16_f32 v57, v59, v59
    v_lshlrev_b32 v59, 16, v57
    v_rcp_f32 v59, v59
    v_sub_f32 v136, v136, v56
    v_sub_f32 v137, v137, v56
    v_sub_f32 v138, v138, v56
    v_sub_f32 v139, v139, v56
    v_sub_f32 v140, v140, v56
    v_sub_f32 v141, v141, v56
    v_sub_f32 v142, v142, v56
    v_sub_f32 v143, v143, v56
    v_cvt_pk_bf16_f32 v57, v136, v137
    v_lshlrev_b32 v136, 16, v57
    v_and_b32 v137, 0xffff0000, v57
    v_cvt_pk_bf16_f32 v57, v138, v139
    v_lshlrev_b32 v138, 16, v57
    v_and_b32 v139, 0xffff0000, v57
    v_cvt_pk_bf16_f32 v57, v140, v141
    v_lshlrev_b32 v140, 16, v57
    v_and_b32 v141, 0xffff0000, v57
    v_cvt_pk_bf16_f32 v57, v142, v143
    v_lshlrev_b32 v142, 16, v57
    v_and_b32 v143, 0xffff0000, v57
    v_mul_f32 v136, v136, v59
    v_mul_f32 v137, v137, v59
    v_mul_f32 v138, v138, v59
    v_mul_f32 v139, v139, v59
    v_mul_f32 v140, v140, v59
    v_mul_f32 v141, v141, v59
    v_mul_f32 v142, v142, v59
    v_mul_f32 v143, v143, v59
    v_cvt_pk_bf16_f32 v57, v136, v137
    v_lshlrev_b32 v136, 16, v57
    v_and_b32 v137, 0xffff0000, v57
    v_cvt_pk_bf16_f32 v57, v138, v139
    v_lshlrev_b32 v138, 16, v57
    v_and_b32 v139, 0xffff0000, v57
    v_cvt_pk_bf16_f32 v57, v140, v141
    v_lshlrev_b32 v140, 16, v57
    v_and_b32 v141, 0xffff0000, v57
    v_cvt_pk_bf16_f32 v57, v142, v143
    v_lshlrev_b32 v142, 16, v57
    v_and_b32 v143, 0xffff0000, v57
    s_waitcnt vmcnt(1)
    v_and_b32 v145, 0xffff0000, v8
    v_lshlrev_b32 v144, 16, v8
    v_and_b32 v147, 0xffff0000, v9
    v_lshlrev_b32 v146, 16, v9
    v_and_b32 v149, 0xffff0000, v10
    v_lshlrev_b32 v148, 16, v10
    v_and_b32 v151, 0xffff0000, v11
    v_lshlrev_b32 v150, 16, v11
    v_add_f32 v56, v144, v145
    v_add_f32 v56, v56, v146
    v_add_f32 v56, v56, v147
    v_add_f32 v56, v56, v148
    v_add_f32 v56, v56, v149
    v_add_f32 v56, v56, v150
    v_add_f32 v56, v56, v151
    s_nop 1
    v_add_f32_dpp v56, v56, v56 row_ror:8 row_mask:0xf bank_mask:0xf
    s_nop 1
    v_add_f32_dpp v56, v56, v56 row_ror:4 row_mask:0xf bank_mask:0xf
    s_nop 1
    v_add_f32_dpp v56, v56, v56 row_ror:2 row_mask:0xf bank_mask:0xf
    s_nop 1
    v_add_f32_dpp v56, v56, v56 row_ror:1 row_mask:0xf bank_mask:0xf
    v_mov_b32 v57, v56
    s_nop 1
    v_permlane16_swap_b32 v56, v57
    v_add_f32 v56, v56, v57
    v_mov_b32 v57, v56
    s_nop 1
    v_permlane32_swap_b32 v56, v57
    v_add_f32 v56, v56, v57
    v_mul_f32 v56, 0x3b000000, v56
    v_sub_f32 v58, v144, v56
    v_mul_f32 v59, v58, v58
    v_sub_f32 v58, v145, v56
    v_fmac_f32 v59, v58, v58
    v_sub_f32 v58, v146, v56
    v_fmac_f32 v59, v58, v58
    v_sub_f32 v58, v147, v56
    v_fmac_f32 v59, v58, v58
    v_sub_f32 v58, v148, v56
    v_fmac_f32 v59, v58, v58
    v_sub_f32 v58, v149, v56
    v_fmac_f32 v59, v58, v58
    v_sub_f32 v58, v150, v56
    v_fmac_f32 v59, v58, v58
    v_sub_f32 v58, v151, v56
    v_fmac_f32 v59, v58, v58
    s_nop 1
    v_add_f32_dpp v59, v59, v59 row_ror:8 row_mask:0xf bank_mask:0xf
    s_nop 1
    v_add_f32_dpp v59, v59, v59 row_ror:4 row_mask:0xf bank_mask:0xf
    s_nop 1
    v_add_f32_dpp v59, v59, v59 row_ror:2 row_mask:0xf bank_mask:0xf
    s_nop 1
    v_add_f32_dpp v59, v59, v59 row_ror:1 row_mask:0xf bank_mask:0xf
    v_mov_b32 v57, v59
    s_nop 1
    v_permlane16_swap_b32 v59, v57
    v_add_f32 v59, v59, v57
    v_mov_b32 v57, v59
    s_nop 1
    v_permlane32_swap_b32 v59, v57
    v_add_f32 v59, v59, v57
    v_mul_f32 v59, 0x3b000000, v59
    v_cvt_pk_bf16_f32 v57, v56, v59
    v_lshlrev_b32 v56, 16, v57
    v_and_b32 v59, 0xffff0000, v57
    v_add_f32 v59, 0x3727c5ac, v59
    v_cvt_pk_bf16_f32 v57, v59, v59
    v_lshlrev_b32 v59, 16, v57
    v_sqrt_f32 v59, v59
    s_nop 0
    v_cvt_pk_bf16_f32 v57, v59, v59
    v_lshlrev_b32 v59, 16, v57
    v_rcp_f32 v59, v59
    v_sub_f32 v144, v144, v56
    v_sub_f32 v145, v145, v56
    v_sub_f32 v146, v146, v56
    v_sub_f32 v147, v147, v56
    v_sub_f32 v148, v148, v56
    v_sub_f32 v149, v149, v56
    v_sub_f32 v150, v150, v56
    v_sub_f32 v151, v151, v56
    v_cvt_pk_bf16_f32 v57, v144, v145
    v_lshlrev_b32 v144, 16, v57
    v_and_b32 v145, 0xffff0000, v57
    v_cvt_pk_bf16_f32 v57, v146, v147
    v_lshlrev_b32 v146, 16, v57
    v_and_b32 v147, 0xffff0000, v57
    v_cvt_pk_bf16_f32 v57, v148, v149
    v_lshlrev_b32 v148, 16, v57
    v_and_b32 v149, 0xffff0000, v57
    v_cvt_pk_bf16_f32 v57, v150, v151
    v_lshlrev_b32 v150, 16, v57
    v_and_b32 v151, 0xffff0000, v57
    v_mul_f32 v144, v144, v59
    v_mul_f32 v145, v145, v59
    v_mul_f32 v146, v146, v59
    v_mul_f32 v147, v147, v59
    v_mul_f32 v148, v148, v59
    v_mul_f32 v149, v149, v59
    v_mul_f32 v150, v150, v59
    v_mul_f32 v151, v151, v59
    v_cvt_pk_bf16_f32 v57, v144, v145
    v_lshlrev_b32 v144, 16, v57
    v_and_b32 v145, 0xffff0000, v57
    v_cvt_pk_bf16_f32 v57, v146, v147
    v_lshlrev_b32 v146, 16, v57
    v_and_b32 v147, 0xffff0000, v57
    v_cvt_pk_bf16_f32 v57, v148, v149
    v_lshlrev_b32 v148, 16, v57
    v_and_b32 v149, 0xffff0000, v57
    v_cvt_pk_bf16_f32 v57, v150, v151
    v_lshlrev_b32 v150, 16, v57
    v_and_b32 v151, 0xffff0000, v57
    s_waitcnt vmcnt(0)
    v_and_b32 v153, 0xffff0000, v12
    v_lshlrev_b32 v152, 16, v12
    v_and_b32 v155, 0xffff0000, v13
    v_lshlrev_b32 v154, 16, v13
    v_and_b32 v157, 0xffff0000, v14
    v_lshlrev_b32 v156, 16, v14
    v_and_b32 v159, 0xffff0000, v15
    v_lshlrev_b32 v158, 16, v15
    v_add_f32 v56, v152, v153
    v_add_f32 v56, v56, v154
    v_add_f32 v56, v56, v155
    v_add_f32 v56, v56, v156
    v_add_f32 v56, v56, v157
    v_add_f32 v56, v56, v158
    v_add_f32 v56, v56, v159
    s_nop 1
    v_add_f32_dpp v56, v56, v56 row_ror:8 row_mask:0xf bank_mask:0xf
    s_nop 1
    v_add_f32_dpp v56, v56, v56 row_ror:4 row_mask:0xf bank_mask:0xf
    s_nop 1
    v_add_f32_dpp v56, v56, v56 row_ror:2 row_mask:0xf bank_mask:0xf
    s_nop 1
    v_add_f32_dpp v56, v56, v56 row_ror:1 row_mask:0xf bank_mask:0xf
    v_mov_b32 v57, v56
    s_nop 1
    v_permlane16_swap_b32 v56, v57
    v_add_f32 v56, v56, v57
    v_mov_b32 v57, v56
    s_nop 1
    v_permlane32_swap_b32 v56, v57
    v_add_f32 v56, v56, v57
    v_mul_f32 v56, 0x3b000000, v56
    v_sub_f32 v58, v152, v56
    v_mul_f32 v59, v58, v58
    v_sub_f32 v58, v153, v56
    v_fmac_f32 v59, v58, v58
    v_sub_f32 v58, v154, v56
    v_fmac_f32 v59, v58, v58
    v_sub_f32 v58, v155, v56
    v_fmac_f32 v59, v58, v58
    v_sub_f32 v58, v156, v56
    v_fmac_f32 v59, v58, v58
    v_sub_f32 v58, v157, v56
    v_fmac_f32 v59, v58, v58
    v_sub_f32 v58, v158, v56
    v_fmac_f32 v59, v58, v58
    v_sub_f32 v58, v159, v56
    v_fmac_f32 v59, v58, v58
    s_nop 1
    v_add_f32_dpp v59, v59, v59 row_ror:8 row_mask:0xf bank_mask:0xf
    s_nop 1
    v_add_f32_dpp v59, v59, v59 row_ror:4 row_mask:0xf bank_mask:0xf
    s_nop 1
    v_add_f32_dpp v59, v59, v59 row_ror:2 row_mask:0xf bank_mask:0xf
    s_nop 1
    v_add_f32_dpp v59, v59, v59 row_ror:1 row_mask:0xf bank_mask:0xf
    v_mov_b32 v57, v59
    s_nop 1
    v_permlane16_swap_b32 v59, v57
    v_add_f32 v59, v59, v57
    v_mov_b32 v57, v59
    s_nop 1
    v_permlane32_swap_b32 v59, v57
    v_add_f32 v59, v59, v57
    v_mul_f32 v59, 0x3b000000, v59
    v_cvt_pk_bf16_f32 v57, v56, v59
    v_lshlrev_b32 v56, 16, v57
    v_and_b32 v59, 0xffff0000, v57
    v_add_f32 v59, 0x3727c5ac, v59
    v_cvt_pk_bf16_f32 v57, v59, v59
    v_lshlrev_b32 v59, 16, v57
    v_sqrt_f32 v59, v59
    s_nop 0
    v_cvt_pk_bf16_f32 v57, v59, v59
    v_lshlrev_b32 v59, 16, v57
    v_rcp_f32 v59, v59
    v_sub_f32 v152, v152, v56
    v_sub_f32 v153, v153, v56
    v_sub_f32 v154, v154, v56
    v_sub_f32 v155, v155, v56
    v_sub_f32 v156, v156, v56
    v_sub_f32 v157, v157, v56
    v_sub_f32 v158, v158, v56
    v_sub_f32 v159, v159, v56
    v_cvt_pk_bf16_f32 v57, v152, v153
    v_lshlrev_b32 v152, 16, v57
    v_and_b32 v153, 0xffff0000, v57
    v_cvt_pk_bf16_f32 v57, v154, v155
    v_lshlrev_b32 v154, 16, v57
    v_and_b32 v155, 0xffff0000, v57
    v_cvt_pk_bf16_f32 v57, v156, v157
    v_lshlrev_b32 v156, 16, v57
    v_and_b32 v157, 0xffff0000, v57
    v_cvt_pk_bf16_f32 v57, v158, v159
    v_lshlrev_b32 v158, 16, v57
    v_and_b32 v159, 0xffff0000, v57
    v_mul_f32 v152, v152, v59
    v_mul_f32 v153, v153, v59
    v_mul_f32 v154, v154, v59
    v_mul_f32 v155, v155, v59
    v_mul_f32 v156, v156, v59
    v_mul_f32 v157, v157, v59
    v_mul_f32 v158, v158, v59
    v_mul_f32 v159, v159, v59
    v_cvt_pk_bf16_f32 v57, v152, v153
    v_lshlrev_b32 v152, 16, v57
    v_and_b32 v153, 0xffff0000, v57
    v_cvt_pk_bf16_f32 v57, v154, v155
    v_lshlrev_b32 v154, 16, v57
    v_and_b32 v155, 0xffff0000, v57
    v_cvt_pk_bf16_f32 v57, v156, v157
    v_lshlrev_b32 v156, 16, v57
    v_and_b32 v157, 0xffff0000, v57
    v_cvt_pk_bf16_f32 v57, v158, v159
    v_lshlrev_b32 v158, 16, v57
    v_and_b32 v159, 0xffff0000, v57
    s_nop 1
L_lna23:
    v_mov_b32 v56, 16
    s_nop 1
L_fi25:
    global_load_dword v57, v56, s[34:35] sc1
    s_waitcnt vmcnt(0)
    v_readfirstlane_b32 s54, v57
    s_and_b32 s53, s54, 0xffff
    s_cmp_ge_u32 s53, 32
    s_nop 1
    s_cbranch_scc1 L_fd26
    s_add_u32 s60, s60, 1
    s_cmp_gt_u32 s60, 0x40000
    s_cbranch_scc1 L_exit
    s_sleep 2
    s_branch L_fi25
L_fd26:
    v_lshlrev_b32 v58, 5, v125
    s_nop 1
L_lm27:
    s_mov_b32 s69, 0x220000
    buffer_load_dwordx4 v[16:19], v58, s[40:43], s69 offen sc1
    buffer_load_dwordx4 v[20:23], v58, s[40:43], s69 offen offset:16 sc1
    s_mov_b32 s69, 0x220800
    buffer_load_dwordx4 v[24:27], v58, s[40:43], s69 offen sc1
    buffer_load_dwordx4 v[28:31], v58, s[40:43], s69 offen offset:16 sc1
    s_waitcnt vmcnt(0)
    v_max_u32 v56, v16, v17
    v_max3_u32 v56, v56, v18, v19
    v_max3_u32 v56, v56, v20, v21
    v_max3_u32 v56, v56, v22, v23
    v_max3_u32 v56, v56, v24, v25
    v_max3_u32 v56, v56, v26, v27
    v_max3_u32 v56, v56, v28, v29
    v_max3_u32 v56, v56, v30, v31
    v_cmp_eq_u32 vcc, -1, v56
    s_nop 0
    s_cbranch_vccz L_lmd28
    s_add_u32 s60, s60, 1
    s_cmp_gt_u32 s60, 0x40000
    s_cbranch_scc1 L_exit
    s_sleep 4
    s_branch L_lm27
L_lmd28:
    v_add_f32 v24, 1.0, v24
    v_add_f32 v25, 1.0, v25
    v_add_f32 v26, 1.0, v26
    v_add_f32 v27, 1.0, v27
    v_add_f32 v28, 1.0, v28
    v_add_f32 v29, 1.0, v29
    v_add_f32 v30, 1.0, v30
    v_add_f32 v31, 1.0, v31
    v_cvt_pk_bf16_f32 v57, v24, v25
    v_lshlrev_b32 v24, 16, v57
    v_and_b32 v25, 0xffff0000, v57
    v_cvt_pk_bf16_f32 v57, v26, v27
    v_lshlrev_b32 v26, 16, v57
    v_and_b32 v27, 0xffff0000, v57
    v_cvt_pk_bf16_f32 v57, v28, v29
    v_lshlrev_b32 v28, 16, v57
    v_and_b32 v29, 0xffff0000, v57
    v_cvt_pk_bf16_f32 v57, v30, v31
    v_lshlrev_b32 v30, 16, v57
    v_and_b32 v31, 0xffff0000, v57
    v_lshlrev_b32 v76, 8, v125
    s_lshl_b32 s69, s49, 6
    v_add_u32 v76, s69, v76
    v_mul_f32 v128, v128, v24
    v_mul_f32 v129, v129, v25
    v_mul_f32 v130, v130, v26
    v_mul_f32 v131, v131, v27
    v_mul_f32 v132, v132, v28
    v_mul_f32 v133, v133, v29
    v_mul_f32 v134, v134, v30
    v_mul_f32 v135, v135, v31
    v_cvt_pk_bf16_f32 v56, v128, v129
    v_lshlrev_b32 v128, 16, v56
    v_and_b32 v129, 0xffff0000, v56
    v_cvt_pk_bf16_f32 v56, v130, v131
    v_lshlrev_b32 v130, 16, v56
    v_and_b32 v131, 0xffff0000, v56
    v_cvt_pk_bf16_f32 v56, v132, v133
    v_lshlrev_b32 v132, 16, v56
    v_and_b32 v133, 0xffff0000, v56
    v_cvt_pk_bf16_f32 v56, v134, v135
    v_lshlrev_b32 v134, 16, v56
    v_and_b32 v135, 0xffff0000, v56
    v_add_f32 v128, v128, v16
    v_add_f32 v129, v129, v17
    v_add_f32 v130, v130, v18
    v_add_f32 v131, v131, v19
    v_add_f32 v132, v132, v20
    v_add_f32 v133, v133, v21
    v_add_f32 v134, v134, v22
    v_add_f32 v135, v135, v23
    v_cvt_pk_bf16_f32 v60, v128, v129
    v_cvt_pk_bf16_f32 v61, v130, v131
    v_cvt_pk_bf16_f32 v62, v132, v133
    v_cvt_pk_bf16_f32 v63, v134, v135
    ds_write_b128 v76, v[60:63] offset:0
    v_mul_f32 v136, v136, v24
    v_mul_f32 v137, v137, v25
    v_mul_f32 v138, v138, v26
    v_mul_f32 v139, v139, v27
    v_mul_f32 v140, v140, v28
    v_mul_f32 v141, v141, v29
    v_mul_f32 v142, v142, v30
    v_mul_f32 v143, v143, v31
    v_cvt_pk_bf16_f32 v56, v136, v137
    v_lshlrev_b32 v136, 16, v56
    v_and_b32 v137, 0xffff0000, v56
    v_cvt_pk_bf16_f32 v56, v138, v139
    v_lshlrev_b32 v138, 16, v56
    v_and_b32 v139, 0xffff0000, v56
    v_cvt_pk_bf16_f32 v56, v140, v141
    v_lshlrev_b32 v140, 16, v56
    v_and_b32 v141, 0xffff0000, v56
    v_cvt_pk_bf16_f32 v56, v142, v143
    v_lshlrev_b32 v142, 16, v56
    v_and_b32 v143, 0xffff0000, v56
    v_add_f32 v136, v136, v16
    v_add_f32 v137, v137, v17
    v_add_f32 v138, v138, v18
    v_add_f32 v139, v139, v19
    v_add_f32 v140, v140, v20
    v_add_f32 v141, v141, v21
    v_add_f32 v142, v142, v22
    v_add_f32 v143, v143, v23
    v_cvt_pk_bf16_f32 v64, v136, v137
    v_cvt_pk_bf16_f32 v65, v138, v139
    v_cvt_pk_bf16_f32 v66, v140, v141
    v_cvt_pk_bf16_f32 v67, v142, v143
    ds_write_b128 v76, v[64:67] offset:16
    v_mul_f32 v144, v144, v24
    v_mul_f32 v145, v145, v25
    v_mul_f32 v146, v146, v26
    v_mul_f32 v147, v147, v27
    v_mul_f32 v148, v148, v28
    v_mul_f32 v149, v149, v29
    v_mul_f32 v150, v150, v30
    v_mul_f32 v151, v151, v31
    v_cvt_pk_bf16_f32 v56, v144, v145
    v_lshlrev_b32 v144, 16, v56
    v_and_b32 v145, 0xffff0000, v56
    v_cvt_pk_bf16_f32 v56, v146, v147
    v_lshlrev_b32 v146, 16, v56
    v_and_b32 v147, 0xffff0000, v56
    v_cvt_pk_bf16_f32 v56, v148, v149
    v_lshlrev_b32 v148, 16, v56
    v_and_b32 v149, 0xffff0000, v56
    v_cvt_pk_bf16_f32 v56, v150, v151
    v_lshlrev_b32 v150, 16, v56
    v_and_b32 v151, 0xffff0000, v56
    v_add_f32 v144, v144, v16
    v_add_f32 v145, v145, v17
    v_add_f32 v146, v146, v18
    v_add_f32 v147, v147, v19
    v_add_f32 v148, v148, v20
    v_add_f32 v149, v149, v21
    v_add_f32 v150, v150, v22
    v_add_f32 v151, v151, v23
    v_cvt_pk_bf16_f32 v68, v144, v145
    v_cvt_pk_bf16_f32 v69, v146, v147
    v_cvt_pk_bf16_f32 v70, v148, v149
    v_cvt_pk_bf16_f32 v71, v150, v151
    ds_write_b128 v76, v[68:71] offset:32
    v_mul_f32 v152, v152, v24
    v_mul_f32 v153, v153, v25
    v_mul_f32 v154, v154, v26
    v_mul_f32 v155, v155, v27
    v_mul_f32 v156, v156, v28
    v_mul_f32 v157, v157, v29
    v_mul_f32 v158, v158, v30
    v_mul_f32 v159, v159, v31
    v_cvt_pk_bf16_f32 v56, v152, v153
    v_lshlrev_b32 v152, 16, v56
    v_and_b32 v153, 0xffff0000, v56
    v_cvt_pk_bf16_f32 v56, v154, v155
    v_lshlrev_b32 v154, 16, v56
    v_and_b32 v155, 0xffff0000, v56
    v_cvt_pk_bf16_f32 v56, v156, v157
    v_lshlrev_b32 v156, 16, v56
    v_and_b32 v157, 0xffff0000, v56
    v_cvt_pk_bf16_f32 v56, v158, v159
    v_lshlrev_b32 v158, 16, v56
    v_and_b32 v159, 0xffff0000, v56
    v_add_f32 v152, v152, v16
    v_add_f32 v153, v153, v17
    v_add_f32 v154, v154, v18
    v_add_f32 v155, v155, v19
    v_add_f32 v156, v156, v20
    v_add_f32 v157, v157, v21
    v_add_f32 v158, v158, v22
    v_add_f32 v159, v159, v23
    v_cvt_pk_bf16_f32 v72, v152, v153
    v_cvt_pk_bf16_f32 v73, v154, v155
    v_cvt_pk_bf16_f32 v74, v156, v157
    v_cvt_pk_bf16_f32 v75, v158, v159
    ds_write_b128 v76, v[72:75] offset:48
    s_waitcnt lgkmcnt(0)
    s_barrier
    v_lshlrev_b32 v72, 4, v125
    s_lshl_b32 s69, s49, 12
    v_add_u32 v77, s69, v72
    ds_read_b128 v[0:3], v77 offset:0
    ds_read_b128 v[4:7], v77 offset:1024
    ds_read_b128 v[8:11], v77 offset:2048
    ds_read_b128 v[12:15], v77 offset:3072
    s_lshl_b32 s69, s78, 14
    s_add_u32 s69, s69, 0x400000
    s_waitcnt lgkmcnt(3)
    buffer_store_dwordx4 v[0:3], v77, s[40:43], s69 offen offset:0 sc1
    s_waitcnt lgkmcnt(2)
    buffer_store_dwordx4 v[4:7], v77, s[40:43], s69 offen offset:1024 sc1
    s_waitcnt lgkmcnt(1)
    buffer_store_dwordx4 v[8:11], v77, s[40:43], s69 offen offset:2048 sc1
    s_waitcnt lgkmcnt(0)
    buffer_store_dwordx4 v[12:15], v77, s[40:43], s69 offen offset:3072 sc1
    s_waitcnt vmcnt(0)
    s_barrier
    s_cmp_lg_u32 s49, 0
    s_cbranch_scc1 L_lnb24
    s_lshr_b32 s69, s78, 1
    s_lshl_b32 s69, s69, 6
    s_add_u32 s69, s69, 0x200000
    v_mov_b32 v56, 0
    v_mov_b32 v57, 1
    s_mov_b64 exec, 1
    buffer_atomic_add v57, v56, s[40:43], s69 offen
    s_mov_b64 exec, -1
L_lnb24:
L_lndone22:
    v_min_u32 v114, 47, v125
    v_lshlrev_b32 v114, 6, v114
    s_mov_b32 s70, 0x200000
    s_nop 0
L_gal30:
    buffer_load_dword v115, v114, s[40:43], s70 offen sc1
    s_waitcnt vmcnt(0)
    v_cmp_gt_u32 vcc, 2, v115
    s_nop 0
    s_cbranch_vccz L_gall29
    s_add_u32 s60, s60, 1
    s_cmp_gt_u32 s60, 0x40000
    s_cbranch_scc1 L_exit
    s_sleep 8
    s_branch L_gal30
L_gall29:
    s_add_u32 s69, s68, 0x38000
    buffer_load_dwordx4 v[128:131], v112, s[40:43], s69 offen offset:0
    buffer_load_dwordx4 v[132:135], v112, s[40:43], s69 offen offset:1024
    buffer_load_dwordx4 v[136:139], v112, s[40:43], s69 offen offset:2048
    buffer_load_dwordx4 v[140:143], v112, s[40:43], s69 offen offset:3072
    s_add_u32 s69, s68, 0x39000
    buffer_load_dwordx4 v[144:147], v112, s[40:43], s69 offen offset:0
    buffer_load_dwordx4 v[148:151], v112, s[40:43], s69 offen offset:1024
    buffer_load_dwordx4 v[152:155], v112, s[40:43], s69 offen offset:2048
    buffer_load_dwordx4 v[156:159], v112, s[40:43], s69 offen offset:3072
    s_add_u32 s69, s68, 0x3c000
    buffer_load_dwordx4 v[160:163], v112, s[40:43], s69 offen offset:0
    buffer_load_dwordx4 v[164:167], v112, s[40:43], s69 offen offset:1024
    buffer_load_dwordx4 v[168:171], v112, s[40:43], s69 offen offset:2048
    buffer_load_dwordx4 v[172:175], v112, s[40:43], s69 offen offset:3072
    s_add_u32 s69, s68, 0x3d000
    buffer_load_dwordx4 v[176:179], v112, s[40:43], s69 offen offset:0
    buffer_load_dwordx4 v[180:183], v112, s[40:43], s69 offen offset:1024
    buffer_load_dwordx4 v[184:187], v112, s[40:43], s69 offen offset:2048
    buffer_load_dwordx4 v[188:191], v112, s[40:43], s69 offen offset:3072
    s_waitcnt vmcnt(0)
L_gnf21:
    s_add_u32 s66, s66, 7
    s_add_u32 s68, s68, 0x38000
    s_cmp_lt_u32 s66, 64
    s_cbranch_scc1 L_gtop16
    s_waitcnt vmcnt(0)
    s_barrier
    v_mov_b32 v114, 0
    v_mov_b32 v115, s67
    s_mov_b64 exec, 1
    buffer_store_dword v115, v114, s[40:43], s71 offen sc1
    s_mov_b64 exec, -1
    v_lshrrev_b32 v101, 4, v125
    v_lshlrev_b32 v100, 13, v101
    v_lshlrev_b32 v102, 11, v101
    v_and_b32 v101, 15, v125
    v_lshl_add_u32 v100, v101, 4, v100
    v_lshl_add_u32 v102, v101, 2, v102
    s_lshl_b32 s53, s48, 8
    s_lshl_b32 s54, s49, 17
    s_add_u32 s53, s53, s54
    v_add_u32 v100, s53, v100
    s_lshl_b32 s53, s49, 6
    v_add_u32 v102, s53, v102
    s_lshl_b32 s55, s49, 12
    s_waitcnt vmcnt(0) lgkmcnt(0)
    s_barrier
    s_mov_b32 s44, s8
    s_and_b32 s45, s9, 0xffff
    s_mov_b32 s46, 0x400000
    s_mov_b32 s47, 0x20000
    s_add_u32 m0, s55, 0
    s_mov_b32 s54, 0x0
    buffer_load_dwordx4 v100, s[44:47], s54 offen lds
    s_add_u32 m0, s55, 1024
    s_mov_b32 s54, 0x8000
    buffer_load_dwordx4 v100, s[44:47], s54 offen lds
    s_add_u32 m0, s55, 2048
    s_mov_b32 s54, 0x10000
    buffer_load_dwordx4 v100, s[44:47], s54 offen lds
    s_add_u32 m0, s55, 3072
    s_mov_b32 s54, 0x18000
    buffer_load_dwordx4 v100, s[44:47], s54 offen lds
    s_add_u32 m0, s55, 16384
    s_mov_b32 s54, 0x80000
    buffer_load_dwordx4 v100, s[44:47], s54 offen lds
    s_add_u32 m0, s55, 17408
    s_mov_b32 s54, 0x88000
    buffer_load_dwordx4 v100, s[44:47], s54 offen lds
    s_add_u32 m0, s55, 18432
    s_mov_b32 s54, 0x90000
    buffer_load_dwordx4 v100, s[44:47], s54 offen lds
    s_add_u32 m0, s55, 19456
    s_mov_b32 s54, 0x98000
    buffer_load_dwordx4 v100, s[44:47], s54 offen lds
    s_add_u32 m0, s55, 32768
    s_mov_b32 s54, 0x100000
    buffer_load_dwordx4 v100, s[44:47], s54 offen lds
    s_add_u32 m0, s55, 33792
    s_mov_b32 s54, 0x108000
    buffer_load_dwordx4 v100, s[44:47], s54 offen lds
    s_add_u32 m0, s55, 34816
    s_mov_b32 s54, 0x110000
    buffer_load_dwordx4 v100, s[44:47], s54 offen lds
    s_add_u32 m0, s55, 35840
    s_mov_b32 s54, 0x118000
    buffer_load_dwordx4 v100, s[44:47], s54 offen lds
    s_add_u32 m0, s55, 49152
    s_mov_b32 s54, 0x180000
    buffer_load_dwordx4 v100, s[44:47], s54 offen lds
    s_add_u32 m0, s55, 50176
    s_mov_b32 s54, 0x188000
    buffer_load_dwordx4 v100, s[44:47], s54 offen lds
    s_add_u32 m0, s55, 51200
    s_mov_b32 s54, 0x190000
    buffer_load_dwordx4 v100, s[44:47], s54 offen lds
    s_add_u32 m0, s55, 52224
    s_mov_b32 s54, 0x198000
    buffer_load_dwordx4 v100, s[44:47], s54 offen lds
    s_add_u32 m0, s55, 65536
    s_mov_b32 s54, 0x200000
    buffer_load_dwordx4 v100, s[44:47], s54 offen lds
    s_add_u32 m0, s55, 66560
    s_mov_b32 s54, 0x208000
    buffer_load_dwordx4 v100, s[44:47], s54 offen lds
    s_add_u32 m0, s55, 67584
    s_mov_b32 s54, 0x210000
    buffer_load_dwordx4 v100, s[44:47], s54 offen lds
    s_add_u32 m0, s55, 68608
    s_mov_b32 s54, 0x218000
    buffer_load_dwordx4 v100, s[44:47], s54 offen lds
    s_add_u32 m0, s55, 81920
    s_mov_b32 s54, 0x280000
    buffer_load_dwordx4 v100, s[44:47], s54 offen lds
    s_add_u32 m0, s55, 82944
    s_mov_b32 s54, 0x288000
    buffer_load_dwordx4 v100, s[44:47], s54 offen lds
    s_add_u32 m0, s55, 83968
    s_mov_b32 s54, 0x290000
    buffer_load_dwordx4 v100, s[44:47], s54 offen lds
    s_add_u32 m0, s55, 84992
    s_mov_b32 s54, 0x298000
    buffer_load_dwordx4 v100, s[44:47], s54 offen lds
    s_add_u32 m0, s55, 98304
    s_mov_b32 s54, 0x300000
    buffer_load_dwordx4 v100, s[44:47], s54 offen lds
    s_add_u32 m0, s55, 99328
    s_mov_b32 s54, 0x308000
    buffer_load_dwordx4 v100, s[44:47], s54 offen lds
    s_add_u32 m0, s55, 100352
    s_mov_b32 s54, 0x310000
    buffer_load_dwordx4 v100, s[44:47], s54 offen lds
    s_add_u32 m0, s55, 101376
    s_mov_b32 s54, 0x318000
    buffer_load_dwordx4 v100, s[44:47], s54 offen lds
    s_add_u32 m0, s55, 114688
    s_mov_b32 s54, 0x380000
    buffer_load_dwordx4 v100, s[44:47], s54 offen lds
    s_add_u32 m0, s55, 115712
    s_mov_b32 s54, 0x388000
    buffer_load_dwordx4 v100, s[44:47], s54 offen lds
    s_add_u32 m0, s55, 116736
    s_mov_b32 s54, 0x390000
    buffer_load_dwordx4 v100, s[44:47], s54 offen lds
    s_add_u32 m0, s55, 117760
    s_mov_b32 s54, 0x398000
    buffer_load_dwordx4 v100, s[44:47], s54 offen lds
    s_waitcnt vmcnt(28) lgkmcnt(0)
    s_barrier
    v_add_u32 v101, 0, v102
    ds_read2st64_b32 v[0:1], v101 offset0:0 offset1:1
    ds_read2st64_b32 v[2:3], v101 offset0:2 offset1:3
    ds_read2st64_b32 v[4:5], v101 offset0:4 offset1:5
    ds_read2st64_b32 v[6:7], v101 offset0:6 offset1:7
    ds_read2st64_b32 v[8:9], v101 offset0:32 offset1:33
    ds_read2st64_b32 v[10:11], v101 offset0:34 offset1:35
    ds_read2st64_b32 v[12:13], v101 offset0:36 offset1:37
    ds_read2st64_b32 v[14:15], v101 offset0:38 offset1:39
    s_waitcnt lgkmcnt(7)
    v_perm_b32 v64, v1, v0, s50
    s_waitcnt lgkmcnt(6)
    v_perm_b32 v65, v3, v2, s50
    s_waitcnt lgkmcnt(5)
    v_perm_b32 v66, v5, v4, s50
    s_waitcnt lgkmcnt(4)
    v_perm_b32 v67, v7, v6, s50
    s_waitcnt lgkmcnt(3)
    v_perm_b32 v68, v9, v8, s50
    s_waitcnt lgkmcnt(2)
    v_perm_b32 v69, v11, v10, s50
    s_waitcnt lgkmcnt(1)
    v_perm_b32 v70, v13, v12, s50
    s_waitcnt lgkmcnt(0)
    v_perm_b32 v71, v15, v14, s50
    v_accvgpr_write_b32 a0, v64
    v_accvgpr_write_b32 a1, v65
    v_accvgpr_write_b32 a2, v66
    v_accvgpr_write_b32 a3, v67
    v_accvgpr_write_b32 a4, v68
    v_accvgpr_write_b32 a5, v69
    v_accvgpr_write_b32 a6, v70
    v_accvgpr_write_b32 a7, v71
    v_perm_b32 v72, v1, v0, s51
    v_perm_b32 v73, v3, v2, s51
    v_perm_b32 v74, v5, v4, s51
    v_perm_b32 v75, v7, v6, s51
    v_perm_b32 v76, v9, v8, s51
    v_perm_b32 v77, v11, v10, s51
    v_perm_b32 v78, v13, v12, s51
    v_perm_b32 v79, v15, v14, s51
    v_accvgpr_write_b32 a8, v72
    v_accvgpr_write_b32 a9, v73
    v_accvgpr_write_b32 a10, v74
    v_accvgpr_write_b32 a11, v75
    v_accvgpr_write_b32 a12, v76
    v_accvgpr_write_b32 a13, v77
    v_accvgpr_write_b32 a14, v78
    v_accvgpr_write_b32 a15, v79
    s_waitcnt vmcnt(24) lgkmcnt(0)
    s_barrier
    v_add_u32 v101, 16384, v102
    ds_read2st64_b32 v[0:1], v101 offset0:0 offset1:1
    ds_read2st64_b32 v[2:3], v101 offset0:2 offset1:3
    ds_read2st64_b32 v[4:5], v101 offset0:4 offset1:5
    ds_read2st64_b32 v[6:7], v101 offset0:6 offset1:7
    ds_read2st64_b32 v[8:9], v101 offset0:32 offset1:33
    ds_read2st64_b32 v[10:11], v101 offset0:34 offset1:35
    ds_read2st64_b32 v[12:13], v101 offset0:36 offset1:37
    ds_read2st64_b32 v[14:15], v101 offset0:38 offset1:39
    s_waitcnt lgkmcnt(7)
    v_perm_b32 v64, v1, v0, s50
    s_waitcnt lgkmcnt(6)
    v_perm_b32 v65, v3, v2, s50
    s_waitcnt lgkmcnt(5)
    v_perm_b32 v66, v5, v4, s50
    s_waitcnt lgkmcnt(4)
    v_perm_b32 v67, v7, v6, s50
    s_waitcnt lgkmcnt(3)
    v_perm_b32 v68, v9, v8, s50
    s_waitcnt lgkmcnt(2)
    v_perm_b32 v69, v11, v10, s50
    s_waitcnt lgkmcnt(1)
    v_perm_b32 v70, v13, v12, s50
    s_waitcnt lgkmcnt(0)
    v_perm_b32 v71, v15, v14, s50
    v_accvgpr_write_b32 a16, v64
    v_accvgpr_write_b32 a17, v65
    v_accvgpr_write_b32 a18, v66
    v_accvgpr_write_b32 a19, v67
    v_accvgpr_write_b32 a20, v68
    v_accvgpr_write_b32 a21, v69
    v_accvgpr_write_b32 a22, v70
    v_accvgpr_write_b32 a23, v71
    v_perm_b32 v72, v1, v0, s51
    v_perm_b32 v73, v3, v2, s51
    v_perm_b32 v74, v5, v4, s51
    v_perm_b32 v75, v7, v6, s51
    v_perm_b32 v76, v9, v8, s51
    v_perm_b32 v77, v11, v10, s51
    v_perm_b32 v78, v13, v12, s51
    v_perm_b32 v79, v15, v14, s51
    v_accvgpr_write_b32 a24, v72
    v_accvgpr_write_b32 a25, v73
    v_accvgpr_write_b32 a26, v74
    v_accvgpr_write_b32 a27, v75
    v_accvgpr_write_b32 a28, v76
    v_accvgpr_write_b32 a29, v77
    v_accvgpr_write_b32 a30, v78
    v_accvgpr_write_b32 a31, v79
    s_waitcnt vmcnt(20) lgkmcnt(0)
    s_barrier
    v_add_u32 v101, 32768, v102
    ds_read2st64_b32 v[0:1], v101 offset0:0 offset1:1
    ds_read2st64_b32 v[2:3], v101 offset0:2 offset1:3
    ds_read2st64_b32 v[4:5], v101 offset0:4 offset1:5
    ds_read2st64_b32 v[6:7], v101 offset0:6 offset1:7
    ds_read2st64_b32 v[8:9], v101 offset0:32 offset1:33
    ds_read2st64_b32 v[10:11], v101 offset0:34 offset1:35
    ds_read2st64_b32 v[12:13], v101 offset0:36 offset1:37
    ds_read2st64_b32 v[14:15], v101 offset0:38 offset1:39
    s_waitcnt lgkmcnt(7)
    v_perm_b32 v64, v1, v0, s50
    s_waitcnt lgkmcnt(6)
    v_perm_b32 v65, v3, v2, s50
    s_waitcnt lgkmcnt(5)
    v_perm_b32 v66, v5, v4, s50
    s_waitcnt lgkmcnt(4)
    v_perm_b32 v67, v7, v6, s50
    s_waitcnt lgkmcnt(3)
    v_perm_b32 v68, v9, v8, s50
    s_waitcnt lgkmcnt(2)
    v_perm_b32 v69, v11, v10, s50
    s_waitcnt lgkmcnt(1)
    v_perm_b32 v70, v13, v12, s50
    s_waitcnt lgkmcnt(0)
    v_perm_b32 v71, v15, v14, s50
    v_accvgpr_write_b32 a32, v64
    v_accvgpr_write_b32 a33, v65
    v_accvgpr_write_b32 a34, v66
    v_accvgpr_write_b32 a35, v67
    v_accvgpr_write_b32 a36, v68
    v_accvgpr_write_b32 a37, v69
    v_accvgpr_write_b32 a38, v70
    v_accvgpr_write_b32 a39, v71
    v_perm_b32 v72, v1, v0, s51
    v_perm_b32 v73, v3, v2, s51
    v_perm_b32 v74, v5, v4, s51
    v_perm_b32 v75, v7, v6, s51
    v_perm_b32 v76, v9, v8, s51
    v_perm_b32 v77, v11, v10, s51
    v_perm_b32 v78, v13, v12, s51
    v_perm_b32 v79, v15, v14, s51
    v_accvgpr_write_b32 a40, v72
    v_accvgpr_write_b32 a41, v73
    v_accvgpr_write_b32 a42, v74
    v_accvgpr_write_b32 a43, v75
    v_accvgpr_write_b32 a44, v76
    v_accvgpr_write_b32 a45, v77
    v_accvgpr_write_b32 a46, v78
    v_accvgpr_write_b32 a47, v79
    s_waitcnt vmcnt(16) lgkmcnt(0)
    s_barrier
    v_add_u32 v101, 49152, v102
    ds_read2st64_b32 v[0:1], v101 offset0:0 offset1:1
    ds_read2st64_b32 v[2:3], v101 offset0:2 offset1:3
    ds_read2st64_b32 v[4:5], v101 offset0:4 offset1:5
    ds_read2st64_b32 v[6:7], v101 offset0:6 offset1:7
    ds_read2st64_b32 v[8:9], v101 offset0:32 offset1:33
    ds_read2st64_b32 v[10:11], v101 offset0:34 offset1:35
    ds_read2st64_b32 v[12:13], v101 offset0:36 offset1:37
    ds_read2st64_b32 v[14:15], v101 offset0:38 offset1:39
    s_waitcnt lgkmcnt(7)
    v_perm_b32 v64, v1, v0, s50
    s_waitcnt lgkmcnt(6)
    v_perm_b32 v65, v3, v2, s50
    s_waitcnt lgkmcnt(5)
    v_perm_b32 v66, v5, v4, s50
    s_waitcnt lgkmcnt(4)
    v_perm_b32 v67, v7, v6, s50
    s_waitcnt lgkmcnt(3)
    v_perm_b32 v68, v9, v8, s50
    s_waitcnt lgkmcnt(2)
    v_perm_b32 v69, v11, v10, s50
    s_waitcnt lgkmcnt(1)
    v_perm_b32 v70, v13, v12, s50
    s_waitcnt lgkmcnt(0)
    v_perm_b32 v71, v15, v14, s50
    v_accvgpr_write_b32 a48, v64
    v_accvgpr_write_b32 a49, v65
    v_accvgpr_write_b32 a50, v66
    v_accvgpr_write_b32 a51, v67
    v_accvgpr_write_b32 a52, v68
    v_accvgpr_write_b32 a53, v69
    v_accvgpr_write_b32 a54, v70
    v_accvgpr_write_b32 a55, v71
    v_perm_b32 v72, v1, v0, s51
    v_perm_b32 v73, v3, v2, s51
    v_perm_b32 v74, v5, v4, s51
    v_perm_b32 v75, v7, v6, s51
    v_perm_b32 v76, v9, v8, s51
    v_perm_b32 v77, v11, v10, s51
    v_perm_b32 v78, v13, v12, s51
    v_perm_b32 v79, v15, v14, s51
    v_accvgpr_write_b32 a56, v72
    v_accvgpr_write_b32 a57, v73
    v_accvgpr_write_b32 a58, v74
    v_accvgpr_write_b32 a59, v75
    v_accvgpr_write_b32 a60, v76
    v_accvgpr_write_b32 a61, v77
    v_accvgpr_write_b32 a62, v78
    v_accvgpr_write_b32 a63, v79
    s_waitcnt vmcnt(12) lgkmcnt(0)
    s_barrier
    v_add_u32 v101, 65536, v102
    ds_read2st64_b32 v[0:1], v101 offset0:0 offset1:1
    ds_read2st64_b32 v[2:3], v101 offset0:2 offset1:3
    ds_read2st64_b32 v[4:5], v101 offset0:4 offset1:5
    ds_read2st64_b32 v[6:7], v101 offset0:6 offset1:7
    ds_read2st64_b32 v[8:9], v101 offset0:32 offset1:33
    ds_read2st64_b32 v[10:11], v101 offset0:34 offset1:35
    ds_read2st64_b32 v[12:13], v101 offset0:36 offset1:37
    ds_read2st64_b32 v[14:15], v101 offset0:38 offset1:39
    s_waitcnt lgkmcnt(7)
    v_perm_b32 v64, v1, v0, s50
    s_waitcnt lgkmcnt(6)
    v_perm_b32 v65, v3, v2, s50
    s_waitcnt lgkmcnt(5)
    v_perm_b32 v66, v5, v4, s50
    s_waitcnt lgkmcnt(4)
    v_perm_b32 v67, v7, v6, s50
    s_waitcnt lgkmcnt(3)
    v_perm_b32 v68, v9, v8, s50
    s_waitcnt lgkmcnt(2)
    v_perm_b32 v69, v11, v10, s50
    s_waitcnt lgkmcnt(1)
    v_perm_b32 v70, v13, v12, s50
    s_waitcnt lgkmcnt(0)
    v_perm_b32 v71, v15, v14, s50
    v_accvgpr_write_b32 a64, v64
    v_accvgpr_write_b32 a65, v65
    v_accvgpr_write_b32 a66, v66
    v_accvgpr_write_b32 a67, v67
    v_accvgpr_write_b32 a68, v68
    v_accvgpr_write_b32 a69, v69
    v_accvgpr_write_b32 a70, v70
    v_accvgpr_write_b32 a71, v71
    v_perm_b32 v72, v1, v0, s51
    v_perm_b32 v73, v3, v2, s51
    v_perm_b32 v74, v5, v4, s51
    v_perm_b32 v75, v7, v6, s51
    v_perm_b32 v76, v9, v8, s51
    v_perm_b32 v77, v11, v10, s51
    v_perm_b32 v78, v13, v12, s51
    v_perm_b32 v79, v15, v14, s51
    v_accvgpr_write_b32 a72, v72
    v_accvgpr_write_b32 a73, v73
    v_accvgpr_write_b32 a74, v74
    v_accvgpr_write_b32 a75, v75
    v_accvgpr_write_b32 a76, v76
    v_accvgpr_write_b32 a77, v77
    v_accvgpr_write_b32 a78, v78
    v_accvgpr_write_b32 a79, v79
    s_waitcnt vmcnt(8) lgkmcnt(0)
    s_barrier
    v_add_u32 v101, 81920, v102
    ds_read2st64_b32 v[0:1], v101 offset0:0 offset1:1
    ds_read2st64_b32 v[2:3], v101 offset0:2 offset1:3
    ds_read2st64_b32 v[4:5], v101 offset0:4 offset1:5
    ds_read2st64_b32 v[6:7], v101 offset0:6 offset1:7
    ds_read2st64_b32 v[8:9], v101 offset0:32 offset1:33
    ds_read2st64_b32 v[10:11], v101 offset0:34 offset1:35
    ds_read2st64_b32 v[12:13], v101 offset0:36 offset1:37
    ds_read2st64_b32 v[14:15], v101 offset0:38 offset1:39
    s_waitcnt lgkmcnt(7)
    v_perm_b32 v64, v1, v0, s50
    s_waitcnt lgkmcnt(6)
    v_perm_b32 v65, v3, v2, s50
    s_waitcnt lgkmcnt(5)
    v_perm_b32 v66, v5, v4, s50
    s_waitcnt lgkmcnt(4)
    v_perm_b32 v67, v7, v6, s50
    s_waitcnt lgkmcnt(3)
    v_perm_b32 v68, v9, v8, s50
    s_waitcnt lgkmcnt(2)
    v_perm_b32 v69, v11, v10, s50
    s_waitcnt lgkmcnt(1)
    v_perm_b32 v70, v13, v12, s50
    s_waitcnt lgkmcnt(0)
    v_perm_b32 v71, v15, v14, s50
    v_accvgpr_write_b32 a80, v64
    v_accvgpr_write_b32 a81, v65
    v_accvgpr_write_b32 a82, v66
    v_accvgpr_write_b32 a83, v67
    v_accvgpr_write_b32 a84, v68
    v_accvgpr_write_b32 a85, v69
    v_accvgpr_write_b32 a86, v70
    v_accvgpr_write_b32 a87, v71
    v_perm_b32 v72, v1, v0, s51
    v_perm_b32 v73, v3, v2, s51
    v_perm_b32 v74, v5, v4, s51
    v_perm_b32 v75, v7, v6, s51
    v_perm_b32 v76, v9, v8, s51
    v_perm_b32 v77, v11, v10, s51
    v_perm_b32 v78, v13, v12, s51
    v_perm_b32 v79, v15, v14, s51
    v_accvgpr_write_b32 a88, v72
    v_accvgpr_write_b32 a89, v73
    v_accvgpr_write_b32 a90, v74
    v_accvgpr_write_b32 a91, v75
    v_accvgpr_write_b32 a92, v76
    v_accvgpr_write_b32 a93, v77
    v_accvgpr_write_b32 a94, v78
    v_accvgpr_write_b32 a95, v79
    s_waitcnt vmcnt(4) lgkmcnt(0)
    s_barrier
    v_add_u32 v101, 98304, v102
    ds_read2st64_b32 v[0:1], v101 offset0:0 offset1:1
    ds_read2st64_b32 v[2:3], v101 offset0:2 offset1:3
    ds_read2st64_b32 v[4:5], v101 offset0:4 offset1:5
    ds_read2st64_b32 v[6:7], v101 offset0:6 offset1:7
    ds_read2st64_b32 v[8:9], v101 offset0:32 offset1:33
    ds_read2st64_b32 v[10:11], v101 offset0:34 offset1:35
    ds_read2st64_b32 v[12:13], v101 offset0:36 offset1:37
    ds_read2st64_b32 v[14:15], v101 offset0:38 offset1:39
    s_waitcnt lgkmcnt(7)
    v_perm_b32 v64, v1, v0, s50
    s_waitcnt lgkmcnt(6)
    v_perm_b32 v65, v3, v2, s50
    s_waitcnt lgkmcnt(5)
    v_perm_b32 v66, v5, v4, s50
    s_waitcnt lgkmcnt(4)
    v_perm_b32 v67, v7, v6, s50
    s_waitcnt lgkmcnt(3)
    v_perm_b32 v68, v9, v8, s50
    s_waitcnt lgkmcnt(2)
    v_perm_b32 v69, v11, v10, s50
    s_waitcnt lgkmcnt(1)
    v_perm_b32 v70, v13, v12, s50
    s_waitcnt lgkmcnt(0)
    v_perm_b32 v71, v15, v14, s50
    v_accvgpr_write_b32 a96, v64
    v_accvgpr_write_b32 a97, v65
    v_accvgpr_write_b32 a98, v66
    v_accvgpr_write_b32 a99, v67
    v_accvgpr_write_b32 a100, v68
    v_accvgpr_write_b32 a101, v69
    v_accvgpr_write_b32 a102, v70
    v_accvgpr_write_b32 a103, v71
    v_perm_b32 v72, v1, v0, s51
    v_perm_b32 v73, v3, v2, s51
    v_perm_b32 v74, v5, v4, s51
    v_perm_b32 v75, v7, v6, s51
    v_perm_b32 v76, v9, v8, s51
    v_perm_b32 v77, v11, v10, s51
    v_perm_b32 v78, v13, v12, s51
    v_perm_b32 v79, v15, v14, s51
    v_accvgpr_write_b32 a104, v72
    v_accvgpr_write_b32 a105, v73
    v_accvgpr_write_b32 a106, v74
    v_accvgpr_write_b32 a107, v75
    v_accvgpr_write_b32 a108, v76
    v_accvgpr_write_b32 a109, v77
    v_accvgpr_write_b32 a110, v78
    v_accvgpr_write_b32 a111, v79
    s_waitcnt vmcnt(0) lgkmcnt(0)
    s_barrier
    v_add_u32 v101, 114688, v102
    ds_read2st64_b32 v[0:1], v101 offset0:0 offset1:1
    ds_read2st64_b32 v[2:3], v101 offset0:2 offset1:3
    ds_read2st64_b32 v[4:5], v101 offset0:4 offset1:5
    ds_read2st64_b32 v[6:7], v101 offset0:6 offset1:7
    ds_read2st64_b32 v[8:9], v101 offset0:32 offset1:33
    ds_read2st64_b32 v[10:11], v101 offset0:34 offset1:35
    ds_read2st64_b32 v[12:13], v101 offset0:36 offset1:37
    ds_read2st64_b32 v[14:15], v101 offset0:38 offset1:39
    s_waitcnt lgkmcnt(7)
    v_perm_b32 v64, v1, v0, s50
    s_waitcnt lgkmcnt(6)
    v_perm_b32 v65, v3, v2, s50
    s_waitcnt lgkmcnt(5)
    v_perm_b32 v66, v5, v4, s50
    s_waitcnt lgkmcnt(4)
    v_perm_b32 v67, v7, v6, s50
    s_waitcnt lgkmcnt(3)
    v_perm_b32 v68, v9, v8, s50
    s_waitcnt lgkmcnt(2)
    v_perm_b32 v69, v11, v10, s50
    s_waitcnt lgkmcnt(1)
    v_perm_b32 v70, v13, v12, s50
    s_waitcnt lgkmcnt(0)
    v_perm_b32 v71, v15, v14, s50
    v_accvgpr_write_b32 a112, v64
    v_accvgpr_write_b32 a113, v65
    v_accvgpr_write_b32 a114, v66
    v_accvgpr_write_b32 a115, v67
    v_accvgpr_write_b32 a116, v68
    v_accvgpr_write_b32 a117, v69
    v_accvgpr_write_b32 a118, v70
    v_accvgpr_write_b32 a119, v71
    v_perm_b32 v72, v1, v0, s51
    v_perm_b32 v73, v3, v2, s51
    v_perm_b32 v74, v5, v4, s51
    v_perm_b32 v75, v7, v6, s51
    v_perm_b32 v76, v9, v8, s51
    v_perm_b32 v77, v11, v10, s51
    v_perm_b32 v78, v13, v12, s51
    v_perm_b32 v79, v15, v14, s51
    v_accvgpr_write_b32 a120, v72
    v_accvgpr_write_b32 a121, v73
    v_accvgpr_write_b32 a122, v74
    v_accvgpr_write_b32 a123, v75
    v_accvgpr_write_b32 a124, v76
    v_accvgpr_write_b32 a125, v77
    v_accvgpr_write_b32 a126, v78
    v_accvgpr_write_b32 a127, v79
    s_waitcnt vmcnt(0) lgkmcnt(0)
    s_barrier
    v_lshlrev_b32 v112, 4, v125
    s_lshl_b32 s53, s49, 11
    v_add_u32 v113, s53, v112
    s_mov_b32 s66, s65
    s_mov_b32 s67, 0
    s_lshl_b32 s71, s48, 3
    s_add_u32 s71, s71, s65
    s_lshl_b32 s71, s71, 6
    s_add_u32 s71, s71, 0x201000
    s_lshl_b32 s68, s66, 15
    s_add_u32 s68, s68, 0x400000
    s_add_u32 s69, s68, 0x0
    buffer_load_dwordx4 v[128:131], v112, s[40:43], s69 offen offset:0
    buffer_load_dwordx4 v[132:135], v112, s[40:43], s69 offen offset:1024
    buffer_load_dwordx4 v[136:139], v112, s[40:43], s69 offen offset:2048
    buffer_load_dwordx4 v[140:143], v112, s[40:43], s69 offen offset:3072
    s_add_u32 s69, s68, 0x1000
    buffer_load_dwordx4 v[144:147], v112, s[40:43], s69 offen offset:0
    buffer_load_dwordx4 v[148:151], v112, s[40:43], s69 offen offset:1024
    buffer_load_dwordx4 v[152:155], v112, s[40:43], s69 offen offset:2048
    buffer_load_dwordx4 v[156:159], v112, s[40:43], s69 offen offset:3072
    s_add_u32 s69, s68, 0x4000
    buffer_load_dwordx4 v[160:163], v112, s[40:43], s69 offen offset:0
    buffer_load_dwordx4 v[164:167], v112, s[40:43], s69 offen offset:1024
    buffer_load_dwordx4 v[168:171], v112, s[40:43], s69 offen offset:2048
    buffer_load_dwordx4 v[172:175], v112, s[40:43], s69 offen offset:3072
    s_add_u32 s69, s68, 0x5000
    buffer_load_dwordx4 v[176:179], v112, s[40:43], s69 offen offset:0
    buffer_load_dwordx4 v[180:183], v112, s[40:43], s69 offen offset:1024
    buffer_load_dwordx4 v[184:187], v112, s[40:43], s69 offen offset:2048
    buffer_load_dwordx4 v[188:191], v112, s[40:43], s69 offen offset:3072
    s_waitcnt vmcnt(0)
L_gtop31:
    s_add_u32 s69, s68, 0x2000
    buffer_load_dwordx4 v[192:195], v112, s[40:43], s69 offen offset:0
    buffer_load_dwordx4 v[196:199], v112, s[40:43], s69 offen offset:1024
    buffer_load_dwordx4 v[200:203], v112, s[40:43], s69 offen offset:2048
    buffer_load_dwordx4 v[204:207], v112, s[40:43], s69 offen offset:3072
    s_add_u32 s69, s68, 0x3000
    buffer_load_dwordx4 v[208:211], v112, s[40:43], s69 offen offset:0
    buffer_load_dwordx4 v[212:215], v112, s[40:43], s69 offen offset:1024
    buffer_load_dwordx4 v[216:219], v112, s[40:43], s69 offen offset:2048
    buffer_load_dwordx4 v[220:223], v112, s[40:43], s69 offen offset:3072
    s_add_u32 s69, s68, 0x6000
    buffer_load_dwordx4 v[224:227], v112, s[40:43], s69 offen offset:0
    buffer_load_dwordx4 v[228:231], v112, s[40:43], s69 offen offset:1024
    buffer_load_dwordx4 v[232:235], v112, s[40:43], s69 offen offset:2048
    buffer_load_dwordx4 v[236:239], v112, s[40:43], s69 offen offset:3072
    s_add_u32 s69, s68, 0x7000
    buffer_load_dwordx4 v[240:243], v112, s[40:43], s69 offen offset:0
    buffer_load_dwordx4 v[244:247], v112, s[40:43], s69 offen offset:1024
    buffer_load_dwordx4 v[248:251], v112, s[40:43], s69 offen offset:2048
    buffer_load_dwordx4 v[252:255], v112, s[40:43], s69 offen offset:3072
    s_waitcnt vmcnt(18)
    v_mfma_f32_16x16x32_bf16 v[0:3], a[0:3], v[128:131], 0
    v_mfma_f32_16x16x32_bf16 v[8:11], a[8:11], v[128:131], 0
    v_mfma_f32_16x16x32_bf16 v[4:7], a[0:3], v[160:163], 0
    v_mfma_f32_16x16x32_bf16 v[12:15], a[8:11], v[160:163], 0
    v_mfma_f32_16x16x32_bf16 v[0:3], a[4:7], v[132:135], v[0:3]
    v_mfma_f32_16x16x32_bf16 v[8:11], a[12:15], v[132:135], v[8:11]
    v_mfma_f32_16x16x32_bf16 v[4:7], a[4:7], v[164:167], v[4:7]
    v_mfma_f32_16x16x32_bf16 v[12:15], a[12:15], v[164:167], v[12:15]
    v_mfma_f32_16x16x32_bf16 v[0:3], a[16:19], v[136:139], v[0:3]
    v_mfma_f32_16x16x32_bf16 v[8:11], a[24:27], v[136:139], v[8:11]
    v_mfma_f32_16x16x32_bf16 v[4:7], a[16:19], v[168:171], v[4:7]
    v_mfma_f32_16x16x32_bf16 v[12:15], a[24:27], v[168:171], v[12:15]
    v_mfma_f32_16x16x32_bf16 v[0:3], a[20:23], v[140:143], v[0:3]
    v_mfma_f32_16x16x32_bf16 v[8:11], a[28:31], v[140:143], v[8:11]
    v_mfma_f32_16x16x32_bf16 v[4:7], a[20:23], v[172:175], v[4:7]
    v_mfma_f32_16x16x32_bf16 v[12:15], a[28:31], v[172:175], v[12:15]
    v_mfma_f32_16x16x32_bf16 v[0:3], a[32:35], v[144:147], v[0:3]
    v_mfma_f32_16x16x32_bf16 v[8:11], a[40:43], v[144:147], v[8:11]
    v_mfma_f32_16x16x32_bf16 v[4:7], a[32:35], v[176:179], v[4:7]
    v_mfma_f32_16x16x32_bf16 v[12:15], a[40:43], v[176:179], v[12:15]
    v_mfma_f32_16x16x32_bf16 v[0:3], a[36:39], v[148:151], v[0:3]
    v_mfma_f32_16x16x32_bf16 v[8:11], a[44:47], v[148:151], v[8:11]
    v_mfma_f32_16x16x32_bf16 v[4:7], a[36:39], v[180:183], v[4:7]
    v_mfma_f32_16x16x32_bf16 v[12:15], a[44:47], v[180:183], v[12:15]
    v_mfma_f32_16x16x32_bf16 v[0:3], a[48:51], v[152:155], v[0:3]
    v_mfma_f32_16x16x32_bf16 v[8:11], a[56:59], v[152:155], v[8:11]
    v_mfma_f32_16x16x32_bf16 v[4:7], a[48:51], v[184:187], v[4:7]
    v_mfma_f32_16x16x32_bf16 v[12:15], a[56:59], v[184:187], v[12:15]
    v_mfma_f32_16x16x32_bf16 v[0:3], a[52:55], v[156:159], v[0:3]
    v_mfma_f32_16x16x32_bf16 v[8:11], a[60:63], v[156:159], v[8:11]
    v_mfma_f32_16x16x32_bf16 v[4:7], a[52:55], v[188:191], v[4:7]
    v_mfma_f32_16x16x32_bf16 v[12:15], a[60:63], v[188:191], v[12:15]
    s_waitcnt vmcnt(0)
    s_add_u32 s69, s68, 0x38000
    buffer_load_dwordx4 v[128:131], v112, s[40:43], s69 offen offset:0
    buffer_load_dwordx4 v[132:135], v112, s[40:43], s69 offen offset:1024
    buffer_load_dwordx4 v[136:139], v112, s[40:43], s69 offen offset:2048
    buffer_load_dwordx4 v[140:143], v112, s[40:43], s69 offen offset:3072
    s_add_u32 s69, s68, 0x39000
    buffer_load_dwordx4 v[144:147], v112, s[40:43], s69 offen offset:0
    buffer_load_dwordx4 v[148:151], v112, s[40:43], s69 offen offset:1024
    buffer_load_dwordx4 v[152:155], v112, s[40:43], s69 offen offset:2048
    buffer_load_dwordx4 v[156:159], v112, s[40:43], s69 offen offset:3072
    s_add_u32 s69, s68, 0x3c000
    buffer_load_dwordx4 v[160:163], v112, s[40:43], s69 offen offset:0
    buffer_load_dwordx4 v[164:167], v112, s[40:43], s69 offen offset:1024
    buffer_load_dwordx4 v[168:171], v112, s[40:43], s69 offen offset:2048
    buffer_load_dwordx4 v[172:175], v112, s[40:43], s69 offen offset:3072
    s_add_u32 s69, s68, 0x3d000
    buffer_load_dwordx4 v[176:179], v112, s[40:43], s69 offen offset:0
    buffer_load_dwordx4 v[180:183], v112, s[40:43], s69 offen offset:1024
    buffer_load_dwordx4 v[184:187], v112, s[40:43], s69 offen offset:2048
    buffer_load_dwordx4 v[188:191], v112, s[40:43], s69 offen offset:3072
    v_mfma_f32_16x16x32_bf16 v[0:3], a[64:67], v[192:195], v[0:3]
    v_mfma_f32_16x16x32_bf16 v[8:11], a[72:75], v[192:195], v[8:11]
    v_mfma_f32_16x16x32_bf16 v[4:7], a[64:67], v[224:227], v[4:7]
    v_mfma_f32_16x16x32_bf16 v[12:15], a[72:75], v[224:227], v[12:15]
    v_mfma_f32_16x16x32_bf16 v[0:3], a[68:71], v[196:199], v[0:3]
    v_mfma_f32_16x16x32_bf16 v[8:11], a[76:79], v[196:199], v[8:11]
    v_mfma_f32_16x16x32_bf16 v[4:7], a[68:71], v[228:231], v[4:7]
    v_mfma_f32_16x16x32_bf16 v[12:15], a[76:79], v[228:231], v[12:15]
    v_mfma_f32_16x16x32_bf16 v[0:3], a[80:83], v[200:203], v[0:3]
    v_mfma_f32_16x16x32_bf16 v[8:11], a[88:91], v[200:203], v[8:11]
    v_mfma_f32_16x16x32_bf16 v[4:7], a[80:83], v[232:235], v[4:7]
    v_mfma_f32_16x16x32_bf16 v[12:15], a[88:91], v[232:235], v[12:15]
    v_mfma_f32_16x16x32_bf16 v[0:3], a[84:87], v[204:207], v[0:3]
    v_mfma_f32_16x16x32_bf16 v[8:11], a[92:95], v[204:207], v[8:11]
    v_mfma_f32_16x16x32_bf16 v[4:7], a[84:87], v[236:239], v[4:7]
    v_mfma_f32_16x16x32_bf16 v[12:15], a[92:95], v[236:239], v[12:15]
    v_mfma_f32_16x16x32_bf16 v[0:3], a[96:99], v[208:211], v[0:3]
    v_mfma_f32_16x16x32_bf16 v[8:11], a[104:107], v[208:211], v[8:11]
    v_mfma_f32_16x16x32_bf16 v[4:7], a[96:99], v[240:243], v[4:7]
    v_mfma_f32_16x16x32_bf16 v[12:15], a[104:107], v[240:243], v[12:15]
    v_mfma_f32_16x16x32_bf16 v[0:3], a[100:103], v[212:215], v[0:3]
    v_mfma_f32_16x16x32_bf16 v[8:11], a[108:111], v[212:215], v[8:11]
    v_mfma_f32_16x16x32_bf16 v[4:7], a[100:103], v[244:247], v[4:7]
    v_mfma_f32_16x16x32_bf16 v[12:15], a[108:111], v[244:247], v[12:15]
    v_mfma_f32_16x16x32_bf16 v[0:3], a[112:115], v[216:219], v[0:3]
    v_mfma_f32_16x16x32_bf16 v[8:11], a[120:123], v[216:219], v[8:11]
    v_mfma_f32_16x16x32_bf16 v[4:7], a[112:115], v[248:251], v[4:7]
    v_mfma_f32_16x16x32_bf16 v[12:15], a[120:123], v[248:251], v[12:15]
    v_mfma_f32_16x16x32_bf16 v[0:3], a[116:119], v[220:223], v[0:3]
    v_mfma_f32_16x16x32_bf16 v[8:11], a[124:127], v[220:223], v[8:11]
    v_mfma_f32_16x16x32_bf16 v[4:7], a[116:119], v[252:255], v[4:7]
    v_mfma_f32_16x16x32_bf16 v[12:15], a[124:127], v[252:255], v[12:15]
    s_lshl_b32 s69, s66, 18
    s_lshl_b32 s70, s48, 13
    s_add_u32 s69, s69, s70
    s_add_u32 s70, s69, 0x3000000
    s_nop 1
    v_cvt_pk_bf16_f32 v32, v0, v8
    v_cvt_pk_bf16_f32 v33, v1, v9
    v_cvt_pk_bf16_f32 v34, v2, v10
    v_cvt_pk_bf16_f32 v35, v3, v11
    buffer_store_dwordx4 v[32:35], v113, s[40:43], s70 offen offset:0 sc1
    v_cvt_pk_bf16_f32 v36, v4, v12
    v_cvt_pk_bf16_f32 v37, v5, v13
    v_cvt_pk_bf16_f32 v38, v6, v14
    v_cvt_pk_bf16_f32 v39, v7, v15
    buffer_store_dwordx4 v[36:39], v113, s[40:43], s70 offen offset:1024 sc1
    s_add_u32 s67, s67, 1
    s_add_u32 s66, s66, 7
    s_add_u32 s68, s68, 0x38000
    s_cmp_lt_u32 s66, 64
    s_cbranch_scc1 L_gtop31
    s_waitcnt vmcnt(0)
    s_mov_b32 s67, 100
    s_barrier
    v_mov_b32 v114, 0
    v_mov_b32 v115, s67
    s_mov_b64 exec, 1
    buffer_store_dword v115, v114, s[40:43], s71 offen sc1
    s_mov_b64 exec, -1
    v_lshlrev_b32 v250, 4, v125
    v_lshrrev_b32 v1, 4, v125
    v_lshlrev_b32 v0, 13, v1
    v_and_b32 v2, 15, v125
    v_lshl_add_u32 v0, v2, 4, v0
    s_lshl_b32 s68, s49, 8
    v_add_u32 v0, s68, v0
    v_mov_b32 v3, v0
    s_lshl_b32 s68, s48, 17
    v_add_u32 v0, s68, v0
    s_mov_b32 s44, s14
    s_and_b32 s45, s15, 0xffff
    s_mov_b32 s46, 0x400000
    s_mov_b32 s47, 0x20000
    s_mov_b32 s53, 0x0
    buffer_load_dwordx4 v[128:131], v0, s[44:47], s53 offen
    s_mov_b32 s53, 0x400
    buffer_load_dwordx4 v[132:135], v0, s[44:47], s53 offen
    s_mov_b32 s53, 0x800
    buffer_load_dwordx4 v[136:139], v0, s[44:47], s53 offen
    s_mov_b32 s53, 0xc00
    buffer_load_dwordx4 v[140:143], v0, s[44:47], s53 offen
    s_mov_b32 s53, 0x1000
    buffer_load_dwordx4 v[144:147], v0, s[44:47], s53 offen
    s_mov_b32 s53, 0x1400
    buffer_load_dwordx4 v[148:151], v0, s[44:47], s53 offen
    s_mov_b32 s53, 0x1800
    buffer_load_dwordx4 v[152:155], v0, s[44:47], s53 offen
    s_mov_b32 s53, 0x1c00
    buffer_load_dwordx4 v[156:159], v0, s[44:47], s53 offen
    s_mov_b32 s53, 0x8000
    buffer_load_dwordx4 v[160:163], v0, s[44:47], s53 offen
    s_mov_b32 s53, 0x8400
    buffer_load_dwordx4 v[164:167], v0, s[44:47], s53 offen
    s_mov_b32 s53, 0x8800
    buffer_load_dwordx4 v[168:171], v0, s[44:47], s53 offen
    s_mov_b32 s53, 0x8c00
    buffer_load_dwordx4 v[172:175], v0, s[44:47], s53 offen
    s_mov_b32 s53, 0x9000
    buffer_load_dwordx4 v[176:179], v0, s[44:47], s53 offen
    s_mov_b32 s53, 0x9400
    buffer_load_dwordx4 v[180:183], v0, s[44:47], s53 offen
    s_mov_b32 s53, 0x9800
    buffer_load_dwordx4 v[184:187], v0, s[44:47], s53 offen
    s_mov_b32 s53, 0x9c00
    buffer_load_dwordx4 v[188:191], v0, s[44:47], s53 offen
    s_waitcnt vmcnt(14)
    v_perm_b32 v252, v132, v128, s50
    v_accvgpr_write_b32 a0, v252
    v_perm_b32 v253, v132, v128, s51
    v_accvgpr_write_b32 a16, v253
    v_perm_b32 v254, v133, v129, s50
    v_accvgpr_write_b32 a32, v254
    v_perm_b32 v255, v133, v129, s51
    v_accvgpr_write_b32 a48, v255
    v_perm_b32 v252, v134, v130, s50
    v_accvgpr_write_b32 a64, v252
    v_perm_b32 v253, v134, v130, s51
    v_accvgpr_write_b32 a80, v253
    v_perm_b32 v254, v135, v131, s50
    v_accvgpr_write_b32 a96, v254
    v_perm_b32 v255, v135, v131, s51
    v_accvgpr_write_b32 a112, v255
    s_waitcnt vmcnt(12)
    v_perm_b32 v252, v140, v136, s50
    v_accvgpr_write_b32 a1, v252
    v_perm_b32 v253, v140, v136, s51
    v_accvgpr_write_b32 a17, v253
    v_perm_b32 v254, v141, v137, s50
    v_accvgpr_write_b32 a33, v254
    v_perm_b32 v255, v141, v137, s51
    v_accvgpr_write_b32 a49, v255
    v_perm_b32 v252, v142, v138, s50
    v_accvgpr_write_b32 a65, v252
    v_perm_b32 v253, v142, v138, s51
    v_accvgpr_write_b32 a81, v253
    v_perm_b32 v254, v143, v139, s50
    v_accvgpr_write_b32 a97, v254
    v_perm_b32 v255, v143, v139, s51
    v_accvgpr_write_b32 a113, v255
    s_waitcnt vmcnt(10)
    v_perm_b32 v252, v148, v144, s50
    v_accvgpr_write_b32 a2, v252
    v_perm_b32 v253, v148, v144, s51
    v_accvgpr_write_b32 a18, v253
    v_perm_b32 v254, v149, v145, s50
    v_accvgpr_write_b32 a34, v254
    v_perm_b32 v255, v149, v145, s51
    v_accvgpr_write_b32 a50, v255
    v_perm_b32 v252, v150, v146, s50
    v_accvgpr_write_b32 a66, v252
    v_perm_b32 v253, v150, v146, s51
    v_accvgpr_write_b32 a82, v253
    v_perm_b32 v254, v151, v147, s50
    v_accvgpr_write_b32 a98, v254
    v_perm_b32 v255, v151, v147, s51
    v_accvgpr_write_b32 a114, v255
    s_waitcnt vmcnt(8)
    v_perm_b32 v252, v156, v152, s50
    v_accvgpr_write_b32 a3, v252
    v_perm_b32 v253, v156, v152, s51
    v_accvgpr_write_b32 a19, v253
    v_perm_b32 v254, v157, v153, s50
    v_accvgpr_write_b32 a35, v254
    v_perm_b32 v255, v157, v153, s51
    v_accvgpr_write_b32 a51, v255
    v_perm_b32 v252, v158, v154, s50
    v_accvgpr_write_b32 a67, v252
    v_perm_b32 v253, v158, v154, s51
    v_accvgpr_write_b32 a83, v253
    v_perm_b32 v254, v159, v155, s50
    v_accvgpr_write_b32 a99, v254
    v_perm_b32 v255, v159, v155, s51
    v_accvgpr_write_b32 a115, v255
    s_mov_b32 s53, 0x10000
    buffer_load_dwordx4 v[128:131], v0, s[44:47], s53 offen
    s_mov_b32 s53, 0x10400
    buffer_load_dwordx4 v[132:135], v0, s[44:47], s53 offen
    s_mov_b32 s53, 0x10800
    buffer_load_dwordx4 v[136:139], v0, s[44:47], s53 offen
    s_mov_b32 s53, 0x10c00
    buffer_load_dwordx4 v[140:143], v0, s[44:47], s53 offen
    s_mov_b32 s53, 0x11000
    buffer_load_dwordx4 v[144:147], v0, s[44:47], s53 offen
    s_mov_b32 s53, 0x11400
    buffer_load_dwordx4 v[148:151], v0, s[44:47], s53 offen
    s_mov_b32 s53, 0x11800
    buffer_load_dwordx4 v[152:155], v0, s[44:47], s53 offen
    s_mov_b32 s53, 0x11c00
    buffer_load_dwordx4 v[156:159], v0, s[44:47], s53 offen
    s_waitcnt vmcnt(14)
    v_perm_b32 v252, v164, v160, s50
    v_accvgpr_write_b32 a4, v252
    v_perm_b32 v253, v164, v160, s51
    v_accvgpr_write_b32 a20, v253
    v_perm_b32 v254, v165, v161, s50
    v_accvgpr_write_b32 a36, v254
    v_perm_b32 v255, v165, v161, s51
    v_accvgpr_write_b32 a52, v255
    v_perm_b32 v252, v166, v162, s50
    v_accvgpr_write_b32 a68, v252
    v_perm_b32 v253, v166, v162, s51
    v_accvgpr_write_b32 a84, v253
    v_perm_b32 v254, v167, v163, s50
    v_accvgpr_write_b32 a100, v254
    v_perm_b32 v255, v167, v163, s51
    v_accvgpr_write_b32 a116, v255
    s_waitcnt vmcnt(12)
    v_perm_b32 v252, v172, v168, s50
    v_accvgpr_write_b32 a5, v252
    v_perm_b32 v253, v172, v168, s51
    v_accvgpr_write_b32 a21, v253
    v_perm_b32 v254, v173, v169, s50
    v_accvgpr_write_b32 a37, v254
    v_perm_b32 v255, v173, v169, s51
    v_accvgpr_write_b32 a53, v255
    v_perm_b32 v252, v174, v170, s50
    v_accvgpr_write_b32 a69, v252
    v_perm_b32 v253, v174, v170, s51
    v_accvgpr_write_b32 a85, v253
    v_perm_b32 v254, v175, v171, s50
    v_accvgpr_write_b32 a101, v254
    v_perm_b32 v255, v175, v171, s51
    v_accvgpr_write_b32 a117, v255
    s_waitcnt vmcnt(10)
    v_perm_b32 v252, v180, v176, s50
    v_accvgpr_write_b32 a6, v252
    v_perm_b32 v253, v180, v176, s51
    v_accvgpr_write_b32 a22, v253
    v_perm_b32 v254, v181, v177, s50
    v_accvgpr_write_b32 a38, v254
    v_perm_b32 v255, v181, v177, s51
    v_accvgpr_write_b32 a54, v255
    v_perm_b32 v252, v182, v178, s50
    v_accvgpr_write_b32 a70, v252
    v_perm_b32 v253, v182, v178, s51
    v_accvgpr_write_b32 a86, v253
    v_perm_b32 v254, v183, v179, s50
    v_accvgpr_write_b32 a102, v254
    v_perm_b32 v255, v183, v179, s51
    v_accvgpr_write_b32 a118, v255
    s_waitcnt vmcnt(8)
    v_perm_b32 v252, v188, v184, s50
    v_accvgpr_write_b32 a7, v252
    v_perm_b32 v253, v188, v184, s51
    v_accvgpr_write_b32 a23, v253
    v_perm_b32 v254, v189, v185, s50
    v_accvgpr_write_b32 a39, v254
    v_perm_b32 v255, v189, v185, s51
    v_accvgpr_write_b32 a55, v255
    v_perm_b32 v252, v190, v186, s50
    v_accvgpr_write_b32 a71, v252
    v_perm_b32 v253, v190, v186, s51
    v_accvgpr_write_b32 a87, v253
    v_perm_b32 v254, v191, v187, s50
    v_accvgpr_write_b32 a103, v254
    v_perm_b32 v255, v191, v187, s51
    v_accvgpr_write_b32 a119, v255
    s_mov_b32 s53, 0x18000
    buffer_load_dwordx4 v[160:163], v0, s[44:47], s53 offen
    s_mov_b32 s53, 0x18400
    buffer_load_dwordx4 v[164:167], v0, s[44:47], s53 offen
    s_mov_b32 s53, 0x18800
    buffer_load_dwordx4 v[168:171], v0, s[44:47], s53 offen
    s_mov_b32 s53, 0x18c00
    buffer_load_dwordx4 v[172:175], v0, s[44:47], s53 offen
    s_mov_b32 s53, 0x19000
    buffer_load_dwordx4 v[176:179], v0, s[44:47], s53 offen
    s_mov_b32 s53, 0x19400
    buffer_load_dwordx4 v[180:183], v0, s[44:47], s53 offen
    s_mov_b32 s53, 0x19800
    buffer_load_dwordx4 v[184:187], v0, s[44:47], s53 offen
    s_mov_b32 s53, 0x19c00
    buffer_load_dwordx4 v[188:191], v0, s[44:47], s53 offen
    s_waitcnt vmcnt(14)
    v_perm_b32 v252, v132, v128, s50
    v_accvgpr_write_b32 a8, v252
    v_perm_b32 v253, v132, v128, s51
    v_accvgpr_write_b32 a24, v253
    v_perm_b32 v254, v133, v129, s50
    v_accvgpr_write_b32 a40, v254
    v_perm_b32 v255, v133, v129, s51
    v_accvgpr_write_b32 a56, v255
    v_perm_b32 v252, v134, v130, s50
    v_accvgpr_write_b32 a72, v252
    v_perm_b32 v253, v134, v130, s51
    v_accvgpr_write_b32 a88, v253
    v_perm_b32 v254, v135, v131, s50
    v_accvgpr_write_b32 a104, v254
    v_perm_b32 v255, v135, v131, s51
    v_accvgpr_write_b32 a120, v255
    s_waitcnt vmcnt(12)
    v_perm_b32 v252, v140, v136, s50
    v_accvgpr_write_b32 a9, v252
    v_perm_b32 v253, v140, v136, s51
    v_accvgpr_write_b32 a25, v253
    v_perm_b32 v254, v141, v137, s50
    v_accvgpr_write_b32 a41, v254
    v_perm_b32 v255, v141, v137, s51
    v_accvgpr_write_b32 a57, v255
    v_perm_b32 v252, v142, v138, s50
    v_accvgpr_write_b32 a73, v252
    v_perm_b32 v253, v142, v138, s51
    v_accvgpr_write_b32 a89, v253
    v_perm_b32 v254, v143, v139, s50
    v_accvgpr_write_b32 a105, v254
    v_perm_b32 v255, v143, v139, s51
    v_accvgpr_write_b32 a121, v255
    s_waitcnt vmcnt(10)
    v_perm_b32 v252, v148, v144, s50
    v_accvgpr_write_b32 a10, v252
    v_perm_b32 v253, v148, v144, s51
    v_accvgpr_write_b32 a26, v253
    v_perm_b32 v254, v149, v145, s50
    v_accvgpr_write_b32 a42, v254
    v_perm_b32 v255, v149, v145, s51
    v_accvgpr_write_b32 a58, v255
    v_perm_b32 v252, v150, v146, s50
    v_accvgpr_write_b32 a74, v252
    v_perm_b32 v253, v150, v146, s51
    v_accvgpr_write_b32 a90, v253
    v_perm_b32 v254, v151, v147, s50
    v_accvgpr_write_b32 a106, v254
    v_perm_b32 v255, v151, v147, s51
    v_accvgpr_write_b32 a122, v255
    s_waitcnt vmcnt(8)
    v_perm_b32 v252, v156, v152, s50
    v_accvgpr_write_b32 a11, v252
    v_perm_b32 v253, v156, v152, s51
    v_accvgpr_write_b32 a27, v253
    v_perm_b32 v254, v157, v153, s50
    v_accvgpr_write_b32 a43, v254
    v_perm_b32 v255, v157, v153, s51
    v_accvgpr_write_b32 a59, v255
    v_perm_b32 v252, v158, v154, s50
    v_accvgpr_write_b32 a75, v252
    v_perm_b32 v253, v158, v154, s51
    v_accvgpr_write_b32 a91, v253
    v_perm_b32 v254, v159, v155, s50
    v_accvgpr_write_b32 a107, v254
    v_perm_b32 v255, v159, v155, s51
    v_accvgpr_write_b32 a123, v255
    s_waitcnt vmcnt(6)
    v_perm_b32 v252, v164, v160, s50
    v_accvgpr_write_b32 a12, v252
    v_perm_b32 v253, v164, v160, s51
    v_accvgpr_write_b32 a28, v253
    v_perm_b32 v254, v165, v161, s50
    v_accvgpr_write_b32 a44, v254
    v_perm_b32 v255, v165, v161, s51
    v_accvgpr_write_b32 a60, v255
    v_perm_b32 v252, v166, v162, s50
    v_accvgpr_write_b32 a76, v252
    v_perm_b32 v253, v166, v162, s51
    v_accvgpr_write_b32 a92, v253
    v_perm_b32 v254, v167, v163, s50
    v_accvgpr_write_b32 a108, v254
    v_perm_b32 v255, v167, v163, s51
    v_accvgpr_write_b32 a124, v255
    s_waitcnt vmcnt(4)
    v_perm_b32 v252, v172, v168, s50
    v_accvgpr_write_b32 a13, v252
    v_perm_b32 v253, v172, v168, s51
    v_accvgpr_write_b32 a29, v253
    v_perm_b32 v254, v173, v169, s50
    v_accvgpr_write_b32 a45, v254
    v_perm_b32 v255, v173, v169, s51
    v_accvgpr_write_b32 a61, v255
    v_perm_b32 v252, v174, v170, s50
    v_accvgpr_write_b32 a77, v252
    v_perm_b32 v253, v174, v170, s51
    v_accvgpr_write_b32 a93, v253
    v_perm_b32 v254, v175, v171, s50
    v_accvgpr_write_b32 a109, v254
    v_perm_b32 v255, v175, v171, s51
    v_accvgpr_write_b32 a125, v255
    s_waitcnt vmcnt(2)
    v_perm_b32 v252, v180, v176, s50
    v_accvgpr_write_b32 a14, v252
    v_perm_b32 v253, v180, v176, s51
    v_accvgpr_write_b32 a30, v253
    v_perm_b32 v254, v181, v177, s50
    v_accvgpr_write_b32 a46, v254
    v_perm_b32 v255, v181, v177, s51
    v_accvgpr_write_b32 a62, v255
    v_perm_b32 v252, v182, v178, s50
    v_accvgpr_write_b32 a78, v252
    v_perm_b32 v253, v182, v178, s51
    v_accvgpr_write_b32 a94, v253
    v_perm_b32 v254, v183, v179, s50
    v_accvgpr_write_b32 a110, v254
    v_perm_b32 v255, v183, v179, s51
    v_accvgpr_write_b32 a126, v255
    s_waitcnt vmcnt(0)
    v_perm_b32 v252, v188, v184, s50
    v_accvgpr_write_b32 a15, v252
    v_perm_b32 v253, v188, v184, s51
    v_accvgpr_write_b32 a31, v253
    v_perm_b32 v254, v189, v185, s50
    v_accvgpr_write_b32 a47, v254
    v_perm_b32 v255, v189, v185, s51
    v_accvgpr_write_b32 a63, v255
    v_perm_b32 v252, v190, v186, s50
    v_accvgpr_write_b32 a79, v252
    v_perm_b32 v253, v190, v186, s51
    v_accvgpr_write_b32 a95, v253
    v_perm_b32 v254, v191, v187, s50
    v_accvgpr_write_b32 a111, v254
    v_perm_b32 v255, v191, v187, s51
    v_accvgpr_write_b32 a127, v255
    s_sub_u32 s85, s79, 32
    s_cmp_ge_u32 s85, 43
    s_cbranch_scc1 L_ffs32
    s_lshl_b32 s68, s85, 15
    v_add_u32 v3, s68, v3
    s_mov_b32 s44, s26
    s_and_b32 s45, s27, 0xffff
    s_mov_b32 s46, 0x158000
    s_mov_b32 s47, 0x20000
    s_mov_b32 s53, 0x0
    buffer_load_dwordx4 v[128:131], v3, s[44:47], s53 offen
    s_mov_b32 s53, 0x400
    buffer_load_dwordx4 v[132:135], v3, s[44:47], s53 offen
    s_mov_b32 s53, 0x800
    buffer_load_dwordx4 v[136:139], v3, s[44:47], s53 offen
    s_mov_b32 s53, 0xc00
    buffer_load_dwordx4 v[140:143], v3, s[44:47], s53 offen
    s_mov_b32 s53, 0x1000
    buffer_load_dwordx4 v[144:147], v3, s[44:47], s53 offen
    s_mov_b32 s53, 0x1400
    buffer_load_dwordx4 v[148:151], v3, s[44:47], s53 offen
    s_mov_b32 s53, 0x1800
    buffer_load_dwordx4 v[152:155], v3, s[44:47], s53 offen
    s_mov_b32 s53, 0x1c00
    buffer_load_dwordx4 v[156:159], v3, s[44:47], s53 offen
    s_waitcnt vmcnt(6)
    v_perm_b32 v252, v132, v128, s50
    v_accvgpr_write_b32 a192, v252
    v_perm_b32 v253, v132, v128, s51
    v_accvgpr_write_b32 a196, v253
    v_perm_b32 v254, v133, v129, s50
    v_accvgpr_write_b32 a200, v254
    v_perm_b32 v255, v133, v129, s51
    v_accvgpr_write_b32 a204, v255
    v_perm_b32 v252, v134, v130, s50
    v_accvgpr_write_b32 a208, v252
    v_perm_b32 v253, v134, v130, s51
    v_accvgpr_write_b32 a212, v253
    v_perm_b32 v254, v135, v131, s50
    v_accvgpr_write_b32 a216, v254
    v_perm_b32 v255, v135, v131, s51
    v_accvgpr_write_b32 a220, v255
    s_waitcnt vmcnt(4)
    v_perm_b32 v252, v140, v136, s50
    v_accvgpr_write_b32 a193, v252
    v_perm_b32 v253, v140, v136, s51
    v_accvgpr_write_b32 a197, v253
    v_perm_b32 v254, v141, v137, s50
    v_accvgpr_write_b32 a201, v254
    v_perm_b32 v255, v141, v137, s51
    v_accvgpr_write_b32 a205, v255
    v_perm_b32 v252, v142, v138, s50
    v_accvgpr_write_b32 a209, v252
    v_perm_b32 v253, v142, v138, s51
    v_accvgpr_write_b32 a213, v253
    v_perm_b32 v254, v143, v139, s50
    v_accvgpr_write_b32 a217, v254
    v_perm_b32 v255, v143, v139, s51
    v_accvgpr_write_b32 a221, v255
    s_waitcnt vmcnt(2)
    v_perm_b32 v252, v148, v144, s50
    v_accvgpr_write_b32 a194, v252
    v_perm_b32 v253, v148, v144, s51
    v_accvgpr_write_b32 a198, v253
    v_perm_b32 v254, v149, v145, s50
    v_accvgpr_write_b32 a202, v254
    v_perm_b32 v255, v149, v145, s51
    v_accvgpr_write_b32 a206, v255
    v_perm_b32 v252, v150, v146, s50
    v_accvgpr_write_b32 a210, v252
    v_perm_b32 v253, v150, v146, s51
    v_accvgpr_write_b32 a214, v253
    v_perm_b32 v254, v151, v147, s50
    v_accvgpr_write_b32 a218, v254
    v_perm_b32 v255, v151, v147, s51
    v_accvgpr_write_b32 a222, v255
    s_waitcnt vmcnt(0)
    v_perm_b32 v252, v156, v152, s50
    v_accvgpr_write_b32 a195, v252
    v_perm_b32 v253, v156, v152, s51
    v_accvgpr_write_b32 a199, v253
    v_perm_b32 v254, v157, v153, s50
    v_accvgpr_write_b32 a203, v254
    v_perm_b32 v255, v157, v153, s51
    v_accvgpr_write_b32 a207, v255
    v_perm_b32 v252, v158, v154, s50
    v_accvgpr_write_b32 a211, v252
    v_perm_b32 v253, v158, v154, s51
    v_accvgpr_write_b32 a215, v253
    v_perm_b32 v254, v159, v155, s50
    v_accvgpr_write_b32 a219, v254
    v_perm_b32 v255, v159, v155, s51
    v_accvgpr_write_b32 a223, v255
    s_mov_b32 s68, 22016
    v_mul_lo_u32 v4, s68, v1
    v_lshl_add_u32 v4, v2, 2, v4
    s_lshr_b32 s68, s49, 1
    s_mul_i32 s68, s68, 704512
    s_lshl_b32 s69, s85, 6
    s_add_u32 s68, s68, s69
    v_add_u32 v4, s68, v4
    s_bitcmp1_b32 s49, 0
    s_cbranch_scc1 L_ffu33
    s_mov_b32 s44, s22
    s_and_b32 s45, s23, 0xffff
    s_mov_b32 s46, 0x158000
    s_mov_b32 s47, 0x20000
    s_branch L_ffg34
L_ffu33:
    s_mov_b32 s44, s24
    s_and_b32 s45, s25, 0xffff
    s_mov_b32 s46, 0x158000
    s_mov_b32 s47, 0x20000
L_ffg34:
    s_mov_b32 s53, 0x0
    buffer_load_dword v128, v4, s[44:47], s53 offen
    s_mov_b32 s53, 0xac0
    buffer_load_dword v129, v4, s[44:47], s53 offen
    s_mov_b32 s53, 0x1580
    buffer_load_dword v130, v4, s[44:47], s53 offen
    s_mov_b32 s53, 0x2040
    buffer_load_dword v131, v4, s[44:47], s53 offen
    s_mov_b32 s53, 0x2b00
    buffer_load_dword v132, v4, s[44:47], s53 offen
    s_mov_b32 s53, 0x35c0
    buffer_load_dword v133, v4, s[44:47], s53 offen
    s_mov_b32 s53, 0x4080
    buffer_load_dword v134, v4, s[44:47], s53 offen
    s_mov_b32 s53, 0x4b40
    buffer_load_dword v135, v4, s[44:47], s53 offen
    s_mov_b32 s53, 0x15800
    buffer_load_dword v136, v4, s[44:47], s53 offen
    s_mov_b32 s53, 0x162c0
    buffer_load_dword v137, v4, s[44:47], s53 offen
    s_mov_b32 s53, 0x16d80
    buffer_load_dword v138, v4, s[44:47], s53 offen
    s_mov_b32 s53, 0x17840
    buffer_load_dword v139, v4, s[44:47], s53 offen
    s_mov_b32 s53, 0x18300
    buffer_load_dword v140, v4, s[44:47], s53 offen
    s_mov_b32 s53, 0x18dc0
    buffer_load_dword v141, v4, s[44:47], s53 offen
    s_mov_b32 s53, 0x19880
    buffer_load_dword v142, v4, s[44:47], s53 offen
    s_mov_b32 s53, 0x1a340
    buffer_load_dword v143, v4, s[44:47], s53 offen
    s_mov_b32 s53, 0x2b000
    buffer_load_dword v144, v4, s[44:47], s53 offen
    s_mov_b32 s53, 0x2bac0
    buffer_load_dword v145, v4, s[44:47], s53 offen
    s_mov_b32 s53, 0x2c580
    buffer_load_dword v146, v4, s[44:47], s53 offen
    s_mov_b32 s53, 0x2d040
    buffer_load_dword v147, v4, s[44:47], s53 offen
    s_mov_b32 s53, 0x2db00
    buffer_load_dword v148, v4, s[44:47], s53 offen
    s_mov_b32 s53, 0x2e5c0
    buffer_load_dword v149, v4, s[44:47], s53 offen
    s_mov_b32 s53, 0x2f080
    buffer_load_dword v150, v4, s[44:47], s53 offen
    s_mov_b32 s53, 0x2fb40
    buffer_load_dword v151, v4, s[44:47], s53 offen
    s_mov_b32 s53, 0x40800
    buffer_load_dword v152, v4, s[44:47], s53 offen
    s_mov_b32 s53, 0x412c0
    buffer_load_dword v153, v4, s[44:47], s53 offen
    s_mov_b32 s53, 0x41d80
    buffer_load_dword v154, v4, s[44:47], s53 offen
    s_mov_b32 s53, 0x42840
    buffer_load_dword v155, v4, s[44:47], s53 offen
    s_mov_b32 s53, 0x43300
    buffer_load_dword v156, v4, s[44:47], s53 offen
    s_mov_b32 s53, 0x43dc0
    buffer_load_dword v157, v4, s[44:47], s53 offen
    s_mov_b32 s53, 0x44880
    buffer_load_dword v158, v4, s[44:47], s53 offen
    s_mov_b32 s53, 0x45340
    buffer_load_dword v159, v4, s[44:47], s53 offen
    s_waitcnt vmcnt(30)
    v_perm_b32 v252, v129, v128, s50
    v_accvgpr_write_b32 a128, v252
    v_perm_b32 v253, v129, v128, s51
    v_accvgpr_write_b32 a160, v253
    s_waitcnt vmcnt(28)
    v_perm_b32 v252, v131, v130, s50
    v_accvgpr_write_b32 a129, v252
    v_perm_b32 v253, v131, v130, s51
    v_accvgpr_write_b32 a161, v253
    s_waitcnt vmcnt(26)
    v_perm_b32 v252, v133, v132, s50
    v_accvgpr_write_b32 a130, v252
    v_perm_b32 v253, v133, v132, s51
    v_accvgpr_write_b32 a162, v253
    s_waitcnt vmcnt(24)
    v_perm_b32 v252, v135, v134, s50
    v_accvgpr_write_b32 a131, v252
    v_perm_b32 v253, v135, v134, s51
    v_accvgpr_write_b32 a163, v253
    s_waitcnt vmcnt(22)
    v_perm_b32 v252, v137, v136, s50
    v_accvgpr_write_b32 a132, v252
    v_perm_b32 v253, v137, v136, s51
    v_accvgpr_write_b32 a164, v253
    s_waitcnt vmcnt(20)
    v_perm_b32 v252, v139, v138, s50
    v_accvgpr_write_b32 a133, v252
    v_perm_b32 v253, v139, v138, s51
    v_accvgpr_write_b32 a165, v253
    s_waitcnt vmcnt(18)
    v_perm_b32 v252, v141, v140, s50
    v_accvgpr_write_b32 a134, v252
    v_perm_b32 v253, v141, v140, s51
    v_accvgpr_write_b32 a166, v253
    s_waitcnt vmcnt(16)
    v_perm_b32 v252, v143, v142, s50
    v_accvgpr_write_b32 a135, v252
    v_perm_b32 v253, v143, v142, s51
    v_accvgpr_write_b32 a167, v253
    s_waitcnt vmcnt(14)
    v_perm_b32 v252, v145, v144, s50
    v_accvgpr_write_b32 a136, v252
    v_perm_b32 v253, v145, v144, s51
    v_accvgpr_write_b32 a168, v253
    s_waitcnt vmcnt(12)
    v_perm_b32 v252, v147, v146, s50
    v_accvgpr_write_b32 a137, v252
    v_perm_b32 v253, v147, v146, s51
    v_accvgpr_write_b32 a169, v253
    s_waitcnt vmcnt(10)
    v_perm_b32 v252, v149, v148, s50
    v_accvgpr_write_b32 a138, v252
    v_perm_b32 v253, v149, v148, s51
    v_accvgpr_write_b32 a170, v253
    s_waitcnt vmcnt(8)
    v_perm_b32 v252, v151, v150, s50
    v_accvgpr_write_b32 a139, v252
    v_perm_b32 v253, v151, v150, s51
    v_accvgpr_write_b32 a171, v253
    s_waitcnt vmcnt(6)
    v_perm_b32 v252, v153, v152, s50
    v_accvgpr_write_b32 a140, v252
    v_perm_b32 v253, v153, v152, s51
    v_accvgpr_write_b32 a172, v253
    s_waitcnt vmcnt(4)
    v_perm_b32 v252, v155, v154, s50
    v_accvgpr_write_b32 a141, v252
    v_perm_b32 v253, v155, v154, s51
    v_accvgpr_write_b32 a173, v253
    s_waitcnt vmcnt(2)
    v_perm_b32 v252, v157, v156, s50
    v_accvgpr_write_b32 a142, v252
    v_perm_b32 v253, v157, v156, s51
    v_accvgpr_write_b32 a174, v253
    s_waitcnt vmcnt(0)
    v_perm_b32 v252, v159, v158, s50
    v_accvgpr_write_b32 a143, v252
    v_perm_b32 v253, v159, v158, s51
    v_accvgpr_write_b32 a175, v253
    s_mov_b32 s53, 0x56000
    buffer_load_dword v128, v4, s[44:47], s53 offen
    s_mov_b32 s53, 0x56ac0
    buffer_load_dword v129, v4, s[44:47], s53 offen
    s_mov_b32 s53, 0x57580
    buffer_load_dword v130, v4, s[44:47], s53 offen
    s_mov_b32 s53, 0x58040
    buffer_load_dword v131, v4, s[44:47], s53 offen
    s_mov_b32 s53, 0x58b00
    buffer_load_dword v132, v4, s[44:47], s53 offen
    s_mov_b32 s53, 0x595c0
    buffer_load_dword v133, v4, s[44:47], s53 offen
    s_mov_b32 s53, 0x5a080
    buffer_load_dword v134, v4, s[44:47], s53 offen
    s_mov_b32 s53, 0x5ab40
    buffer_load_dword v135, v4, s[44:47], s53 offen
    s_mov_b32 s53, 0x6b800
    buffer_load_dword v136, v4, s[44:47], s53 offen
    s_mov_b32 s53, 0x6c2c0
    buffer_load_dword v137, v4, s[44:47], s53 offen
    s_mov_b32 s53, 0x6cd80
    buffer_load_dword v138, v4, s[44:47], s53 offen
    s_mov_b32 s53, 0x6d840
    buffer_load_dword v139, v4, s[44:47], s53 offen
    s_mov_b32 s53, 0x6e300
    buffer_load_dword v140, v4, s[44:47], s53 offen
    s_mov_b32 s53, 0x6edc0
    buffer_load_dword v141, v4, s[44:47], s53 offen
    s_mov_b32 s53, 0x6f880
    buffer_load_dword v142, v4, s[44:47], s53 offen
    s_mov_b32 s53, 0x70340
    buffer_load_dword v143, v4, s[44:47], s53 offen
    s_mov_b32 s53, 0x81000
    buffer_load_dword v144, v4, s[44:47], s53 offen
    s_mov_b32 s53, 0x81ac0
    buffer_load_dword v145, v4, s[44:47], s53 offen
    s_mov_b32 s53, 0x82580
    buffer_load_dword v146, v4, s[44:47], s53 offen
    s_mov_b32 s53, 0x83040
    buffer_load_dword v147, v4, s[44:47], s53 offen
    s_mov_b32 s53, 0x83b00
    buffer_load_dword v148, v4, s[44:47], s53 offen
    s_mov_b32 s53, 0x845c0
    buffer_load_dword v149, v4, s[44:47], s53 offen
    s_mov_b32 s53, 0x85080
    buffer_load_dword v150, v4, s[44:47], s53 offen
    s_mov_b32 s53, 0x85b40
    buffer_load_dword v151, v4, s[44:47], s53 offen
    s_mov_b32 s53, 0x96800
    buffer_load_dword v152, v4, s[44:47], s53 offen
    s_mov_b32 s53, 0x972c0
    buffer_load_dword v153, v4, s[44:47], s53 offen
    s_mov_b32 s53, 0x97d80
    buffer_load_dword v154, v4, s[44:47], s53 offen
    s_mov_b32 s53, 0x98840
    buffer_load_dword v155, v4, s[44:47], s53 offen
    s_mov_b32 s53, 0x99300
    buffer_load_dword v156, v4, s[44:47], s53 offen
    s_mov_b32 s53, 0x99dc0
    buffer_load_dword v157, v4, s[44:47], s53 offen
    s_mov_b32 s53, 0x9a880
    buffer_load_dword v158, v4, s[44:47], s53 offen
    s_mov_b32 s53, 0x9b340
    buffer_load_dword v159, v4, s[44:47], s53 offen
    s_waitcnt vmcnt(30)
    v_perm_b32 v252, v129, v128, s50
    v_accvgpr_write_b32 a144, v252
    v_perm_b32 v253, v129, v128, s51
    v_accvgpr_write_b32 a176, v253
    s_waitcnt vmcnt(28)
    v_perm_b32 v252, v131, v130, s50
    v_accvgpr_write_b32 a145, v252
    v_perm_b32 v253, v131, v130, s51
    v_accvgpr_write_b32 a177, v253
    s_waitcnt vmcnt(26)
    v_perm_b32 v252, v133, v132, s50
    v_accvgpr_write_b32 a146, v252
    v_perm_b32 v253, v133, v132, s51
    v_accvgpr_write_b32 a178, v253
    s_waitcnt vmcnt(24)
    v_perm_b32 v252, v135, v134, s50
    v_accvgpr_write_b32 a147, v252
    v_perm_b32 v253, v135, v134, s51
    v_accvgpr_write_b32 a179, v253
    s_waitcnt vmcnt(22)
    v_perm_b32 v252, v137, v136, s50
    v_accvgpr_write_b32 a148, v252
    v_perm_b32 v253, v137, v136, s51
    v_accvgpr_write_b32 a180, v253
    s_waitcnt vmcnt(20)
    v_perm_b32 v252, v139, v138, s50
    v_accvgpr_write_b32 a149, v252
    v_perm_b32 v253, v139, v138, s51
    v_accvgpr_write_b32 a181, v253
    s_waitcnt vmcnt(18)
    v_perm_b32 v252, v141, v140, s50
    v_accvgpr_write_b32 a150, v252
    v_perm_b32 v253, v141, v140, s51
    v_accvgpr_write_b32 a182, v253
    s_waitcnt vmcnt(16)
    v_perm_b32 v252, v143, v142, s50
    v_accvgpr_write_b32 a151, v252
    v_perm_b32 v253, v143, v142, s51
    v_accvgpr_write_b32 a183, v253
    s_waitcnt vmcnt(14)
    v_perm_b32 v252, v145, v144, s50
    v_accvgpr_write_b32 a152, v252
    v_perm_b32 v253, v145, v144, s51
    v_accvgpr_write_b32 a184, v253
    s_waitcnt vmcnt(12)
    v_perm_b32 v252, v147, v146, s50
    v_accvgpr_write_b32 a153, v252
    v_perm_b32 v253, v147, v146, s51
    v_accvgpr_write_b32 a185, v253
    s_waitcnt vmcnt(10)
    v_perm_b32 v252, v149, v148, s50
    v_accvgpr_write_b32 a154, v252
    v_perm_b32 v253, v149, v148, s51
    v_accvgpr_write_b32 a186, v253
    s_waitcnt vmcnt(8)
    v_perm_b32 v252, v151, v150, s50
    v_accvgpr_write_b32 a155, v252
    v_perm_b32 v253, v151, v150, s51
    v_accvgpr_write_b32 a187, v253
    s_waitcnt vmcnt(6)
    v_perm_b32 v252, v153, v152, s50
    v_accvgpr_write_b32 a156, v252
    v_perm_b32 v253, v153, v152, s51
    v_accvgpr_write_b32 a188, v253
    s_waitcnt vmcnt(4)
    v_perm_b32 v252, v155, v154, s50
    v_accvgpr_write_b32 a157, v252
    v_perm_b32 v253, v155, v154, s51
    v_accvgpr_write_b32 a189, v253
    s_waitcnt vmcnt(2)
    v_perm_b32 v252, v157, v156, s50
    v_accvgpr_write_b32 a158, v252
    v_perm_b32 v253, v157, v156, s51
    v_accvgpr_write_b32 a190, v253
    s_waitcnt vmcnt(0)
    v_perm_b32 v252, v159, v158, s50
    v_accvgpr_write_b32 a159, v252
    v_perm_b32 v253, v159, v158, s51
    v_accvgpr_write_b32 a191, v253
    s_nop 1
L_ffs32:
    v_lshlrev_b32 v5, 5, v125
    s_nop 1
L_lm35:
    s_mov_b32 s68, 0x221000
    buffer_load_dwordx4 v[208:211], v5, s[40:43], s68 offen sc1
    buffer_load_dwordx4 v[212:215], v5, s[40:43], s68 offen offset:16 sc1
    s_mov_b32 s68, 0x221800
    buffer_load_dwordx4 v[224:227], v5, s[40:43], s68 offen sc1
    buffer_load_dwordx4 v[228:231], v5, s[40:43], s68 offen offset:16 sc1
    s_mov_b32 s68, 0x222000
    buffer_load_dwordx4 v[216:219], v5, s[40:43], s68 offen sc1
    buffer_load_dwordx4 v[220:223], v5, s[40:43], s68 offen offset:16 sc1
    s_mov_b32 s68, 0x222800
    buffer_load_dwordx4 v[232:235], v5, s[40:43], s68 offen sc1
    buffer_load_dwordx4 v[236:239], v5, s[40:43], s68 offen offset:16 sc1
    s_waitcnt vmcnt(0)
    v_max_u32 v252, v208, v209
    v_max3_u32 v252, v252, v210, v211
    v_max3_u32 v252, v252, v212, v213
    v_max3_u32 v252, v252, v214, v215
    v_max3_u32 v252, v252, v224, v225
    v_max3_u32 v252, v252, v226, v227
    v_max3_u32 v252, v252, v228, v229
    v_max3_u32 v252, v252, v230, v231
    v_max3_u32 v252, v252, v216, v217
    v_max3_u32 v252, v252, v218, v219
    v_max3_u32 v252, v252, v220, v221
    v_max3_u32 v252, v252, v222, v223
    v_max3_u32 v252, v252, v232, v233
    v_max3_u32 v252, v252, v234, v235
    v_max3_u32 v252, v252, v236, v237
    v_max3_u32 v252, v252, v238, v239
    v_cmp_eq_u32 vcc, -1, v252
    s_nop 0
    s_cbranch_vccz L_lmd36
    s_add_u32 s60, s60, 1
    s_cmp_gt_u32 s60, 0x40000
    s_cbranch_scc1 L_exit
    s_sleep 4
    s_branch L_lm35
L_lmd36:
    global_load_dwordx4 v[8:11], v250, s[20:21]
    s_waitcnt vmcnt(0)
    v_and_b32 v241, 0xffff0000, v8
    v_lshlrev_b32 v240, 16, v8
    v_and_b32 v243, 0xffff0000, v9
    v_lshlrev_b32 v242, 16, v9
    v_and_b32 v245, 0xffff0000, v10
    v_lshlrev_b32 v244, 16, v10
    v_and_b32 v247, 0xffff0000, v11
    v_lshlrev_b32 v246, 16, v11
    v_add_f32 v216, 1.0, v216
    v_add_f32 v217, 1.0, v217
    v_add_f32 v218, 1.0, v218
    v_add_f32 v219, 1.0, v219
    v_add_f32 v220, 1.0, v220
    v_add_f32 v221, 1.0, v221
    v_add_f32 v222, 1.0, v222
    v_add_f32 v223, 1.0, v223
    v_cvt_pk_bf16_f32 v252, v216, v217
    v_lshlrev_b32 v216, 16, v252
    v_and_b32 v217, 0xffff0000, v252
    v_cvt_pk_bf16_f32 v252, v218, v219
    v_lshlrev_b32 v218, 16, v252
    v_and_b32 v219, 0xffff0000, v252
    v_cvt_pk_bf16_f32 v252, v220, v221
    v_lshlrev_b32 v220, 16, v252
    v_and_b32 v221, 0xffff0000, v252
    v_cvt_pk_bf16_f32 v252, v222, v223
    v_lshlrev_b32 v222, 16, v252
    v_and_b32 v223, 0xffff0000, v252
    v_lshrrev_b32 v1, 4, v125
    v_and_b32 v2, 15, v125
    s_mul_i32 s68, s49, 8704
    s_add_u32 s68, s68, 32768
    v_mul_u32_u24 v248, 272, v2
    v_lshl_add_u32 v248, v1, 6, v248
    v_add_u32 v248, s68, v248
    v_mul_u32_u24 v249, 272, v1
    v_lshl_add_u32 v249, v2, 4, v249
    v_add_u32 v249, s68, v249
    v_lshlrev_b32 v206, 10, v1
    v_lshl_add_u32 v206, v2, 4, v206
    s_lshl_b32 s68, s49, 8
    v_add_u32 v206, s68, v206
    v_bfe_u32 v3, v125, 2, 2
    v_lshlrev_b32 v251, 8, v3
    v_lshl_add_u32 v251, v1, 6, v251
    v_and_b32 v3, 1, v125
    v_lshl_add_u32 v251, v3, 2, v251
    s_mov_b32 s80, 0xce6e6b28
    s_mov_b32 s81, 0x3db504f3
    s_mov_b32 s82, 0x3fb8aa3b
    s_mov_b32 s83, 0x3f80
    s_mov_b32 s84, 0x3f800000
    s_lshr_b32 s68, s49, 1
    s_lshl_b32 s68, s68, 4
    v_add_u32 v207, s68, v2
    v_lshlrev_b32 v3, 2, v1
    v_sub_u32 v207, v207, v3
    s_sub_u32 s66, s65, 1
    s_cmp_lt_u32 s66, 2
    s_cbranch_scc1 L_aend37
    s_sub_u32 s66, s65, 2
    s_cmp_eq_u32 s65, 0
    s_cselect_b32 s66, 0, s66
    s_mov_b32 s67, 0
    v_min_u32 v104, 6, v125
    v_lshlrev_b32 v104, 6, v104
    s_lshl_b32 s68, s48, 9
    s_add_u32 s68, s68, 0x201000
L_aq38:
    buffer_load_dword v105, v104, s[40:43], s68 offen sc1
    s_waitcnt vmcnt(0)
    v_cmp_gt_u32 vcc, 100, v105
    s_nop 0
    s_cbranch_vccz L_aqd39
    s_add_u32 s60, s60, 1
    s_cmp_gt_u32 s60, 0x40000
    s_cbranch_scc1 L_exit
    s_sleep 16
    s_branch L_aq38
L_aqd39:
L_atop40:
    s_lshl_b32 s68, s66, 18
    s_lshl_b32 s69, s48, 13
    s_add_u32 s68, s68, s69
    s_add_u32 s69, s68, 0x1000000
    buffer_load_dwordx4 v[0:3], v250, s[40:43], s69 offen offset:0
    buffer_load_dwordx4 v[4:7], v250, s[40:43], s69 offen offset:1024
    buffer_load_dwordx4 v[8:11], v250, s[40:43], s69 offen offset:2048
    buffer_load_dwordx4 v[12:15], v250, s[40:43], s69 offen offset:3072
    s_add_u32 s69, s68, 0x1001000
    buffer_load_dwordx4 v[16:19], v250, s[40:43], s69 offen offset:0
    buffer_load_dwordx4 v[20:23], v250, s[40:43], s69 offen offset:1024
    buffer_load_dwordx4 v[24:27], v250, s[40:43], s69 offen offset:2048
    buffer_load_dwordx4 v[28:31], v250, s[40:43], s69 offen offset:3072
    s_lshr_b32 s71, s49, 1
    s_lshl_b32 s71, s71, 10
    s_add_u32 s69, s68, s71
    s_add_u32 s69, s69, 0x3000000
    s_add_u32 s70, s69, 4096
    buffer_load_dwordx4 v[32:35], v250, s[40:43], s69 offen offset:0
    buffer_load_dwordx4 v[36:39], v250, s[40:43], s69 offen offset:2048
    buffer_load_dwordx4 v[40:43], v250, s[40:43], s70 offen offset:0
    buffer_load_dwordx4 v[44:47], v250, s[40:43], s70 offen offset:2048
    s_and_b32 s71, s49, 1
    s_lshl_b32 s70, s71, 12
    s_add_u32 s69, s68, s70
    s_add_u32 s69, s69, 0x2000000
    buffer_load_dwordx4 v[48:51], v250, s[40:43], s69 offen offset:0
    buffer_load_dwordx4 v[52:55], v250, s[40:43], s69 offen offset:1024
    buffer_load_dwordx4 v[56:59], v250, s[40:43], s69 offen offset:2048
    buffer_load_dwordx4 v[60:63], v250, s[40:43], s69 offen offset:3072
    s_waitcnt vmcnt(7)
    v_mfma_f32_16x16x32_bf16 v[84:87], v[0:3], v[32:35], 0
    v_mfma_f32_16x16x32_bf16 v[88:91], v[4:7], v[32:35], 0
    s_waitcnt vmcnt(6)
    v_mfma_f32_16x16x32_bf16 v[84:87], v[8:11], v[36:39], v[84:87]
    v_mfma_f32_16x16x32_bf16 v[88:91], v[12:15], v[36:39], v[88:91]
    s_waitcnt vmcnt(5)
    v_mfma_f32_16x16x32_bf16 v[84:87], v[16:19], v[40:43], v[84:87]
    v_mfma_f32_16x16x32_bf16 v[88:91], v[20:23], v[40:43], v[88:91]
    s_waitcnt vmcnt(4)
    v_mfma_f32_16x16x32_bf16 v[84:87], v[24:27], v[44:47], v[84:87]
    v_mfma_f32_16x16x32_bf16 v[88:91], v[28:31], v[44:47], v[88:91]
    s_nop 6
    v_cvt_pk_bf16_f32 v104, v84, v85
    v_lshlrev_b32 v84, 16, v104
    v_and_b32 v85, 0xffff0000, v104
    v_cvt_pk_bf16_f32 v104, v86, v87
    v_lshlrev_b32 v86, 16, v104
    v_and_b32 v87, 0xffff0000, v104
    v_cvt_pk_bf16_f32 v104, v88, v89
    v_lshlrev_b32 v88, 16, v104
    v_and_b32 v89, 0xffff0000, v104
    v_cvt_pk_bf16_f32 v104, v90, v91
    v_lshlrev_b32 v90, 16, v104
    v_and_b32 v91, 0xffff0000, v104
    v_mul_f32 v84, s81, v84
    v_mul_f32 v85, s81, v85
    v_mul_f32 v86, s81, v86
    v_mul_f32 v87, s81, v87
    v_mul_f32 v88, s81, v88
    v_mul_f32 v89, s81, v89
    v_mul_f32 v90, s81, v90
    v_mul_f32 v91, s81, v91
    v_cvt_pk_bf16_f32 v104, v84, v85
    v_lshlrev_b32 v84, 16, v104
    v_and_b32 v85, 0xffff0000, v104
    v_cvt_pk_bf16_f32 v104, v86, v87
    v_lshlrev_b32 v86, 16, v104
    v_and_b32 v87, 0xffff0000, v104
    v_cvt_pk_bf16_f32 v104, v88, v89
    v_lshlrev_b32 v88, 16, v104
    v_and_b32 v89, 0xffff0000, v104
    v_cvt_pk_bf16_f32 v104, v90, v91
    v_lshlrev_b32 v90, 16, v104
    v_and_b32 v91, 0xffff0000, v104
    v_mov_b32 v105, s80
    v_cmp_le_i32 vcc, 0, v207
    s_nop 1
    v_cndmask_b32 v84, v105, v84, vcc
    v_cmp_le_i32 vcc, 1, v207
    s_nop 1
    v_cndmask_b32 v85, v105, v85, vcc
    v_cmp_le_i32 vcc, 2, v207
    s_nop 1
    v_cndmask_b32 v86, v105, v86, vcc
    v_cmp_le_i32 vcc, 3, v207
    s_nop 1
    v_cndmask_b32 v87, v105, v87, vcc
    v_cmp_le_i32 vcc, 16, v207
    s_nop 1
    v_cndmask_b32 v88, v105, v88, vcc
    v_cmp_le_i32 vcc, 17, v207
    s_nop 1
    v_cndmask_b32 v89, v105, v89, vcc
    v_cmp_le_i32 vcc, 18, v207
    s_nop 1
    v_cndmask_b32 v90, v105, v90, vcc
    v_cmp_le_i32 vcc, 19, v207
    s_nop 1
    v_cndmask_b32 v91, v105, v91, vcc
    v_max3_f32 v105, v84, v85, v86
    v_max3_f32 v105, v105, v87, v88
    v_max3_f32 v105, v105, v89, v90
    v_max_f32 v105, v105, v91
    s_lshl_b32 s69, s66, 17
    s_lshl_b32 s70, s48, 12
    s_add_u32 s69, s69, s70
    s_add_u32 s69, s69, 0x4100000
    s_lshl_b32 s71, s71, 11
    s_add_u32 s71, s71, s69
    s_lshl_b32 s68, s48, 7
    s_add_u32 s68, s68, 0x207000
    v_mov_b32 v108, 0
    s_cmp_lg_u32 s49, 0
    s_cbranch_scc1 L_akb45
L_akc41:
    buffer_load_dword v109, v108, s[40:43], s68 offen sc1
    s_waitcnt vmcnt(0)
    v_readfirstlane_b32 s53, v109
    s_cmp_gt_u32 s53, s66
    s_nop 2
    s_cbranch_scc1 L_akb45
    s_add_u32 s53, s53, 3
    s_cmp_ge_u32 s53, s66
    s_cbranch_scc1 L_akl44
    s_add_u32 s60, s60, 1
    s_cmp_gt_u32 s60, 0x40000
    s_cbranch_scc1 L_exit
    s_sleep 32
    s_branch L_akc41
L_akl44:
    v_lshlrev_b32 v110, 6, v125
    buffer_load_dword v109, v110, s[40:43], s69 offen sc1
    s_waitcnt vmcnt(0)
    v_cmp_eq_u32 vcc, -1, v109
    s_nop 0
    s_cbranch_vccz L_akb45
    s_add_u32 s60, s60, 1
    s_cmp_gt_u32 s60, 0x40000
    s_cbranch_scc1 L_exit
    s_and_b32 s53, s60, 15
    s_cmp_eq_u32 s53, 0
    s_cbranch_scc1 L_akc41
    s_sleep 2
    s_branch L_akl44
L_akb45:
    s_barrier
L_akp42:
    buffer_load_dword v109, v108, s[40:43], s68 offen sc1
    buffer_load_dword v64, v251, s[40:43], s69 offen offset:0 sc1
    buffer_load_dword v65, v251, s[40:43], s69 offen offset:16 sc1
    buffer_load_dword v66, v251, s[40:43], s69 offen offset:32 sc1
    buffer_load_dword v67, v251, s[40:43], s69 offen offset:48 sc1
    buffer_load_dword v68, v251, s[40:43], s69 offen offset:1024 sc1
    buffer_load_dword v69, v251, s[40:43], s69 offen offset:1040 sc1
    buffer_load_dword v70, v251, s[40:43], s69 offen offset:1056 sc1
    buffer_load_dword v71, v251, s[40:43], s69 offen offset:1072 sc1
    buffer_load_dword v72, v251, s[40:43], s69 offen offset:2048 sc1
    buffer_load_dword v73, v251, s[40:43], s69 offen offset:2064 sc1
    buffer_load_dword v74, v251, s[40:43], s69 offen offset:2080 sc1
    buffer_load_dword v75, v251, s[40:43], s69 offen offset:2096 sc1
    buffer_load_dword v76, v251, s[40:43], s69 offen offset:3072 sc1
    buffer_load_dword v77, v251, s[40:43], s69 offen offset:3088 sc1
    buffer_load_dword v78, v251, s[40:43], s69 offen offset:3104 sc1
    buffer_load_dword v79, v251, s[40:43], s69 offen offset:3120 sc1
    buffer_load_dwordx2 v[80:81], v250, s[40:43], s71 offen offset:8 sc1
    buffer_load_dwordx2 v[82:83], v250, s[40:43], s71 offen offset:1032 sc1
    s_waitcnt vmcnt(0)
    v_readfirstlane_b32 s53, v109
    s_cmp_gt_u32 s53, s66
    s_nop 2
    s_cbranch_scc1 L_akd43
    v_max3_u32 v110, v64, v65, v66
    v_max3_u32 v110, v110, v67, v68
    v_max3_u32 v110, v110, v69, v70
    v_max3_u32 v110, v110, v71, v72
    v_max3_u32 v110, v110, v73, v74
    v_max3_u32 v110, v110, v75, v76
    v_max3_u32 v110, v110, v77, v78
    v_max3_u32 v110, v110, v79, v80
    v_max3_u32 v110, v110, v81, v82
    v_max_u32 v110, v110, v83
    v_cmp_eq_u32 vcc, -1, v110
    s_nop 0
    s_cbranch_vccz L_akd43
    s_add_u32 s60, s60, 1
    s_cmp_gt_u32 s60, 0x40000
    s_cbranch_scc1 L_exit
    s_sleep 4
    s_branch L_akp42
L_akd43:
    v_mfma_f32_16x16x32_bf16 v[92:95], v[64:67], v[32:35], 0
    v_mfma_f32_16x16x32_bf16 v[92:95], v[68:71], v[36:39], v[92:95]
    v_mfma_f32_16x16x32_bf16 v[92:95], v[72:75], v[40:43], v[92:95]
    v_mfma_f32_16x16x32_bf16 v[92:95], v[76:79], v[44:47], v[92:95]
    s_nop 7
    v_cvt_pk_bf16_f32 v104, v92, v93
    v_lshlrev_b32 v92, 16, v104
    v_and_b32 v93, 0xffff0000, v104
    v_mul_f32 v92, s81, v92
    v_mul_f32 v93, s81, v93
    v_cvt_pk_bf16_f32 v104, v92, v93
    v_lshlrev_b32 v92, 16, v104
    v_and_b32 v93, 0xffff0000, v104
    v_max3_f32 v105, v105, v92, v93
    v_mov_b32 v107, v105
    s_nop 1
    v_permlane16_swap_b32 v105, v107
    v_max_f32 v105, v105, v107
    v_mov_b32 v107, v105
    s_nop 1
    v_permlane32_swap_b32 v105, v107
    v_max_f32 v105, v105, v107
    v_sub_f32 v84, v84, v105
    v_sub_f32 v85, v85, v105
    v_sub_f32 v86, v86, v105
    v_sub_f32 v87, v87, v105
    v_sub_f32 v88, v88, v105
    v_sub_f32 v89, v89, v105
    v_sub_f32 v90, v90, v105
    v_sub_f32 v91, v91, v105
    v_sub_f32 v92, v92, v105
    v_sub_f32 v93, v93, v105
    v_mul_f32 v84, s82, v84
    v_mul_f32 v85, s82, v85
    v_mul_f32 v86, s82, v86
    v_mul_f32 v87, s82, v87
    v_mul_f32 v88, s82, v88
    v_mul_f32 v89, s82, v89
    v_mul_f32 v90, s82, v90
    v_mul_f32 v91, s82, v91
    v_mul_f32 v92, s82, v92
    v_mul_f32 v93, s82, v93
    v_exp_f32 v84, v84
    v_exp_f32 v85, v85
    v_exp_f32 v86, v86
    v_exp_f32 v87, v87
    v_exp_f32 v88, v88
    v_exp_f32 v89, v89
    v_exp_f32 v90, v90
    v_exp_f32 v91, v91
    v_exp_f32 v92, v92
    v_exp_f32 v93, v93
    v_add_f32 v106, v84, v85
    v_add_f32 v106, v106, v86
    v_add_f32 v106, v106, v87
    v_add_f32 v106, v106, v88
    v_add_f32 v106, v106, v89
    v_add_f32 v106, v106, v90
    v_add_f32 v106, v106, v91
    v_add_f32 v106, v106, v92
    v_add_f32 v106, v106, v93
    v_mov_b32 v107, v106
    s_nop 1
    v_permlane16_swap_b32 v106, v107
    v_add_f32 v106, v106, v107
    v_mov_b32 v107, v106
    s_nop 1
    v_permlane32_swap_b32 v106, v107
    v_add_f32 v106, v106, v107
    v_rcp_f32 v106, v106
    s_nop 0
    v_mul_f32 v84, v84, v106
    v_mul_f32 v85, v85, v106
    v_mul_f32 v86, v86, v106
    v_mul_f32 v87, v87, v106
    v_mul_f32 v88, v88, v106
    v_mul_f32 v89, v89, v106
    v_mul_f32 v90, v90, v106
    v_mul_f32 v91, v91, v106
    v_mul_f32 v92, v92, v106
    v_mul_f32 v93, v93, v106
    v_cvt_pk_bf16_f32 v96, v84, v85
    v_cvt_pk_bf16_f32 v97, v86, v87
    v_cvt_pk_bf16_f32 v98, v88, v89
    v_cvt_pk_bf16_f32 v99, v90, v91
    v_cvt_pk_bf16_f32 v100, v92, v93
    v_mov_b32 v101, 0
    v_mov_b32 v102, 0
    v_mov_b32 v103, v100
    v_mfma_f32_16x16x32_bf16 v[128:131], v[48:51], v[96:99], 0
    v_mfma_f32_16x16x32_bf16 v[132:135], v[52:55], v[96:99], 0
    v_mfma_f32_16x16x32_bf16 v[136:139], v[56:59], v[96:99], 0
    v_mfma_f32_16x16x32_bf16 v[140:143], v[60:63], v[96:99], 0
    s_nop 2
    v_mfma_f32_16x16x16_bf16 v[128:131], v[80:81], v[100:101], v[128:131]
    v_mfma_f32_16x16x16_bf16 v[132:135], v[80:81], v[102:103], v[132:135]
    v_mfma_f32_16x16x16_bf16 v[136:139], v[82:83], v[100:101], v[136:139]
    v_mfma_f32_16x16x16_bf16 v[140:143], v[82:83], v[102:103], v[140:143]
    s_lshl_b32 s70, s49, 11
    v_add_u32 v104, s70, v250
    s_nop 3
    v_cvt_pk_bf16_f32 v84, v128, v132
    v_cvt_pk_bf16_f32 v85, v129, v133
    v_cvt_pk_bf16_f32 v86, v130, v134
    v_cvt_pk_bf16_f32 v87, v131, v135
    ds_write_b128 v104, v[84:87] offset:16384
    v_cvt_pk_bf16_f32 v88, v136, v140
    v_cvt_pk_bf16_f32 v89, v137, v141
    v_cvt_pk_bf16_f32 v90, v138, v142
    v_cvt_pk_bf16_f32 v91, v139, v143
    ds_write_b128 v104, v[88:91] offset:17408
    s_waitcnt lgkmcnt(0)
    s_barrier
    ds_read_b128 v[144:147], v250 offset:16384
    ds_read_b128 v[148:151], v250 offset:17408
    ds_read_b128 v[152:155], v250 offset:18432
    ds_read_b128 v[156:159], v250 offset:19456
    ds_read_b128 v[160:163], v250 offset:20480
    ds_read_b128 v[164:167], v250 offset:21504
    ds_read_b128 v[168:171], v250 offset:22528
    ds_read_b128 v[172:175], v250 offset:23552
    s_waitcnt lgkmcnt(7)
    v_mfma_f32_16x16x32_bf16 v[0:3], a[0:3], v[144:147], 0
    v_mfma_f32_16x16x32_bf16 v[8:11], a[16:19], v[144:147], 0
    v_mfma_f32_16x16x32_bf16 v[16:19], a[32:35], v[144:147], 0
    v_mfma_f32_16x16x32_bf16 v[24:27], a[48:51], v[144:147], 0
    v_mfma_f32_16x16x32_bf16 v[32:35], a[64:67], v[144:147], 0
    v_mfma_f32_16x16x32_bf16 v[40:43], a[80:83], v[144:147], 0
    v_mfma_f32_16x16x32_bf16 v[48:51], a[96:99], v[144:147], 0
    v_mfma_f32_16x16x32_bf16 v[56:59], a[112:115], v[144:147], 0
    s_waitcnt lgkmcnt(6)
    v_mfma_f32_16x16x32_bf16 v[0:3], a[4:7], v[148:151], v[0:3]
    v_mfma_f32_16x16x32_bf16 v[8:11], a[20:23], v[148:151], v[8:11]
    v_mfma_f32_16x16x32_bf16 v[16:19], a[36:39], v[148:151], v[16:19]
    v_mfma_f32_16x16x32_bf16 v[24:27], a[52:55], v[148:151], v[24:27]
    v_mfma_f32_16x16x32_bf16 v[32:35], a[68:71], v[148:151], v[32:35]
    v_mfma_f32_16x16x32_bf16 v[40:43], a[84:87], v[148:151], v[40:43]
    v_mfma_f32_16x16x32_bf16 v[48:51], a[100:103], v[148:151], v[48:51]
    v_mfma_f32_16x16x32_bf16 v[56:59], a[116:119], v[148:151], v[56:59]
    s_waitcnt lgkmcnt(5)
    v_mfma_f32_16x16x32_bf16 v[0:3], a[8:11], v[152:155], v[0:3]
    v_mfma_f32_16x16x32_bf16 v[8:11], a[24:27], v[152:155], v[8:11]
    v_mfma_f32_16x16x32_bf16 v[16:19], a[40:43], v[152:155], v[16:19]
    v_mfma_f32_16x16x32_bf16 v[24:27], a[56:59], v[152:155], v[24:27]
    v_mfma_f32_16x16x32_bf16 v[32:35], a[72:75], v[152:155], v[32:35]
    v_mfma_f32_16x16x32_bf16 v[40:43], a[88:91], v[152:155], v[40:43]
    v_mfma_f32_16x16x32_bf16 v[48:51], a[104:107], v[152:155], v[48:51]
    v_mfma_f32_16x16x32_bf16 v[56:59], a[120:123], v[152:155], v[56:59]
    s_waitcnt lgkmcnt(4)
    v_mfma_f32_16x16x32_bf16 v[0:3], a[12:15], v[156:159], v[0:3]
    v_mfma_f32_16x16x32_bf16 v[8:11], a[28:31], v[156:159], v[8:11]
    v_mfma_f32_16x16x32_bf16 v[16:19], a[44:47], v[156:159], v[16:19]
    v_mfma_f32_16x16x32_bf16 v[24:27], a[60:63], v[156:159], v[24:27]
    v_mfma_f32_16x16x32_bf16 v[32:35], a[76:79], v[156:159], v[32:35]
    v_mfma_f32_16x16x32_bf16 v[40:43], a[92:95], v[156:159], v[40:43]
    v_mfma_f32_16x16x32_bf16 v[48:51], a[108:111], v[156:159], v[48:51]
    v_mfma_f32_16x16x32_bf16 v[56:59], a[124:127], v[156:159], v[56:59]
    s_waitcnt lgkmcnt(3)
    v_mfma_f32_16x16x32_bf16 v[4:7], a[0:3], v[160:163], 0
    v_mfma_f32_16x16x32_bf16 v[12:15], a[16:19], v[160:163], 0
    v_mfma_f32_16x16x32_bf16 v[20:23], a[32:35], v[160:163], 0
    v_mfma_f32_16x16x32_bf16 v[28:31], a[48:51], v[160:163], 0
    v_mfma_f32_16x16x32_bf16 v[36:39], a[64:67], v[160:163], 0
    v_mfma_f32_16x16x32_bf16 v[44:47], a[80:83], v[160:163], 0
    v_mfma_f32_16x16x32_bf16 v[52:55], a[96:99], v[160:163], 0
    v_mfma_f32_16x16x32_bf16 v[60:63], a[112:115], v[160:163], 0
    s_waitcnt lgkmcnt(2)
    v_mfma_f32_16x16x32_bf16 v[4:7], a[4:7], v[164:167], v[4:7]
    v_mfma_f32_16x16x32_bf16 v[12:15], a[20:23], v[164:167], v[12:15]
    v_mfma_f32_16x16x32_bf16 v[20:23], a[36:39], v[164:167], v[20:23]
    v_mfma_f32_16x16x32_bf16 v[28:31], a[52:55], v[164:167], v[28:31]
    v_mfma_f32_16x16x32_bf16 v[36:39], a[68:71], v[164:167], v[36:39]
    v_mfma_f32_16x16x32_bf16 v[44:47], a[84:87], v[164:167], v[44:47]
    v_mfma_f32_16x16x32_bf16 v[52:55], a[100:103], v[164:167], v[52:55]
    v_mfma_f32_16x16x32_bf16 v[60:63], a[116:119], v[164:167], v[60:63]
    s_waitcnt lgkmcnt(1)
    v_mfma_f32_16x16x32_bf16 v[4:7], a[8:11], v[168:171], v[4:7]
    v_mfma_f32_16x16x32_bf16 v[12:15], a[24:27], v[168:171], v[12:15]
    v_mfma_f32_16x16x32_bf16 v[20:23], a[40:43], v[168:171], v[20:23]
    v_mfma_f32_16x16x32_bf16 v[28:31], a[56:59], v[168:171], v[28:31]
    v_mfma_f32_16x16x32_bf16 v[36:39], a[72:75], v[168:171], v[36:39]
    v_mfma_f32_16x16x32_bf16 v[44:47], a[88:91], v[168:171], v[44:47]
    v_mfma_f32_16x16x32_bf16 v[52:55], a[104:107], v[168:171], v[52:55]
    v_mfma_f32_16x16x32_bf16 v[60:63], a[120:123], v[168:171], v[60:63]
    s_waitcnt lgkmcnt(0)
    v_mfma_f32_16x16x32_bf16 v[4:7], a[12:15], v[172:175], v[4:7]
    v_mfma_f32_16x16x32_bf16 v[12:15], a[28:31], v[172:175], v[12:15]
    v_mfma_f32_16x16x32_bf16 v[20:23], a[44:47], v[172:175], v[20:23]
    v_mfma_f32_16x16x32_bf16 v[28:31], a[60:63], v[172:175], v[28:31]
    v_mfma_f32_16x16x32_bf16 v[36:39], a[76:79], v[172:175], v[36:39]
    v_mfma_f32_16x16x32_bf16 v[44:47], a[92:95], v[172:175], v[44:47]
    v_mfma_f32_16x16x32_bf16 v[52:55], a[108:111], v[172:175], v[52:55]
    v_mfma_f32_16x16x32_bf16 v[60:63], a[124:127], v[172:175], v[60:63]
    s_lshl_b32 s69, s66, 20
    s_lshl_b32 s70, s48, 15
    s_add_u32 s69, s69, s70
    s_add_u32 s69, s69, 0x8000000
    v_cvt_pk_bf16_f32 v64, v0, v8
    v_cvt_pk_bf16_f32 v65, v16, v24
    v_cvt_pk_bf16_f32 v66, v32, v40
    v_cvt_pk_bf16_f32 v67, v48, v56
    ds_write_b128 v248, v[64:67] offset:0
    v_cvt_pk_bf16_f32 v68, v1, v9
    v_cvt_pk_bf16_f32 v69, v17, v25
    v_cvt_pk_bf16_f32 v70, v33, v41
    v_cvt_pk_bf16_f32 v71, v49, v57
    ds_write_b128 v248, v[68:71] offset:16
    v_cvt_pk_bf16_f32 v72, v2, v10
    v_cvt_pk_bf16_f32 v73, v18, v26
    v_cvt_pk_bf16_f32 v74, v34, v42
    v_cvt_pk_bf16_f32 v75, v50, v58
    ds_write_b128 v248, v[72:75] offset:32
    v_cvt_pk_bf16_f32 v76, v3, v11
    v_cvt_pk_bf16_f32 v77, v19, v27
    v_cvt_pk_bf16_f32 v78, v35, v43
    v_cvt_pk_bf16_f32 v79, v51, v59
    ds_write_b128 v248, v[76:79] offset:48
    ds_read_b128 v[144:147], v249 offset:0
    ds_read_b128 v[148:151], v249 offset:1088
    ds_read_b128 v[152:155], v249 offset:2176
    ds_read_b128 v[156:159], v249 offset:3264
    s_add_u32 s70, s69, 0
    s_waitcnt lgkmcnt(3)
    buffer_store_dwordx4 v[144:147], v206, s[40:43], s70 offen sc1
    s_add_u32 s70, s69, 4096
    s_waitcnt lgkmcnt(2)
    buffer_store_dwordx4 v[148:151], v206, s[40:43], s70 offen sc1
    s_add_u32 s70, s69, 8192
    s_waitcnt lgkmcnt(1)
    buffer_store_dwordx4 v[152:155], v206, s[40:43], s70 offen sc1
    s_add_u32 s70, s69, 12288
    s_waitcnt lgkmcnt(0)
    buffer_store_dwordx4 v[156:159], v206, s[40:43], s70 offen sc1
    v_cvt_pk_bf16_f32 v80, v4, v12
    v_cvt_pk_bf16_f32 v81, v20, v28
    v_cvt_pk_bf16_f32 v82, v36, v44
    v_cvt_pk_bf16_f32 v83, v52, v60
    ds_write_b128 v248, v[80:83] offset:4352
    v_cvt_pk_bf16_f32 v84, v5, v13
    v_cvt_pk_bf16_f32 v85, v21, v29
    v_cvt_pk_bf16_f32 v86, v37, v45
    v_cvt_pk_bf16_f32 v87, v53, v61
    ds_write_b128 v248, v[84:87] offset:4368
    v_cvt_pk_bf16_f32 v88, v6, v14
    v_cvt_pk_bf16_f32 v89, v22, v30
    v_cvt_pk_bf16_f32 v90, v38, v46
    v_cvt_pk_bf16_f32 v91, v54, v62
    ds_write_b128 v248, v[88:91] offset:4384
    v_cvt_pk_bf16_f32 v92, v7, v15
    v_cvt_pk_bf16_f32 v93, v23, v31
    v_cvt_pk_bf16_f32 v94, v39, v47
    v_cvt_pk_bf16_f32 v95, v55, v63
    ds_write_b128 v248, v[92:95] offset:4400
    ds_read_b128 v[160:163], v249 offset:4352
    ds_read_b128 v[164:167], v249 offset:5440
    ds_read_b128 v[168:171], v249 offset:6528
    ds_read_b128 v[172:175], v249 offset:7616
    s_add_u32 s70, s69, 16384
    s_waitcnt lgkmcnt(3)
    buffer_store_dwordx4 v[160:163], v206, s[40:43], s70 offen sc1
    s_add_u32 s70, s69, 20480
    s_waitcnt lgkmcnt(2)
    buffer_store_dwordx4 v[164:167], v206, s[40:43], s70 offen sc1
    s_add_u32 s70, s69, 24576
    s_waitcnt lgkmcnt(1)
    buffer_store_dwordx4 v[168:171], v206, s[40:43], s70 offen sc1
    s_add_u32 s70, s69, 28672
    s_waitcnt lgkmcnt(0)
    buffer_store_dwordx4 v[172:175], v206, s[40:43], s70 offen sc1
    s_waitcnt vmcnt(0)
    s_barrier
    s_lshl_b32 s69, s66, 7
    s_add_u32 s69, s69, 0x205000
    s_lshl_b32 s70, s65, 12
    s_add_u32 s70, s70, 0x210000
    s_add_u32 s71, s66, 1
    s_cmp_lg_u32 s49, 0
    s_cbranch_scc1 L_anf46
    v_mov_b32 v104, 0
    v_mov_b32 v105, 1
    s_mov_b64 exec, 1
    buffer_atomic_add v105, v104, s[40:43], s69 offen sc0
    s_mov_b64 exec, -1
    s_waitcnt vmcnt(0)
    v_readfirstlane_b32 s53, v105
    s_add_u32 s53, s53, 1
    s_cmp_lg_u32 s53, 32
    s_nop 1
    s_cbranch_scc1 L_sb47
    v_lshlrev_b32 v104, 7, v125
    v_mov_b32 v105, s71
    s_mov_b32 exec_lo, 0xffffffff
    s_mov_b32 exec_hi, 0x0
    buffer_store_dword v105, v104, s[40:43], s70 offen sc1
    s_mov_b64 exec, -1
L_sb47:
L_anf46:
    s_lshl_b32 s69, s79, 7
    s_add_u32 s69, s69, 0x210000
    s_lshl_b32 s72, s66, 5
    s_add_u32 s72, s72, s48
    s_lshl_b32 s71, s72, 10
    s_mov_b32 s44, s4
    s_and_b32 s45, s5, 0xffff
    s_mov_b32 s46, 0x200000
    s_mov_b32 s47, 0x20000
    buffer_load_dwordx4 v[152:155], v250, s[44:47], s71 offen
    s_add_u32 s70, s66, 1
    s_cmp_lg_u32 s49, 0
    s_cbranch_scc1 L_wd49
    v_mov_b32 v144, 0
    s_nop 1
L_w48:
    buffer_load_dword v145, v144, s[40:43], s69 offen sc1
    s_waitcnt vmcnt(0)
    v_readfirstlane_b32 s53, v145
    s_cmp_ge_u32 s53, s70
    s_nop 2
    s_cbranch_scc1 L_wd49
    s_add_u32 s60, s60, 1
    s_cmp_gt_u32 s60, 0x40000
    s_cbranch_scc1 L_exit
    s_sleep 1
    s_branch L_w48
L_wd49:
    s_waitcnt vmcnt(0)
    s_barrier
    s_lshl_b32 s69, s66, 20
    s_lshl_b32 s70, s49, 18
    s_add_u32 s69, s69, s70
    s_lshl_b32 s70, s48, 10
    s_add_u32 s69, s69, s70
    s_add_u32 s69, s69, 0x8000000
    buffer_load_dwordx4 v[0:3], v250, s[40:43], s69 offen
    s_add_u32 s69, s69, 0x8000
    buffer_load_dwordx4 v[4:7], v250, s[40:43], s69 offen
    s_add_u32 s69, s69, 0x8000
    buffer_load_dwordx4 v[8:11], v250, s[40:43], s69 offen
    s_add_u32 s69, s69, 0x8000
    buffer_load_dwordx4 v[12:15], v250, s[40:43], s69 offen
    s_add_u32 s69, s69, 0x8000
    buffer_load_dwordx4 v[16:19], v250, s[40:43], s69 offen
    s_add_u32 s69, s69, 0x8000
    buffer_load_dwordx4 v[20:23], v250, s[40:43], s69 offen
    s_add_u32 s69, s69, 0x8000
    buffer_load_dwordx4 v[24:27], v250, s[40:43], s69 offen
    s_add_u32 s69, s69, 0x8000
    buffer_load_dwordx4 v[28:31], v250, s[40:43], s69 offen
    s_waitcnt vmcnt(7)
    v_and_b32 v129, 0xffff0000, v0
    v_lshlrev_b32 v128, 16, v0
    v_and_b32 v131, 0xffff0000, v1
    v_lshlrev_b32 v130, 16, v1
    v_and_b32 v133, 0xffff0000, v2
    v_lshlrev_b32 v132, 16, v2
    v_and_b32 v135, 0xffff0000, v3
    v_lshlrev_b32 v134, 16, v3
    s_waitcnt vmcnt(6)
    v_dot2c_f32_bf16 v128, s83, v4
    v_dot2c_f32_bf16 v129, s84, v4
    v_dot2c_f32_bf16 v130, s83, v5
    v_dot2c_f32_bf16 v131, s84, v5
    v_dot2c_f32_bf16 v132, s83, v6
    v_dot2c_f32_bf16 v133, s84, v6
    v_dot2c_f32_bf16 v134, s83, v7
    v_dot2c_f32_bf16 v135, s84, v7
    s_waitcnt vmcnt(5)
    v_dot2c_f32_bf16 v128, s83, v8
    v_dot2c_f32_bf16 v129, s84, v8
    v_dot2c_f32_bf16 v130, s83, v9
    v_dot2c_f32_bf16 v131, s84, v9
    v_dot2c_f32_bf16 v132, s83, v10
    v_dot2c_f32_bf16 v133, s84, v10
    v_dot2c_f32_bf16 v134, s83, v11
    v_dot2c_f32_bf16 v135, s84, v11
    s_waitcnt vmcnt(4)
    v_dot2c_f32_bf16 v128, s83, v12
    v_dot2c_f32_bf16 v129, s84, v12
    v_dot2c_f32_bf16 v130, s83, v13
    v_dot2c_f32_bf16 v131, s84, v13
    v_dot2c_f32_bf16 v132, s83, v14
    v_dot2c_f32_bf16 v133, s84, v14
    v_dot2c_f32_bf16 v134, s83, v15
    v_dot2c_f32_bf16 v135, s84, v15
    s_waitcnt vmcnt(3)
    v_dot2c_f32_bf16 v128, s83, v16
    v_dot2c_f32_bf16 v129, s84, v16
    v_dot2c_f32_bf16 v130, s83, v17
    v_dot2c_f32_bf16 v131, s84, v17
    v_dot2c_f32_bf16 v132, s83, v18
    v_dot2c_f32_bf16 v133, s84, v18
    v_dot2c_f32_bf16 v134, s83, v19
    v_dot2c_f32_bf16 v135, s84, v19
    s_waitcnt vmcnt(2)
    v_dot2c_f32_bf16 v128, s83, v20
    v_dot2c_f32_bf16 v129, s84, v20
    v_dot2c_f32_bf16 v130, s83, v21
    v_dot2c_f32_bf16 v131, s84, v21
    v_dot2c_f32_bf16 v132, s83, v22
    v_dot2c_f32_bf16 v133, s84, v22
    v_dot2c_f32_bf16 v134, s83, v23
    v_dot2c_f32_bf16 v135, s84, v23
    s_waitcnt vmcnt(1)
    v_dot2c_f32_bf16 v128, s83, v24
    v_dot2c_f32_bf16 v129, s84, v24
    v_dot2c_f32_bf16 v130, s83, v25
    v_dot2c_f32_bf16 v131, s84, v25
    v_dot2c_f32_bf16 v132, s83, v26
    v_dot2c_f32_bf16 v133, s84, v26
    v_dot2c_f32_bf16 v134, s83, v27
    v_dot2c_f32_bf16 v135, s84, v27
    s_waitcnt vmcnt(0)
    v_dot2c_f32_bf16 v128, s83, v28
    v_dot2c_f32_bf16 v129, s84, v28
    v_dot2c_f32_bf16 v130, s83, v29
    v_dot2c_f32_bf16 v131, s84, v29
    v_dot2c_f32_bf16 v132, s83, v30
    v_dot2c_f32_bf16 v133, s84, v30
    v_dot2c_f32_bf16 v134, s83, v31
    v_dot2c_f32_bf16 v135, s84, v31
    s_nop 3
    s_lshl_b32 s70, s49, 11
    v_add_u32 v144, s70, v250
    ds_write_b128 v144, v[128:131] offset:24576
    ds_write_b128 v144, v[132:135] offset:25600
    s_waitcnt lgkmcnt(0)
    s_barrier
    s_cmp_lg_u32 s49, 0
    s_cbranch_scc1 L_rdone50
    ds_read_b128 v[0:3], v250 offset:24576
    ds_read_b128 v[4:7], v250 offset:25600
    ds_read_b128 v[8:11], v250 offset:26624
    ds_read_b128 v[12:15], v250 offset:27648
    ds_read_b128 v[16:19], v250 offset:28672
    ds_read_b128 v[20:23], v250 offset:29696
    ds_read_b128 v[24:27], v250 offset:30720
    ds_read_b128 v[28:31], v250 offset:31744
    s_waitcnt lgkmcnt(5)
    v_add_f32 v0, v0, v8
    s_waitcnt lgkmcnt(1)
    v_add_f32 v16, v16, v24
    v_add_f32 v1, v1, v9
    v_add_f32 v17, v17, v25
    v_add_f32 v2, v2, v10
    v_add_f32 v18, v18, v26
    v_add_f32 v3, v3, v11
    v_add_f32 v19, v19, v27
    v_add_f32 v4, v4, v12
    s_waitcnt lgkmcnt(0)
    v_add_f32 v20, v20, v28
    v_add_f32 v5, v5, v13
    v_add_f32 v21, v21, v29
    v_add_f32 v6, v6, v14
    v_add_f32 v22, v22, v30
    v_add_f32 v7, v7, v15
    v_add_f32 v23, v23, v31
    v_add_f32 v128, v0, v16
    v_add_f32 v129, v1, v17
    v_add_f32 v130, v2, v18
    v_add_f32 v131, v3, v19
    v_add_f32 v132, v4, v20
    v_add_f32 v133, v5, v21
    v_add_f32 v134, v6, v22
    v_add_f32 v135, v7, v23
    v_cvt_pk_bf16_f32 v144, v128, v129
    v_lshlrev_b32 v128, 16, v144
    v_and_b32 v129, 0xffff0000, v144
    v_cvt_pk_bf16_f32 v144, v130, v131
    v_lshlrev_b32 v130, 16, v144
    v_and_b32 v131, 0xffff0000, v144
    v_cvt_pk_bf16_f32 v144, v132, v133
    v_lshlrev_b32 v132, 16, v144
    v_and_b32 v133, 0xffff0000, v144
    v_cvt_pk_bf16_f32 v144, v134, v135
    v_lshlrev_b32 v134, 16, v144
    v_and_b32 v135, 0xffff0000, v144
    v_mul_f32 v128, v128, v208
    v_mul_f32 v129, v129, v209
    v_mul_f32 v130, v130, v210
    v_mul_f32 v131, v131, v211
    v_mul_f32 v132, v132, v212
    v_mul_f32 v133, v133, v213
    v_mul_f32 v134, v134, v214
    v_mul_f32 v135, v135, v215
    v_cvt_pk_bf16_f32 v144, v128, v129
    v_lshlrev_b32 v128, 16, v144
    v_and_b32 v129, 0xffff0000, v144
    v_cvt_pk_bf16_f32 v144, v130, v131
    v_lshlrev_b32 v130, 16, v144
    v_and_b32 v131, 0xffff0000, v144
    v_cvt_pk_bf16_f32 v144, v132, v133
    v_lshlrev_b32 v132, 16, v144
    v_and_b32 v133, 0xffff0000, v144
    v_cvt_pk_bf16_f32 v144, v134, v135
    v_lshlrev_b32 v134, 16, v144
    v_and_b32 v135, 0xffff0000, v144
    v_and_b32 v137, 0xffff0000, v152
    v_lshlrev_b32 v136, 16, v152
    v_and_b32 v139, 0xffff0000, v153
    v_lshlrev_b32 v138, 16, v153
    v_and_b32 v141, 0xffff0000, v154
    v_lshlrev_b32 v140, 16, v154
    v_and_b32 v143, 0xffff0000, v155
    v_lshlrev_b32 v142, 16, v155
    v_add_f32 v136, v136, v128
    v_add_f32 v137, v137, v129
    v_add_f32 v138, v138, v130
    v_add_f32 v139, v139, v131
    v_add_f32 v140, v140, v132
    v_add_f32 v141, v141, v133
    v_add_f32 v142, v142, v134
    v_add_f32 v143, v143, v135
    v_cvt_pk_bf16_f32 v148, v136, v137
    v_cvt_pk_bf16_f32 v149, v138, v139
    v_cvt_pk_bf16_f32 v150, v140, v141
    v_cvt_pk_bf16_f32 v151, v142, v143
    v_and_b32 v137, 0xffff0000, v148
    v_lshlrev_b32 v136, 16, v148
    v_and_b32 v139, 0xffff0000, v149
    v_lshlrev_b32 v138, 16, v149
    v_and_b32 v141, 0xffff0000, v150
    v_lshlrev_b32 v140, 16, v150
    v_and_b32 v143, 0xffff0000, v151
    v_lshlrev_b32 v142, 16, v151
    s_add_u32 s70, s71, 0x600000
    buffer_store_dwordx4 v[148:151], v250, s[40:43], s70 offen sc1
    v_mov_b32 v128, v136
    v_mov_b32 v129, v137
    v_mov_b32 v130, v138
    v_mov_b32 v131, v139
    v_mov_b32 v132, v140
    v_mov_b32 v133, v141
    v_mov_b32 v134, v142
    v_mov_b32 v135, v143
    v_add_f32 v144, v128, v129
    v_add_f32 v144, v144, v130
    v_add_f32 v144, v144, v131
    v_add_f32 v144, v144, v132
    v_add_f32 v144, v144, v133
    v_add_f32 v144, v144, v134
    v_add_f32 v144, v144, v135
    s_nop 1
    v_add_f32_dpp v144, v144, v144 row_ror:8 row_mask:0xf bank_mask:0xf
    s_nop 1
    v_add_f32_dpp v144, v144, v144 row_ror:4 row_mask:0xf bank_mask:0xf
    s_nop 1
    v_add_f32_dpp v144, v144, v144 row_ror:2 row_mask:0xf bank_mask:0xf
    s_nop 1
    v_add_f32_dpp v144, v144, v144 row_ror:1 row_mask:0xf bank_mask:0xf
    v_mov_b32 v145, v144
    s_nop 1
    v_permlane16_swap_b32 v144, v145
    v_add_f32 v144, v144, v145
    v_mov_b32 v145, v144
    s_nop 1
    v_permlane32_swap_b32 v144, v145
    v_add_f32 v144, v144, v145
    v_mul_f32 v144, 0x3b000000, v144
    v_sub_f32 v146, v128, v144
    v_mul_f32 v147, v146, v146
    v_sub_f32 v146, v129, v144
    v_fmac_f32 v147, v146, v146
    v_sub_f32 v146, v130, v144
    v_fmac_f32 v147, v146, v146
    v_sub_f32 v146, v131, v144
    v_fmac_f32 v147, v146, v146
    v_sub_f32 v146, v132, v144
    v_fmac_f32 v147, v146, v146
    v_sub_f32 v146, v133, v144
    v_fmac_f32 v147, v146, v146
    v_sub_f32 v146, v134, v144
    v_fmac_f32 v147, v146, v146
    v_sub_f32 v146, v135, v144
    v_fmac_f32 v147, v146, v146
    s_nop 1
    v_add_f32_dpp v147, v147, v147 row_ror:8 row_mask:0xf bank_mask:0xf
    s_nop 1
    v_add_f32_dpp v147, v147, v147 row_ror:4 row_mask:0xf bank_mask:0xf
    s_nop 1
    v_add_f32_dpp v147, v147, v147 row_ror:2 row_mask:0xf bank_mask:0xf
    s_nop 1
    v_add_f32_dpp v147, v147, v147 row_ror:1 row_mask:0xf bank_mask:0xf
    v_mov_b32 v145, v147
    s_nop 1
    v_permlane16_swap_b32 v147, v145
    v_add_f32 v147, v147, v145
    v_mov_b32 v145, v147
    s_nop 1
    v_permlane32_swap_b32 v147, v145
    v_add_f32 v147, v147, v145
    v_mul_f32 v147, 0x3b000000, v147
    v_cvt_pk_bf16_f32 v145, v144, v147
    v_lshlrev_b32 v144, 16, v145
    v_and_b32 v147, 0xffff0000, v145
    v_add_f32 v147, 0x3727c5ac, v147
    v_cvt_pk_bf16_f32 v145, v147, v147
    v_lshlrev_b32 v147, 16, v145
    v_sqrt_f32 v147, v147
    s_nop 0
    v_cvt_pk_bf16_f32 v145, v147, v147
    v_lshlrev_b32 v147, 16, v145
    v_rcp_f32 v147, v147
    v_sub_f32 v128, v128, v144
    v_sub_f32 v129, v129, v144
    v_sub_f32 v130, v130, v144
    v_sub_f32 v131, v131, v144
    v_sub_f32 v132, v132, v144
    v_sub_f32 v133, v133, v144
    v_sub_f32 v134, v134, v144
    v_sub_f32 v135, v135, v144
    v_cvt_pk_bf16_f32 v145, v128, v129
    v_lshlrev_b32 v128, 16, v145
    v_and_b32 v129, 0xffff0000, v145
    v_cvt_pk_bf16_f32 v145, v130, v131
    v_lshlrev_b32 v130, 16, v145
    v_and_b32 v131, 0xffff0000, v145
    v_cvt_pk_bf16_f32 v145, v132, v133
    v_lshlrev_b32 v132, 16, v145
    v_and_b32 v133, 0xffff0000, v145
    v_cvt_pk_bf16_f32 v145, v134, v135
    v_lshlrev_b32 v134, 16, v145
    v_and_b32 v135, 0xffff0000, v145
    v_mul_f32 v128, v128, v147
    v_mul_f32 v129, v129, v147
    v_mul_f32 v130, v130, v147
    v_mul_f32 v131, v131, v147
    v_mul_f32 v132, v132, v147
    v_mul_f32 v133, v133, v147
    v_mul_f32 v134, v134, v147
    v_mul_f32 v135, v135, v147
    v_cvt_pk_bf16_f32 v145, v128, v129
    v_lshlrev_b32 v128, 16, v145
    v_and_b32 v129, 0xffff0000, v145
    v_cvt_pk_bf16_f32 v145, v130, v131
    v_lshlrev_b32 v130, 16, v145
    v_and_b32 v131, 0xffff0000, v145
    v_cvt_pk_bf16_f32 v145, v132, v133
    v_lshlrev_b32 v132, 16, v145
    v_and_b32 v133, 0xffff0000, v145
    v_cvt_pk_bf16_f32 v145, v134, v135
    v_lshlrev_b32 v134, 16, v145
    v_and_b32 v135, 0xffff0000, v145
    v_mul_f32 v128, v128, v216
    v_mul_f32 v129, v129, v217
    v_mul_f32 v130, v130, v218
    v_mul_f32 v131, v131, v219
    v_mul_f32 v132, v132, v220
    v_mul_f32 v133, v133, v221
    v_mul_f32 v134, v134, v222
    v_mul_f32 v135, v135, v223
    v_cvt_pk_bf16_f32 v144, v128, v129
    v_lshlrev_b32 v128, 16, v144
    v_and_b32 v129, 0xffff0000, v144
    v_cvt_pk_bf16_f32 v144, v130, v131
    v_lshlrev_b32 v130, 16, v144
    v_and_b32 v131, 0xffff0000, v144
    v_cvt_pk_bf16_f32 v144, v132, v133
    v_lshlrev_b32 v132, 16, v144
    v_and_b32 v133, 0xffff0000, v144
    v_cvt_pk_bf16_f32 v144, v134, v135
    v_lshlrev_b32 v134, 16, v144
    v_and_b32 v135, 0xffff0000, v144
    v_add_f32 v128, v128, v224
    v_add_f32 v129, v129, v225
    v_add_f32 v130, v130, v226
    v_add_f32 v131, v131, v227
    v_add_f32 v132, v132, v228
    v_add_f32 v133, v133, v229
    v_add_f32 v134, v134, v230
    v_add_f32 v135, v135, v231
    v_cvt_pk_bf16_f32 v160, v128, v129
    v_cvt_pk_bf16_f32 v161, v130, v131
    v_cvt_pk_bf16_f32 v162, v132, v133
    v_cvt_pk_bf16_f32 v163, v134, v135
    v_and_b32 v129, 0xffff0000, v160
    v_lshlrev_b32 v128, 16, v160
    v_and_b32 v131, 0xffff0000, v161
    v_lshlrev_b32 v130, 16, v161
    v_and_b32 v133, 0xffff0000, v162
    v_lshlrev_b32 v132, 16, v162
    v_and_b32 v135, 0xffff0000, v163
    v_lshlrev_b32 v134, 16, v163
    s_add_u32 s70, s71, 0x800000
    buffer_store_dwordx4 v[160:163], v250, s[40:43], s70 offen sc1
    v_mul_f32 v144, v128, v240
    v_fmac_f32 v144, v129, v241
    v_fmac_f32 v144, v130, v242
    v_fmac_f32 v144, v131, v243
    v_fmac_f32 v144, v132, v244
    v_fmac_f32 v144, v133, v245
    v_fmac_f32 v144, v134, v246
    v_fmac_f32 v144, v135, v247
    s_nop 1
    v_add_f32_dpp v144, v144, v144 row_ror:8 row_mask:0xf bank_mask:0xf
    s_nop 1
    v_add_f32_dpp v144, v144, v144 row_ror:4 row_mask:0xf bank_mask:0xf
    s_nop 1
    v_add_f32_dpp v144, v144, v144 row_ror:2 row_mask:0xf bank_mask:0xf
    s_nop 1
    v_add_f32_dpp v144, v144, v144 row_ror:1 row_mask:0xf bank_mask:0xf
    v_mov_b32 v145, v144
    s_nop 1
    v_permlane16_swap_b32 v144, v145
    v_add_f32 v144, v144, v145
    v_mov_b32 v145, v144
    s_nop 1
    v_permlane32_swap_b32 v144, v145
    v_add_f32 v144, v144, v145
    v_cvt_pk_bf16_f32 v145, v144, v144
    v_lshlrev_b32 v146, 16, v145
    v_ashrrev_i32 v147, 31, v146
    v_or_b32 v147, 0x80000000, v147
    v_xor_b32 v147, v147, v146
    v_and_b32 v147, 0xffff0000, v147
    s_sub_u32 s70, 2047, s72
    v_or_b32 v147, s70, v147
    v_mov_b32 v145, 0
    s_lshl_b32 s70, s72, 2
    s_add_u32 s70, s70, 0x230000
    s_mov_b64 exec, 1
    buffer_store_dword v147, v145, s[40:43], s70 offen sc1
    s_mov_b64 exec, -1
    v_mul_f32 v128, v128, v232
    v_mul_f32 v129, v129, v233
    v_mul_f32 v130, v130, v234
    v_mul_f32 v131, v131, v235
    v_mul_f32 v132, v132, v236
    v_mul_f32 v133, v133, v237
    v_mul_f32 v134, v134, v238
    v_mul_f32 v135, v135, v239
    v_cvt_pk_bf16_f32 v145, v128, v129
    v_lshlrev_b32 v128, 16, v145
    v_and_b32 v129, 0xffff0000, v145
    v_cvt_pk_bf16_f32 v145, v130, v131
    v_lshlrev_b32 v130, 16, v145
    v_and_b32 v131, 0xffff0000, v145
    v_cvt_pk_bf16_f32 v145, v132, v133
    v_lshlrev_b32 v132, 16, v145
    v_and_b32 v133, 0xffff0000, v145
    v_cvt_pk_bf16_f32 v145, v134, v135
    v_lshlrev_b32 v134, 16, v145
    v_and_b32 v135, 0xffff0000, v145
    v_add_f32 v128, v128, v136
    v_add_f32 v129, v129, v137
    v_add_f32 v130, v130, v138
    v_add_f32 v131, v131, v139
    v_add_f32 v132, v132, v140
    v_add_f32 v133, v133, v141
    v_add_f32 v134, v134, v142
    v_add_f32 v135, v135, v143
    v_cvt_pk_bf16_f32 v152, v128, v129
    v_cvt_pk_bf16_f32 v153, v130, v131
    v_cvt_pk_bf16_f32 v154, v132, v133
    v_cvt_pk_bf16_f32 v155, v134, v135
    s_mov_b32 s44, s32
    s_and_b32 s45, s33, 0xffff
    s_mov_b32 s46, 0x200000
    s_mov_b32 s47, 0x20000
    buffer_store_dwordx4 v[152:155], v250, s[44:47], s71 offen sc1
    s_waitcnt vmcnt(0)
    s_sub_u32 s71, s66, 52
    s_lshl_b32 s70, s71, 8
    s_add_u32 s70, s70, 0x20a000
    s_lshl_b32 s71, s71, 2
    s_add_u32 s71, s71, 0x21a000
    s_mov_b32 s72, 32
    s_cmp_lt_u32 s66, 52
    s_cselect_b32 s70, 0x208300, s70
    s_cselect_b32 s71, 0x218000, s71
    s_cselect_b32 s72, 1664, s72
    v_mov_b32 v144, 0
    v_mov_b32 v145, 1
    s_mov_b64 exec, 1
    buffer_atomic_add v145, v144, s[40:43], s70 offen sc0
    s_mov_b64 exec, -1
    s_waitcnt vmcnt(0)
    v_readfirstlane_b32 s53, v145
    s_add_u32 s53, s53, 1
    s_cmp_lg_u32 s53, s72
    s_nop 1
    s_cbranch_scc1 L_sb51
    v_lshlrev_b32 v144, 7, v125
    v_mov_b32 v145, 1
    s_mov_b32 exec_lo, 0xffffffff
    s_mov_b32 exec_hi, 0x7ff
    buffer_store_dword v145, v144, s[40:43], s71 offen sc1
    s_mov_b64 exec, -1
L_sb51:
L_rdone50:
    s_add_u32 s67, s67, 1
    s_add_u32 s66, s66, 5
    s_cmp_lt_u32 s66, 64
    s_cbranch_scc1 L_atop40
L_aend37:
    s_cmp_ge_u32 s85, 43
    s_cbranch_scc1 L_fdone52
    s_lshl_b32 s68, s85, 7
    s_add_u32 s68, s68, 0x218000
    s_cmp_lg_u32 s49, 0
    s_cbranch_scc1 L_wd57
    v_mov_b32 v40, 0
    s_nop 1
L_w56:
    buffer_load_dword v41, v40, s[40:43], s68 offen sc1
    s_waitcnt vmcnt(0)
    v_readfirstlane_b32 s53, v41
    s_cmp_ge_u32 s53, 1
    s_nop 2
    s_cbranch_scc1 L_wd57
    s_add_u32 s60, s60, 1
    s_cmp_gt_u32 s60, 0x40000
    s_cbranch_scc1 L_exit
    s_sleep 32
    s_branch L_w56
L_wd57:
    s_waitcnt vmcnt(0)
    s_barrier
    s_mov_b32 s68, 0x230000
    s_mov_b32 s69, 0x231000
    v_mov_b32 v24, 0
    v_mov_b32 v25, 0
    v_mov_b32 v26, 0
    v_mov_b32 v27, 0
    buffer_load_dwordx4 v[0:3], v250, s[40:43], s68 offen offset:0 sc1
    buffer_load_dwordx4 v[4:7], v250, s[40:43], s68 offen offset:1024 sc1
    buffer_load_dwordx4 v[8:11], v250, s[40:43], s68 offen offset:2048 sc1
    buffer_load_dwordx4 v[12:15], v250, s[40:43], s68 offen offset:3072 sc1
    buffer_load_dwordx4 v[16:19], v250, s[40:43], s69 offen offset:0 sc1
    buffer_load_dwordx4 v[20:23], v250, s[40:43], s69 offen offset:1024 sc1
    s_mov_b32 exec_hi, 0
    buffer_load_dwordx4 v[24:27], v250, s[40:43], s69 offen offset:2048 sc1
    s_mov_b64 exec, -1
    s_waitcnt vmcnt(6)
    v_max_u32 v40, v0, v1
    v_max3_u32 v40, v40, v2, v3
    s_waitcnt vmcnt(5)
    v_max3_u32 v40, v40, v4, v5
    v_max3_u32 v40, v40, v6, v7
    s_waitcnt vmcnt(4)
    v_max3_u32 v40, v40, v8, v9
    v_max3_u32 v40, v40, v10, v11
    s_waitcnt vmcnt(3)
    v_max3_u32 v40, v40, v12, v13
    v_max3_u32 v40, v40, v14, v15
    s_waitcnt vmcnt(2)
    v_max3_u32 v40, v40, v16, v17
    v_max3_u32 v40, v40, v18, v19
    s_waitcnt vmcnt(1)
    v_max3_u32 v40, v40, v20, v21
    v_max3_u32 v40, v40, v22, v23
    s_waitcnt vmcnt(0)
    v_max3_u32 v40, v40, v24, v25
    v_max3_u32 v40, v40, v26, v27
    s_nop 1
    v_max_u32_dpp v40, v40, v40 row_ror:8 row_mask:0xf bank_mask:0xf
    s_nop 1
    v_max_u32_dpp v40, v40, v40 row_ror:4 row_mask:0xf bank_mask:0xf
    s_nop 1
    v_max_u32_dpp v40, v40, v40 row_ror:2 row_mask:0xf bank_mask:0xf
    s_nop 1
    v_max_u32_dpp v40, v40, v40 row_ror:1 row_mask:0xf bank_mask:0xf
    v_mov_b32 v41, v40
    s_nop 1
    v_permlane16_swap_b32 v40, v41
    v_max_u32 v40, v40, v41
    v_mov_b32 v41, v40
    s_nop 1
    v_permlane32_swap_b32 v40, v41
    v_max_u32 v40, v40, v41
    s_nop 0
    v_readfirstlane_b32 s70, v40
    s_nop 1
    v_cmp_eq_u32 vcc, s70, v0
    s_nop 1
    v_cndmask_b32 v0, v0, 0, vcc
    v_cmp_eq_u32 vcc, s70, v1
    s_nop 1
    v_cndmask_b32 v1, v1, 0, vcc
    v_cmp_eq_u32 vcc, s70, v2
    s_nop 1
    v_cndmask_b32 v2, v2, 0, vcc
    v_cmp_eq_u32 vcc, s70, v3
    s_nop 1
    v_cndmask_b32 v3, v3, 0, vcc
    v_cmp_eq_u32 vcc, s70, v4
    s_nop 1
    v_cndmask_b32 v4, v4, 0, vcc
    v_cmp_eq_u32 vcc, s70, v5
    s_nop 1
    v_cndmask_b32 v5, v5, 0, vcc
    v_cmp_eq_u32 vcc, s70, v6
    s_nop 1
    v_cndmask_b32 v6, v6, 0, vcc
    v_cmp_eq_u32 vcc, s70, v7
    s_nop 1
    v_cndmask_b32 v7, v7, 0, vcc
    v_cmp_eq_u32 vcc, s70, v8
    s_nop 1
    v_cndmask_b32 v8, v8, 0, vcc
    v_cmp_eq_u32 vcc, s70, v9
    s_nop 1
    v_cndmask_b32 v9, v9, 0, vcc
    v_cmp_eq_u32 vcc, s70, v10
    s_nop 1
    v_cndmask_b32 v10, v10, 0, vcc
    v_cmp_eq_u32 vcc, s70, v11
    s_nop 1
    v_cndmask_b32 v11, v11, 0, vcc
    v_cmp_eq_u32 vcc, s70, v12
    s_nop 1
    v_cndmask_b32 v12, v12, 0, vcc
    v_cmp_eq_u32 vcc, s70, v13
    s_nop 1
    v_cndmask_b32 v13, v13, 0, vcc
    v_cmp_eq_u32 vcc, s70, v14
    s_nop 1
    v_cndmask_b32 v14, v14, 0, vcc
    v_cmp_eq_u32 vcc, s70, v15
    s_nop 1
    v_cndmask_b32 v15, v15, 0, vcc
    v_cmp_eq_u32 vcc, s70, v16
    s_nop 1
    v_cndmask_b32 v16, v16, 0, vcc
    v_cmp_eq_u32 vcc, s70, v17
    s_nop 1
    v_cndmask_b32 v17, v17, 0, vcc
    v_cmp_eq_u32 vcc, s70, v18
    s_nop 1
    v_cndmask_b32 v18, v18, 0, vcc
    v_cmp_eq_u32 vcc, s70, v19
    s_nop 1
    v_cndmask_b32 v19, v19, 0, vcc
    v_cmp_eq_u32 vcc, s70, v20
    s_nop 1
    v_cndmask_b32 v20, v20, 0, vcc
    v_cmp_eq_u32 vcc, s70, v21
    s_nop 1
    v_cndmask_b32 v21, v21, 0, vcc
    v_cmp_eq_u32 vcc, s70, v22
    s_nop 1
    v_cndmask_b32 v22, v22, 0, vcc
    v_cmp_eq_u32 vcc, s70, v23
    s_nop 1
    v_cndmask_b32 v23, v23, 0, vcc
    v_cmp_eq_u32 vcc, s70, v24
    s_nop 1
    v_cndmask_b32 v24, v24, 0, vcc
    v_cmp_eq_u32 vcc, s70, v25
    s_nop 1
    v_cndmask_b32 v25, v25, 0, vcc
    v_cmp_eq_u32 vcc, s70, v26
    s_nop 1
    v_cndmask_b32 v26, v26, 0, vcc
    v_cmp_eq_u32 vcc, s70, v27
    s_nop 1
    v_cndmask_b32 v27, v27, 0, vcc
    v_max_u32 v40, v0, v1
    v_max3_u32 v40, v40, v2, v3
    v_max3_u32 v40, v40, v4, v5
    v_max3_u32 v40, v40, v6, v7
    v_max3_u32 v40, v40, v8, v9
    v_max3_u32 v40, v40, v10, v11
    v_max3_u32 v40, v40, v12, v13
    v_max3_u32 v40, v40, v14, v15
    v_max3_u32 v40, v40, v16, v17
    v_max3_u32 v40, v40, v18, v19
    v_max3_u32 v40, v40, v20, v21
    v_max3_u32 v40, v40, v22, v23
    v_max3_u32 v40, v40, v24, v25
    v_max3_u32 v40, v40, v26, v27
    s_nop 1
    v_max_u32_dpp v40, v40, v40 row_ror:8 row_mask:0xf bank_mask:0xf
    s_nop 1
    v_max_u32_dpp v40, v40, v40 row_ror:4 row_mask:0xf bank_mask:0xf
    s_nop 1
    v_max_u32_dpp v40, v40, v40 row_ror:2 row_mask:0xf bank_mask:0xf
    s_nop 1
    v_max_u32_dpp v40, v40, v40 row_ror:1 row_mask:0xf bank_mask:0xf
    v_mov_b32 v41, v40
    s_nop 1
    v_permlane16_swap_b32 v40, v41
    v_max_u32 v40, v40, v41
    v_mov_b32 v41, v40
    s_nop 1
    v_permlane32_swap_b32 v40, v41
    v_max_u32 v40, v40, v41
    s_nop 0
    v_readfirstlane_b32 s71, v40
    s_mov_b32 s94, s70
    s_mov_b32 s95, s71
    s_mov_b32 s90, 0x240000
    s_and_b32 s72, s70, 0x7ff
    s_sub_u32 s72, 2047, s72
    s_and_b32 s73, s71, 0x7ff
    s_sub_u32 s73, 2047, s73
    v_mov_b32 v40, s72
    v_mov_b32 v41, s73
    v_and_b32 v42, 1, v125
    v_cmp_eq_u32 vcc, 1, v42
    s_nop 1
    v_cndmask_b32 v40, v40, v41, vcc
    v_lshlrev_b32 v40, 10, v40
    v_lshrrev_b32 v41, 4, v125
    v_lshl_add_u32 v40, v41, 4, v40
    s_lshr_b32 s68, s49, 1
    s_lshl_b32 s68, s68, 9
    s_add_u32 s68, s68, 0x800000
    buffer_load_dwordx4 v[48:51], v40, s[40:43], s68 offen offset:0 sc1
    buffer_load_dwordx4 v[52:55], v40, s[40:43], s68 offen offset:64 sc1
    buffer_load_dwordx4 v[56:59], v40, s[40:43], s68 offen offset:128 sc1
    buffer_load_dwordx4 v[60:63], v40, s[40:43], s68 offen offset:192 sc1
    buffer_load_dwordx4 v[64:67], v40, s[40:43], s68 offen offset:256 sc1
    buffer_load_dwordx4 v[68:71], v40, s[40:43], s68 offen offset:320 sc1
    buffer_load_dwordx4 v[72:75], v40, s[40:43], s68 offen offset:384 sc1
    buffer_load_dwordx4 v[76:79], v40, s[40:43], s68 offen offset:448 sc1
    s_waitcnt vmcnt(7)
    v_mfma_f32_16x16x32_bf16 v[80:83], a[128:131], v[48:51], 0
    v_mfma_f32_16x16x32_bf16 v[84:87], a[160:163], v[48:51], 0
    s_waitcnt vmcnt(6)
    v_mfma_f32_16x16x32_bf16 v[80:83], a[132:135], v[52:55], v[80:83]
    v_mfma_f32_16x16x32_bf16 v[84:87], a[164:167], v[52:55], v[84:87]
    s_waitcnt vmcnt(5)
    v_mfma_f32_16x16x32_bf16 v[80:83], a[136:139], v[56:59], v[80:83]
    v_mfma_f32_16x16x32_bf16 v[84:87], a[168:171], v[56:59], v[84:87]
    s_waitcnt vmcnt(4)
    v_mfma_f32_16x16x32_bf16 v[80:83], a[140:143], v[60:63], v[80:83]
    v_mfma_f32_16x16x32_bf16 v[84:87], a[172:175], v[60:63], v[84:87]
    s_waitcnt vmcnt(3)
    v_mfma_f32_16x16x32_bf16 v[80:83], a[144:147], v[64:67], v[80:83]
    v_mfma_f32_16x16x32_bf16 v[84:87], a[176:179], v[64:67], v[84:87]
    s_waitcnt vmcnt(2)
    v_mfma_f32_16x16x32_bf16 v[80:83], a[148:151], v[68:71], v[80:83]
    v_mfma_f32_16x16x32_bf16 v[84:87], a[180:183], v[68:71], v[84:87]
    s_waitcnt vmcnt(1)
    v_mfma_f32_16x16x32_bf16 v[80:83], a[152:155], v[72:75], v[80:83]
    v_mfma_f32_16x16x32_bf16 v[84:87], a[184:187], v[72:75], v[84:87]
    s_waitcnt vmcnt(0)
    v_mfma_f32_16x16x32_bf16 v[80:83], a[156:159], v[76:79], v[80:83]
    v_mfma_f32_16x16x32_bf16 v[84:87], a[188:191], v[76:79], v[84:87]
    s_lshl_b32 s68, s49, 11
    v_add_u32 v40, s68, v250
    s_nop 4
    ds_write_b128 v40, v[80:83] offset:1024
    ds_write_b128 v40, v[84:87] offset:2048
    s_waitcnt lgkmcnt(0)
    s_barrier
    ds_read_b128 v[160:163], v250 offset:1024
    ds_read_b128 v[164:167], v250 offset:2048
    ds_read_b128 v[168:171], v250 offset:3072
    ds_read_b128 v[172:175], v250 offset:4096
    ds_read_b128 v[176:179], v250 offset:5120
    ds_read_b128 v[180:183], v250 offset:6144
    ds_read_b128 v[184:187], v250 offset:7168
    ds_read_b128 v[188:191], v250 offset:8192
    s_waitcnt lgkmcnt(3)
    v_add_f32 v160, v160, v176
    s_waitcnt lgkmcnt(1)
    v_add_f32 v168, v168, v184
    v_add_f32 v161, v161, v177
    v_add_f32 v169, v169, v185
    v_add_f32 v162, v162, v178
    v_add_f32 v170, v170, v186
    v_add_f32 v163, v163, v179
    v_add_f32 v171, v171, v187
    v_add_f32 v164, v164, v180
    s_waitcnt lgkmcnt(0)
    v_add_f32 v172, v172, v188
    v_add_f32 v165, v165, v181
    v_add_f32 v173, v173, v189
    v_add_f32 v166, v166, v182
    v_add_f32 v174, v174, v190
    v_add_f32 v167, v167, v183
    v_add_f32 v175, v175, v191
    v_cvt_pk_bf16_f32 v40, v160, v161
    v_lshlrev_b32 v160, 16, v40
    v_and_b32 v161, 0xffff0000, v40
    v_cvt_pk_bf16_f32 v40, v168, v169
    v_lshlrev_b32 v168, 16, v40
    v_and_b32 v169, 0xffff0000, v40
    v_cvt_pk_bf16_f32 v40, v162, v163
    v_lshlrev_b32 v162, 16, v40
    v_and_b32 v163, 0xffff0000, v40
    v_cvt_pk_bf16_f32 v40, v170, v171
    v_lshlrev_b32 v170, 16, v40
    v_and_b32 v171, 0xffff0000, v40
    v_cvt_pk_bf16_f32 v40, v164, v165
    v_lshlrev_b32 v164, 16, v40
    v_and_b32 v165, 0xffff0000, v40
    v_cvt_pk_bf16_f32 v40, v172, v173
    v_lshlrev_b32 v172, 16, v40
    v_and_b32 v173, 0xffff0000, v40
    v_cvt_pk_bf16_f32 v40, v166, v167
    v_lshlrev_b32 v166, 16, v40
    v_and_b32 v167, 0xffff0000, v40
    v_cvt_pk_bf16_f32 v40, v174, v175
    v_lshlrev_b32 v174, 16, v40
    v_and_b32 v175, 0xffff0000, v40
    s_mov_b32 s68, 0xbfb8aa3b
    v_mul_f32 v40, s68, v160
    v_exp_f32 v40, v40
    s_nop 0
    v_add_f32 v40, 1.0, v40
    v_rcp_f32 v40, v40
    s_nop 0
    v_mul_f32 v160, v160, v40
    v_mul_f32 v40, s68, v161
    v_exp_f32 v40, v40
    s_nop 0
    v_add_f32 v40, 1.0, v40
    v_rcp_f32 v40, v40
    s_nop 0
    v_mul_f32 v161, v161, v40
    v_mul_f32 v40, s68, v162
    v_exp_f32 v40, v40
    s_nop 0
    v_add_f32 v40, 1.0, v40
    v_rcp_f32 v40, v40
    s_nop 0
    v_mul_f32 v162, v162, v40
    v_mul_f32 v40, s68, v163
    v_exp_f32 v40, v40
    s_nop 0
    v_add_f32 v40, 1.0, v40
    v_rcp_f32 v40, v40
    s_nop 0
    v_mul_f32 v163, v163, v40
    v_mul_f32 v40, s68, v164
    v_exp_f32 v40, v40
    s_nop 0
    v_add_f32 v40, 1.0, v40
    v_rcp_f32 v40, v40
    s_nop 0
    v_mul_f32 v164, v164, v40
    v_mul_f32 v40, s68, v165
    v_exp_f32 v40, v40
    s_nop 0
    v_add_f32 v40, 1.0, v40
    v_rcp_f32 v40, v40
    s_nop 0
    v_mul_f32 v165, v165, v40
    v_mul_f32 v40, s68, v166
    v_exp_f32 v40, v40
    s_nop 0
    v_add_f32 v40, 1.0, v40
    v_rcp_f32 v40, v40
    s_nop 0
    v_mul_f32 v166, v166, v40
    v_mul_f32 v40, s68, v167
    v_exp_f32 v40, v40
    s_nop 0
    v_add_f32 v40, 1.0, v40
    v_rcp_f32 v40, v40
    s_nop 0
    v_mul_f32 v167, v167, v40
    v_cvt_pk_bf16_f32 v40, v160, v161
    v_lshlrev_b32 v160, 16, v40
    v_and_b32 v161, 0xffff0000, v40
    v_cvt_pk_bf16_f32 v40, v162, v163
    v_lshlrev_b32 v162, 16, v40
    v_and_b32 v163, 0xffff0000, v40
    v_cvt_pk_bf16_f32 v40, v164, v165
    v_lshlrev_b32 v164, 16, v40
    v_and_b32 v165, 0xffff0000, v40
    v_cvt_pk_bf16_f32 v40, v166, v167
    v_lshlrev_b32 v166, 16, v40
    v_and_b32 v167, 0xffff0000, v40
    v_mul_f32 v160, v160, v168
    v_mul_f32 v161, v161, v169
    v_mul_f32 v162, v162, v170
    v_mul_f32 v163, v163, v171
    v_mul_f32 v164, v164, v172
    v_mul_f32 v165, v165, v173
    v_mul_f32 v166, v166, v174
    v_mul_f32 v167, v167, v175
    v_cvt_pk_bf16_f32 v80, v160, v164
    v_cvt_pk_bf16_f32 v81, v161, v165
    v_cvt_pk_bf16_f32 v82, v162, v166
    v_cvt_pk_bf16_f32 v83, v163, v167
    s_nop 1
    v_mfma_f32_16x16x32_bf16 v[128:131], a[192:195], v[80:83], 0
    v_mfma_f32_16x16x32_bf16 v[132:135], a[196:199], v[80:83], 0
    v_mfma_f32_16x16x32_bf16 v[136:139], a[200:203], v[80:83], 0
    v_mfma_f32_16x16x32_bf16 v[140:143], a[204:207], v[80:83], 0
    v_mfma_f32_16x16x32_bf16 v[144:147], a[208:211], v[80:83], 0
    v_mfma_f32_16x16x32_bf16 v[148:151], a[212:215], v[80:83], 0
    v_mfma_f32_16x16x32_bf16 v[152:155], a[216:219], v[80:83], 0
    v_mfma_f32_16x16x32_bf16 v[156:159], a[220:223], v[80:83], 0
    v_and_b32 v40, 1, v125
    v_lshlrev_b32 v40, 11, v40
    v_lshrrev_b32 v41, 4, v125
    v_lshl_add_u32 v40, v41, 4, v40
    s_lshl_b32 s68, s85, 12
    s_lshl_b32 s69, s49, 9
    s_add_u32 s68, s68, s69
    s_add_u32 s68, s68, s90
    s_mov_b32 exec_lo, 0x00030003
    s_mov_b32 exec_hi, 0x00030003
    buffer_store_dwordx4 v[128:131], v40, s[40:43], s68 offen offset:0 sc1
    buffer_store_dwordx4 v[132:135], v40, s[40:43], s68 offen offset:64 sc1
    buffer_store_dwordx4 v[136:139], v40, s[40:43], s68 offen offset:128 sc1
    buffer_store_dwordx4 v[140:143], v40, s[40:43], s68 offen offset:192 sc1
    buffer_store_dwordx4 v[144:147], v40, s[40:43], s68 offen offset:256 sc1
    buffer_store_dwordx4 v[148:151], v40, s[40:43], s68 offen offset:320 sc1
    buffer_store_dwordx4 v[152:155], v40, s[40:43], s68 offen offset:384 sc1
    buffer_store_dwordx4 v[156:159], v40, s[40:43], s68 offen offset:448 sc1
    s_mov_b64 exec, -1
    s_waitcnt vmcnt(0)
    s_barrier
    s_mov_b32 s68, 0x208200
    v_mov_b32 v40, 0
    v_mov_b32 v41, 1
    s_cmp_lg_u32 s49, 0
    s_cbranch_scc1 L_fnt58
    s_mov_b64 exec, 1
    buffer_atomic_add v41, v40, s[40:43], s68 offen sc0
    s_waitcnt vmcnt(0)
    ds_write_b32 v40, v41 offset:512
    s_waitcnt lgkmcnt(0)
    s_mov_b64 exec, -1
L_fnt58:
    s_barrier
    ds_read_b32 v41, v40 offset:512
    s_waitcnt lgkmcnt(0)
    v_readfirstlane_b32 s68, v41
    s_barrier
    s_cmp_lg_u32 s68, 42
    s_nop 1
    s_cbranch_scc1 L_fdone52
    s_lshl_b32 s68, s49, 10
    v_add_u32 v40, s68, v250
    s_mov_b32 s68, s90
    buffer_load_dwordx4 v[0:3], v40, s[40:43], s68 offen sc1
    s_add_u32 s68, s68, 4096
    buffer_load_dwordx4 v[4:7], v40, s[40:43], s68 offen sc1
    s_add_u32 s68, s68, 4096
    buffer_load_dwordx4 v[8:11], v40, s[40:43], s68 offen sc1
    s_add_u32 s68, s68, 4096
    buffer_load_dwordx4 v[12:15], v40, s[40:43], s68 offen sc1
    s_add_u32 s68, s68, 4096
    buffer_load_dwordx4 v[16:19], v40, s[40:43], s68 offen sc1
    s_add_u32 s68, s68, 4096
    buffer_load_dwordx4 v[20:23], v40, s[40:43], s68 offen sc1
    s_add_u32 s68, s68, 4096
    buffer_load_dwordx4 v[24:27], v40, s[40:43], s68 offen sc1
    s_add_u32 s68, s68, 4096
    buffer_load_dwordx4 v[28:31], v40, s[40:43], s68 offen sc1
    s_add_u32 s68, s68, 4096
    buffer_load_dwordx4 v[32:35], v40, s[40:43], s68 offen sc1
    s_add_u32 s68, s68, 4096
    buffer_load_dwordx4 v[36:39], v40, s[40:43], s68 offen sc1
    s_add_u32 s68, s68, 4096
    buffer_load_dwordx4 v[48:51], v40, s[40:43], s68 offen sc1
    s_add_u32 s68, s68, 4096
    buffer_load_dwordx4 v[52:55], v40, s[40:43], s68 offen sc1
    s_add_u32 s68, s68, 4096
    buffer_load_dwordx4 v[56:59], v40, s[40:43], s68 offen sc1
    s_add_u32 s68, s68, 4096
    buffer_load_dwordx4 v[60:63], v40, s[40:43], s68 offen sc1
    s_add_u32 s68, s68, 4096
    buffer_load_dwordx4 v[64:67], v40, s[40:43], s68 offen sc1
    s_add_u32 s68, s68, 4096
    buffer_load_dwordx4 v[68:71], v40, s[40:43], s68 offen sc1
    s_add_u32 s68, s68, 4096
    buffer_load_dwordx4 v[72:75], v40, s[40:43], s68 offen sc1
    s_add_u32 s68, s68, 4096
    buffer_load_dwordx4 v[76:79], v40, s[40:43], s68 offen sc1
    s_add_u32 s68, s68, 4096
    buffer_load_dwordx4 v[80:83], v40, s[40:43], s68 offen sc1
    s_add_u32 s68, s68, 4096
    buffer_load_dwordx4 v[84:87], v40, s[40:43], s68 offen sc1
    s_add_u32 s68, s68, 4096
    buffer_load_dwordx4 v[88:91], v40, s[40:43], s68 offen sc1
    s_add_u32 s68, s68, 4096
    buffer_load_dwordx4 v[92:95], v40, s[40:43], s68 offen sc1
    s_add_u32 s68, s68, 4096
    buffer_load_dwordx4 v[96:99], v40, s[40:43], s68 offen sc1
    s_add_u32 s68, s68, 4096
    buffer_load_dwordx4 v[100:103], v40, s[40:43], s68 offen sc1
    s_add_u32 s68, s68, 4096
    buffer_load_dwordx4 v[104:107], v40, s[40:43], s68 offen sc1
    s_add_u32 s68, s68, 4096
    buffer_load_dwordx4 v[108:111], v40, s[40:43], s68 offen sc1
    s_add_u32 s68, s68, 4096
    buffer_load_dwordx4 v[112:115], v40, s[40:43], s68 offen sc1
    s_add_u32 s68, s68, 4096
    buffer_load_dwordx4 v[116:119], v40, s[40:43], s68 offen sc1
    s_add_u32 s68, s68, 4096
    buffer_load_dwordx4 v[128:131], v40, s[40:43], s68 offen sc1
    s_add_u32 s68, s68, 4096
    buffer_load_dwordx4 v[132:135], v40, s[40:43], s68 offen sc1
    s_add_u32 s68, s68, 4096
    buffer_load_dwordx4 v[136:139], v40, s[40:43], s68 offen sc1
    s_add_u32 s68, s68, 4096
    buffer_load_dwordx4 v[140:143], v40, s[40:43], s68 offen sc1
    s_add_u32 s68, s68, 4096
    buffer_load_dwordx4 v[144:147], v40, s[40:43], s68 offen sc1
    s_add_u32 s68, s68, 4096
    buffer_load_dwordx4 v[148:151], v40, s[40:43], s68 offen sc1
    s_add_u32 s68, s68, 4096
    buffer_load_dwordx4 v[152:155], v40, s[40:43], s68 offen sc1
    s_add_u32 s68, s68, 4096
    buffer_load_dwordx4 v[156:159], v40, s[40:43], s68 offen sc1
    s_add_u32 s68, s68, 4096
    buffer_load_dwordx4 v[160:163], v40, s[40:43], s68 offen sc1
    s_add_u32 s68, s68, 4096
    buffer_load_dwordx4 v[164:167], v40, s[40:43], s68 offen sc1
    s_add_u32 s68, s68, 4096
    buffer_load_dwordx4 v[168:171], v40, s[40:43], s68 offen sc1
    s_add_u32 s68, s68, 4096
    buffer_load_dwordx4 v[172:175], v40, s[40:43], s68 offen sc1
    s_add_u32 s68, s68, 4096
    buffer_load_dwordx4 v[176:179], v40, s[40:43], s68 offen sc1
    s_add_u32 s68, s68, 4096
    buffer_load_dwordx4 v[180:183], v40, s[40:43], s68 offen sc1
    s_add_u32 s68, s68, 4096
    buffer_load_dwordx4 v[184:187], v40, s[40:43], s68 offen sc1
    s_cmp_ge_u32 s49, 2
    s_cselect_b32 s70, s71, s70
    s_cselect_b32 s72, s73, s72
    s_cselect_b32 s71, s87, s86
    v_lshrrev_b32 v188, 5, v125
    s_and_b32 s68, s49, 1
    s_lshl_b32 s68, s68, 1
    v_add_u32 v188, s68, v188
    v_lshlrev_b32 v188, 7, v188
    v_and_b32 v189, 3, v125
    v_lshl_add_u32 v188, v189, 5, v188
    v_bfe_u32 v189, v125, 2, 3
    v_add_u32 v188, v188, v189
    v_lshlrev_b32 v189, 1, v188
    v_lshlrev_b32 v190, 2, v188
    s_lshl_b32 s72, s72, 10
    s_add_u32 s68, s72, 0x800000
    s_add_u32 s69, s72, 0x600000
    s_mov_b32 s74, 0x222800
    buffer_load_ushort v192, v189, s[40:43], s68 offen offset:0 sc1
    buffer_load_ushort v196, v189, s[40:43], s69 offen offset:0 sc1
    buffer_load_dword v200, v190, s[40:43], s74 offen offset:0 sc1
    buffer_load_ushort v193, v189, s[40:43], s68 offen offset:16 sc1
    buffer_load_ushort v197, v189, s[40:43], s69 offen offset:16 sc1
    buffer_load_dword v201, v190, s[40:43], s74 offen offset:32 sc1
    buffer_load_ushort v194, v189, s[40:43], s68 offen offset:32 sc1
    buffer_load_ushort v198, v189, s[40:43], s69 offen offset:32 sc1
    buffer_load_dword v202, v190, s[40:43], s74 offen offset:64 sc1
    buffer_load_ushort v195, v189, s[40:43], s68 offen offset:48 sc1
    buffer_load_ushort v199, v189, s[40:43], s69 offen offset:48 sc1
    buffer_load_dword v203, v190, s[40:43], s74 offen offset:96 sc1
    s_waitcnt vmcnt(53)
    v_add_f32 v0, v0, v4
    v_add_f32 v1, v1, v5
    v_add_f32 v2, v2, v6
    v_add_f32 v3, v3, v7
    s_waitcnt vmcnt(52)
    v_add_f32 v0, v0, v8
    v_add_f32 v1, v1, v9
    v_add_f32 v2, v2, v10
    v_add_f32 v3, v3, v11
    s_waitcnt vmcnt(51)
    v_add_f32 v0, v0, v12
    v_add_f32 v1, v1, v13
    v_add_f32 v2, v2, v14
    v_add_f32 v3, v3, v15
    s_waitcnt vmcnt(50)
    v_add_f32 v0, v0, v16
    v_add_f32 v1, v1, v17
    v_add_f32 v2, v2, v18
    v_add_f32 v3, v3, v19
    s_waitcnt vmcnt(49)
    v_add_f32 v0, v0, v20
    v_add_f32 v1, v1, v21
    v_add_f32 v2, v2, v22
    v_add_f32 v3, v3, v23
    s_waitcnt vmcnt(48)
    v_add_f32 v0, v0, v24
    v_add_f32 v1, v1, v25
    v_add_f32 v2, v2, v26
    v_add_f32 v3, v3, v27
    s_waitcnt vmcnt(47)
    v_add_f32 v0, v0, v28
    v_add_f32 v1, v1, v29
    v_add_f32 v2, v2, v30
    v_add_f32 v3, v3, v31
    s_waitcnt vmcnt(46)
    v_add_f32 v0, v0, v32
    v_add_f32 v1, v1, v33
    v_add_f32 v2, v2, v34
    v_add_f32 v3, v3, v35
    s_waitcnt vmcnt(45)
    v_add_f32 v0, v0, v36
    v_add_f32 v1, v1, v37
    v_add_f32 v2, v2, v38
    v_add_f32 v3, v3, v39
    s_waitcnt vmcnt(44)
    v_add_f32 v0, v0, v48
    v_add_f32 v1, v1, v49
    v_add_f32 v2, v2, v50
    v_add_f32 v3, v3, v51
    s_waitcnt vmcnt(43)
    v_add_f32 v0, v0, v52
    v_add_f32 v1, v1, v53
    v_add_f32 v2, v2, v54
    v_add_f32 v3, v3, v55
    s_waitcnt vmcnt(42)
    v_add_f32 v0, v0, v56
    v_add_f32 v1, v1, v57
    v_add_f32 v2, v2, v58
    v_add_f32 v3, v3, v59
    s_waitcnt vmcnt(41)
    v_add_f32 v0, v0, v60
    v_add_f32 v1, v1, v61
    v_add_f32 v2, v2, v62
    v_add_f32 v3, v3, v63
    s_waitcnt vmcnt(40)
    v_add_f32 v0, v0, v64
    v_add_f32 v1, v1, v65
    v_add_f32 v2, v2, v66
    v_add_f32 v3, v3, v67
    s_waitcnt vmcnt(39)
    v_add_f32 v0, v0, v68
    v_add_f32 v1, v1, v69
    v_add_f32 v2, v2, v70
    v_add_f32 v3, v3, v71
    s_waitcnt vmcnt(38)
    v_add_f32 v0, v0, v72
    v_add_f32 v1, v1, v73
    v_add_f32 v2, v2, v74
    v_add_f32 v3, v3, v75
    s_waitcnt vmcnt(37)
    v_add_f32 v0, v0, v76
    v_add_f32 v1, v1, v77
    v_add_f32 v2, v2, v78
    v_add_f32 v3, v3, v79
    s_waitcnt vmcnt(36)
    v_add_f32 v0, v0, v80
    v_add_f32 v1, v1, v81
    v_add_f32 v2, v2, v82
    v_add_f32 v3, v3, v83
    s_waitcnt vmcnt(35)
    v_add_f32 v0, v0, v84
    v_add_f32 v1, v1, v85
    v_add_f32 v2, v2, v86
    v_add_f32 v3, v3, v87
    s_waitcnt vmcnt(34)
    v_add_f32 v0, v0, v88
    v_add_f32 v1, v1, v89
    v_add_f32 v2, v2, v90
    v_add_f32 v3, v3, v91
    s_waitcnt vmcnt(33)
    v_add_f32 v0, v0, v92
    v_add_f32 v1, v1, v93
    v_add_f32 v2, v2, v94
    v_add_f32 v3, v3, v95
    s_waitcnt vmcnt(32)
    v_add_f32 v0, v0, v96
    v_add_f32 v1, v1, v97
    v_add_f32 v2, v2, v98
    v_add_f32 v3, v3, v99
    s_waitcnt vmcnt(31)
    v_add_f32 v0, v0, v100
    v_add_f32 v1, v1, v101
    v_add_f32 v2, v2, v102
    v_add_f32 v3, v3, v103
    s_waitcnt vmcnt(30)
    v_add_f32 v0, v0, v104
    v_add_f32 v1, v1, v105
    v_add_f32 v2, v2, v106
    v_add_f32 v3, v3, v107
    s_waitcnt vmcnt(29)
    v_add_f32 v0, v0, v108
    v_add_f32 v1, v1, v109
    v_add_f32 v2, v2, v110
    v_add_f32 v3, v3, v111
    s_waitcnt vmcnt(28)
    v_add_f32 v0, v0, v112
    v_add_f32 v1, v1, v113
    v_add_f32 v2, v2, v114
    v_add_f32 v3, v3, v115
    s_waitcnt vmcnt(27)
    v_add_f32 v0, v0, v116
    v_add_f32 v1, v1, v117
    v_add_f32 v2, v2, v118
    v_add_f32 v3, v3, v119
    s_waitcnt vmcnt(26)
    v_add_f32 v0, v0, v128
    v_add_f32 v1, v1, v129
    v_add_f32 v2, v2, v130
    v_add_f32 v3, v3, v131
    s_waitcnt vmcnt(25)
    v_add_f32 v0, v0, v132
    v_add_f32 v1, v1, v133
    v_add_f32 v2, v2, v134
    v_add_f32 v3, v3, v135
    s_waitcnt vmcnt(24)
    v_add_f32 v0, v0, v136
    v_add_f32 v1, v1, v137
    v_add_f32 v2, v2, v138
    v_add_f32 v3, v3, v139
    s_waitcnt vmcnt(23)
    v_add_f32 v0, v0, v140
    v_add_f32 v1, v1, v141
    v_add_f32 v2, v2, v142
    v_add_f32 v3, v3, v143
    s_waitcnt vmcnt(22)
    v_add_f32 v0, v0, v144
    v_add_f32 v1, v1, v145
    v_add_f32 v2, v2, v146
    v_add_f32 v3, v3, v147
    s_waitcnt vmcnt(21)
    v_add_f32 v0, v0, v148
    v_add_f32 v1, v1, v149
    v_add_f32 v2, v2, v150
    v_add_f32 v3, v3, v151
    s_waitcnt vmcnt(20)
    v_add_f32 v0, v0, v152
    v_add_f32 v1, v1, v153
    v_add_f32 v2, v2, v154
    v_add_f32 v3, v3, v155
    s_waitcnt vmcnt(19)
    v_add_f32 v0, v0, v156
    v_add_f32 v1, v1, v157
    v_add_f32 v2, v2, v158
    v_add_f32 v3, v3, v159
    s_waitcnt vmcnt(18)
    v_add_f32 v0, v0, v160
    v_add_f32 v1, v1, v161
    v_add_f32 v2, v2, v162
    v_add_f32 v3, v3, v163
    s_waitcnt vmcnt(17)
    v_add_f32 v0, v0, v164
    v_add_f32 v1, v1, v165
    v_add_f32 v2, v2, v166
    v_add_f32 v3, v3, v167
    s_waitcnt vmcnt(16)
    v_add_f32 v0, v0, v168
    v_add_f32 v1, v1, v169
    v_add_f32 v2, v2, v170
    v_add_f32 v3, v3, v171
    s_waitcnt vmcnt(15)
    v_add_f32 v0, v0, v172
    v_add_f32 v1, v1, v173
    v_add_f32 v2, v2, v174
    v_add_f32 v3, v3, v175
    s_waitcnt vmcnt(14)
    v_add_f32 v0, v0, v176
    v_add_f32 v1, v1, v177
    v_add_f32 v2, v2, v178
    v_add_f32 v3, v3, v179
    s_waitcnt vmcnt(13)
    v_add_f32 v0, v0, v180
    v_add_f32 v1, v1, v181
    v_add_f32 v2, v2, v182
    v_add_f32 v3, v3, v183
    s_waitcnt vmcnt(12)
    v_add_f32 v0, v0, v184
    v_add_f32 v1, v1, v185
    v_add_f32 v2, v2, v186
    v_add_f32 v3, v3, v187
    s_and_b32 s68, s70, 0xffff0000
    s_not_b32 s69, s68
    s_and_b32 s69, s69, 0xffff0000
    s_xor_b32 s74, s68, 0x80000000
    s_bitcmp1_b32 s68, 31
    s_cselect_b32 s68, s74, s69
    v_mov_b32 v8, s68
    v_mul_f32 v8, 0xbfb8aa3b, v8
    v_exp_f32 v8, v8
    s_nop 0
    v_add_f32 v8, 1.0, v8
    v_rcp_f32 v8, v8
    s_nop 0
    v_cvt_pk_bf16_f32 v9, v8, v8
    v_lshlrev_b32 v8, 16, v9
    v_cvt_pk_bf16_f32 v9, v0, v1
    v_lshlrev_b32 v0, 16, v9
    v_and_b32 v1, 0xffff0000, v9
    v_cvt_pk_bf16_f32 v9, v2, v3
    v_lshlrev_b32 v2, 16, v9
    v_and_b32 v3, 0xffff0000, v9
    v_mul_f32 v0, v0, v8
    v_mul_f32 v1, v1, v8
    v_mul_f32 v2, v2, v8
    v_mul_f32 v3, v3, v8
    v_cvt_pk_bf16_f32 v9, v0, v1
    v_lshlrev_b32 v0, 16, v9
    v_and_b32 v1, 0xffff0000, v9
    v_cvt_pk_bf16_f32 v9, v2, v3
    v_lshlrev_b32 v2, 16, v9
    v_and_b32 v3, 0xffff0000, v9
    s_waitcnt vmcnt(11)
    v_lshlrev_b32 v192, 16, v192
    s_waitcnt vmcnt(10)
    v_lshlrev_b32 v196, 16, v196
    v_add_f32 v192, v0, v192
    s_waitcnt vmcnt(8)
    v_lshlrev_b32 v193, 16, v193
    s_waitcnt vmcnt(7)
    v_lshlrev_b32 v197, 16, v197
    v_add_f32 v193, v1, v193
    s_waitcnt vmcnt(5)
    v_lshlrev_b32 v194, 16, v194
    s_waitcnt vmcnt(4)
    v_lshlrev_b32 v198, 16, v198
    v_add_f32 v194, v2, v194
    s_waitcnt vmcnt(2)
    v_lshlrev_b32 v195, 16, v195
    s_waitcnt vmcnt(1)
    v_lshlrev_b32 v199, 16, v199
    v_add_f32 v195, v3, v195
    v_cvt_pk_bf16_f32 v9, v192, v193
    v_lshlrev_b32 v192, 16, v9
    v_and_b32 v193, 0xffff0000, v9
    v_cvt_pk_bf16_f32 v9, v194, v195
    v_lshlrev_b32 v194, 16, v9
    v_and_b32 v195, 0xffff0000, v9
    v_mul_f32 v192, v192, v200
    v_mul_f32 v193, v193, v201
    v_mul_f32 v194, v194, v202
    s_waitcnt vmcnt(0)
    v_mul_f32 v195, v195, v203
    v_cvt_pk_bf16_f32 v9, v192, v193
    v_lshlrev_b32 v192, 16, v9
    v_and_b32 v193, 0xffff0000, v9
    v_cvt_pk_bf16_f32 v9, v194, v195
    v_lshlrev_b32 v194, 16, v9
    v_and_b32 v195, 0xffff0000, v9
    v_add_f32 v192, v192, v196
    v_add_f32 v193, v193, v197
    v_add_f32 v194, v194, v198
    v_add_f32 v195, v195, v199
    s_mov_b32 s44, s32
    s_and_b32 s45, s33, 0xffff
    s_mov_b32 s46, 0x200000
    s_mov_b32 s47, 0x20000
    v_cvt_pk_bf16_f32 v192, v192, v192
    buffer_store_short v192, v189, s[44:47], s72 offen offset:0 sc1
    v_cvt_pk_bf16_f32 v193, v193, v193
    buffer_store_short v193, v189, s[44:47], s72 offen offset:16 sc1
    v_cvt_pk_bf16_f32 v194, v194, v194
    buffer_store_short v194, v189, s[44:47], s72 offen offset:32 sc1
    v_cvt_pk_bf16_f32 v195, v195, v195
    buffer_store_short v195, v189, s[44:47], s72 offen offset:48 sc1
    s_waitcnt vmcnt(0)
    s_mov_b32 s68, 0x208500
    v_mov_b32 v8, 0
    v_mov_b32 v9, 1
    s_mov_b64 exec, 1
    buffer_atomic_add v9, v8, s[40:43], s68 offen
    s_mov_b64 exec, -1
L_fdone52:
    s_cmp_ge_u32 s85, 43
    s_cbranch_scc1 L_fdone59
    s_mov_b32 s88, 0
    s_mov_b32 s89, 1
L_fl60:
    s_lshl_b32 s68, s85, 7
    s_lshl_b32 s69, s88, 2
    s_add_u32 s68, s68, s69
    s_add_u32 s68, s68, 0x21a000
    s_cmp_lg_u32 s49, 0
    s_cbranch_scc1 L_wd64
    v_mov_b32 v40, 0
    s_nop 1
L_w63:
    buffer_load_dword v41, v40, s[40:43], s68 offen sc1
    s_waitcnt vmcnt(0)
    v_readfirstlane_b32 s53, v41
    s_cmp_ge_u32 s53, 1
    s_nop 2
    s_cbranch_scc1 L_wd64
    s_add_u32 s60, s60, 1
    s_cmp_gt_u32 s60, 0x40000
    s_cbranch_scc1 L_exit
    s_sleep 1
    s_branch L_w63
L_wd64:
    s_waitcnt vmcnt(0)
    s_barrier
    s_lshl_b32 s69, s88, 7
    s_add_u32 s69, s69, 0x231a00
    v_and_b32 v40, 31, v125
    v_lshlrev_b32 v40, 2, v40
    buffer_load_dword v0, v40, s[40:43], s69 offen sc1
    s_waitcnt vmcnt(0)
    v_cmp_lt_u32 vcc, s95, v0
    s_nop 0
    s_cbranch_vccz L_fn61
    v_mov_b32 v1, s94
    v_mov_b32 v2, s95
    v_mov_b32 v3, 0
    s_mov_b32 s86, s94
    s_mov_b32 s87, s95
    v_max_u32 v40, v0, v1
    v_max3_u32 v40, v40, v2, v3
    s_nop 1
    v_max_u32_dpp v40, v40, v40 row_ror:8 row_mask:0xf bank_mask:0xf
    s_nop 1
    v_max_u32_dpp v40, v40, v40 row_ror:4 row_mask:0xf bank_mask:0xf
    s_nop 1
    v_max_u32_dpp v40, v40, v40 row_ror:2 row_mask:0xf bank_mask:0xf
    s_nop 1
    v_max_u32_dpp v40, v40, v40 row_ror:1 row_mask:0xf bank_mask:0xf
    v_mov_b32 v41, v40
    s_nop 1
    v_permlane16_swap_b32 v40, v41
    v_max_u32 v40, v40, v41
    v_mov_b32 v41, v40
    s_nop 1
    v_permlane32_swap_b32 v40, v41
    v_max_u32 v40, v40, v41
    s_nop 0
    v_readfirstlane_b32 s70, v40
    s_nop 1
    v_cmp_eq_u32 vcc, s70, v0
    s_nop 1
    v_cndmask_b32 v0, v0, 0, vcc
    v_cmp_eq_u32 vcc, s70, v1
    s_nop 1
    v_cndmask_b32 v1, v1, 0, vcc
    v_cmp_eq_u32 vcc, s70, v2
    s_nop 1
    v_cndmask_b32 v2, v2, 0, vcc
    v_cmp_eq_u32 vcc, s70, v3
    s_nop 1
    v_cndmask_b32 v3, v3, 0, vcc
    v_max_u32 v40, v0, v1
    v_max3_u32 v40, v40, v2, v3
    s_nop 1
    v_max_u32_dpp v40, v40, v40 row_ror:8 row_mask:0xf bank_mask:0xf
    s_nop 1
    v_max_u32_dpp v40, v40, v40 row_ror:4 row_mask:0xf bank_mask:0xf
    s_nop 1
    v_max_u32_dpp v40, v40, v40 row_ror:2 row_mask:0xf bank_mask:0xf
    s_nop 1
    v_max_u32_dpp v40, v40, v40 row_ror:1 row_mask:0xf bank_mask:0xf
    v_mov_b32 v41, v40
    s_nop 1
    v_permlane16_swap_b32 v40, v41
    v_max_u32 v40, v40, v41
    v_mov_b32 v41, v40
    s_nop 1
    v_permlane32_swap_b32 v40, v41
    v_max_u32 v40, v40, v41
    s_nop 0
    v_readfirstlane_b32 s71, v40
    s_mov_b32 s94, s70
    s_mov_b32 s95, s71
    s_mul_i32 s90, s89, 0x30000
    s_add_u32 s90, s90, 0xa00000
    s_and_b32 s72, s70, 0x7ff
    s_sub_u32 s72, 2047, s72
    s_and_b32 s73, s71, 0x7ff
    s_sub_u32 s73, 2047, s73
    v_mov_b32 v40, s72
    v_mov_b32 v41, s73
    v_and_b32 v42, 1, v125
    v_cmp_eq_u32 vcc, 1, v42
    s_nop 1
    v_cndmask_b32 v40, v40, v41, vcc
    v_lshlrev_b32 v40, 10, v40
    v_lshrrev_b32 v41, 4, v125
    v_lshl_add_u32 v40, v41, 4, v40
    s_lshr_b32 s68, s49, 1
    s_lshl_b32 s68, s68, 9
    s_add_u32 s68, s68, 0x800000
    buffer_load_dwordx4 v[48:51], v40, s[40:43], s68 offen offset:0 sc1
    buffer_load_dwordx4 v[52:55], v40, s[40:43], s68 offen offset:64 sc1
    buffer_load_dwordx4 v[56:59], v40, s[40:43], s68 offen offset:128 sc1
    buffer_load_dwordx4 v[60:63], v40, s[40:43], s68 offen offset:192 sc1
    buffer_load_dwordx4 v[64:67], v40, s[40:43], s68 offen offset:256 sc1
    buffer_load_dwordx4 v[68:71], v40, s[40:43], s68 offen offset:320 sc1
    buffer_load_dwordx4 v[72:75], v40, s[40:43], s68 offen offset:384 sc1
    buffer_load_dwordx4 v[76:79], v40, s[40:43], s68 offen offset:448 sc1
    s_waitcnt vmcnt(7)
    v_mfma_f32_16x16x32_bf16 v[80:83], a[128:131], v[48:51], 0
    v_mfma_f32_16x16x32_bf16 v[84:87], a[160:163], v[48:51], 0
    s_waitcnt vmcnt(6)
    v_mfma_f32_16x16x32_bf16 v[80:83], a[132:135], v[52:55], v[80:83]
    v_mfma_f32_16x16x32_bf16 v[84:87], a[164:167], v[52:55], v[84:87]
    s_waitcnt vmcnt(5)
    v_mfma_f32_16x16x32_bf16 v[80:83], a[136:139], v[56:59], v[80:83]
    v_mfma_f32_16x16x32_bf16 v[84:87], a[168:171], v[56:59], v[84:87]
    s_waitcnt vmcnt(4)
    v_mfma_f32_16x16x32_bf16 v[80:83], a[140:143], v[60:63], v[80:83]
    v_mfma_f32_16x16x32_bf16 v[84:87], a[172:175], v[60:63], v[84:87]
    s_waitcnt vmcnt(3)
    v_mfma_f32_16x16x32_bf16 v[80:83], a[144:147], v[64:67], v[80:83]
    v_mfma_f32_16x16x32_bf16 v[84:87], a[176:179], v[64:67], v[84:87]
    s_waitcnt vmcnt(2)
    v_mfma_f32_16x16x32_bf16 v[80:83], a[148:151], v[68:71], v[80:83]
    v_mfma_f32_16x16x32_bf16 v[84:87], a[180:183], v[68:71], v[84:87]
    s_waitcnt vmcnt(1)
    v_mfma_f32_16x16x32_bf16 v[80:83], a[152:155], v[72:75], v[80:83]
    v_mfma_f32_16x16x32_bf16 v[84:87], a[184:187], v[72:75], v[84:87]
    s_waitcnt vmcnt(0)
    v_mfma_f32_16x16x32_bf16 v[80:83], a[156:159], v[76:79], v[80:83]
    v_mfma_f32_16x16x32_bf16 v[84:87], a[188:191], v[76:79], v[84:87]
    s_lshl_b32 s68, s49, 11
    v_add_u32 v40, s68, v250
    s_nop 4
    ds_write_b128 v40, v[80:83] offset:1024
    ds_write_b128 v40, v[84:87] offset:2048
    s_waitcnt lgkmcnt(0)
    s_barrier
    ds_read_b128 v[160:163], v250 offset:1024
    ds_read_b128 v[164:167], v250 offset:2048
    ds_read_b128 v[168:171], v250 offset:3072
    ds_read_b128 v[172:175], v250 offset:4096
    ds_read_b128 v[176:179], v250 offset:5120
    ds_read_b128 v[180:183], v250 offset:6144
    ds_read_b128 v[184:187], v250 offset:7168
    ds_read_b128 v[188:191], v250 offset:8192
    s_waitcnt lgkmcnt(3)
    v_add_f32 v160, v160, v176
    s_waitcnt lgkmcnt(1)
    v_add_f32 v168, v168, v184
    v_add_f32 v161, v161, v177
    v_add_f32 v169, v169, v185
    v_add_f32 v162, v162, v178
    v_add_f32 v170, v170, v186
    v_add_f32 v163, v163, v179
    v_add_f32 v171, v171, v187
    v_add_f32 v164, v164, v180
    s_waitcnt lgkmcnt(0)
    v_add_f32 v172, v172, v188
    v_add_f32 v165, v165, v181
    v_add_f32 v173, v173, v189
    v_add_f32 v166, v166, v182
    v_add_f32 v174, v174, v190
    v_add_f32 v167, v167, v183
    v_add_f32 v175, v175, v191
    v_cvt_pk_bf16_f32 v40, v160, v161
    v_lshlrev_b32 v160, 16, v40
    v_and_b32 v161, 0xffff0000, v40
    v_cvt_pk_bf16_f32 v40, v168, v169
    v_lshlrev_b32 v168, 16, v40
    v_and_b32 v169, 0xffff0000, v40
    v_cvt_pk_bf16_f32 v40, v162, v163
    v_lshlrev_b32 v162, 16, v40
    v_and_b32 v163, 0xffff0000, v40
    v_cvt_pk_bf16_f32 v40, v170, v171
    v_lshlrev_b32 v170, 16, v40
    v_and_b32 v171, 0xffff0000, v40
    v_cvt_pk_bf16_f32 v40, v164, v165
    v_lshlrev_b32 v164, 16, v40
    v_and_b32 v165, 0xffff0000, v40
    v_cvt_pk_bf16_f32 v40, v172, v173
    v_lshlrev_b32 v172, 16, v40
    v_and_b32 v173, 0xffff0000, v40
    v_cvt_pk_bf16_f32 v40, v166, v167
    v_lshlrev_b32 v166, 16, v40
    v_and_b32 v167, 0xffff0000, v40
    v_cvt_pk_bf16_f32 v40, v174, v175
    v_lshlrev_b32 v174, 16, v40
    v_and_b32 v175, 0xffff0000, v40
    s_mov_b32 s68, 0xbfb8aa3b
    v_mul_f32 v40, s68, v160
    v_exp_f32 v40, v40
    s_nop 0
    v_add_f32 v40, 1.0, v40
    v_rcp_f32 v40, v40
    s_nop 0
    v_mul_f32 v160, v160, v40
    v_mul_f32 v40, s68, v161
    v_exp_f32 v40, v40
    s_nop 0
    v_add_f32 v40, 1.0, v40
    v_rcp_f32 v40, v40
    s_nop 0
    v_mul_f32 v161, v161, v40
    v_mul_f32 v40, s68, v162
    v_exp_f32 v40, v40
    s_nop 0
    v_add_f32 v40, 1.0, v40
    v_rcp_f32 v40, v40
    s_nop 0
    v_mul_f32 v162, v162, v40
    v_mul_f32 v40, s68, v163
    v_exp_f32 v40, v40
    s_nop 0
    v_add_f32 v40, 1.0, v40
    v_rcp_f32 v40, v40
    s_nop 0
    v_mul_f32 v163, v163, v40
    v_mul_f32 v40, s68, v164
    v_exp_f32 v40, v40
    s_nop 0
    v_add_f32 v40, 1.0, v40
    v_rcp_f32 v40, v40
    s_nop 0
    v_mul_f32 v164, v164, v40
    v_mul_f32 v40, s68, v165
    v_exp_f32 v40, v40
    s_nop 0
    v_add_f32 v40, 1.0, v40
    v_rcp_f32 v40, v40
    s_nop 0
    v_mul_f32 v165, v165, v40
    v_mul_f32 v40, s68, v166
    v_exp_f32 v40, v40
    s_nop 0
    v_add_f32 v40, 1.0, v40
    v_rcp_f32 v40, v40
    s_nop 0
    v_mul_f32 v166, v166, v40
    v_mul_f32 v40, s68, v167
    v_exp_f32 v40, v40
    s_nop 0
    v_add_f32 v40, 1.0, v40
    v_rcp_f32 v40, v40
    s_nop 0
    v_mul_f32 v167, v167, v40
    v_cvt_pk_bf16_f32 v40, v160, v161
    v_lshlrev_b32 v160, 16, v40
    v_and_b32 v161, 0xffff0000, v40
    v_cvt_pk_bf16_f32 v40, v162, v163
    v_lshlrev_b32 v162, 16, v40
    v_and_b32 v163, 0xffff0000, v40
    v_cvt_pk_bf16_f32 v40, v164, v165
    v_lshlrev_b32 v164, 16, v40
    v_and_b32 v165, 0xffff0000, v40
    v_cvt_pk_bf16_f32 v40, v166, v167
    v_lshlrev_b32 v166, 16, v40
    v_and_b32 v167, 0xffff0000, v40
    v_mul_f32 v160, v160, v168
    v_mul_f32 v161, v161, v169
    v_mul_f32 v162, v162, v170
    v_mul_f32 v163, v163, v171
    v_mul_f32 v164, v164, v172
    v_mul_f32 v165, v165, v173
    v_mul_f32 v166, v166, v174
    v_mul_f32 v167, v167, v175
    v_cvt_pk_bf16_f32 v80, v160, v164
    v_cvt_pk_bf16_f32 v81, v161, v165
    v_cvt_pk_bf16_f32 v82, v162, v166
    v_cvt_pk_bf16_f32 v83, v163, v167
    s_nop 1
    v_mfma_f32_16x16x32_bf16 v[128:131], a[192:195], v[80:83], 0
    v_mfma_f32_16x16x32_bf16 v[132:135], a[196:199], v[80:83], 0
    v_mfma_f32_16x16x32_bf16 v[136:139], a[200:203], v[80:83], 0
    v_mfma_f32_16x16x32_bf16 v[140:143], a[204:207], v[80:83], 0
    v_mfma_f32_16x16x32_bf16 v[144:147], a[208:211], v[80:83], 0
    v_mfma_f32_16x16x32_bf16 v[148:151], a[212:215], v[80:83], 0
    v_mfma_f32_16x16x32_bf16 v[152:155], a[216:219], v[80:83], 0
    v_mfma_f32_16x16x32_bf16 v[156:159], a[220:223], v[80:83], 0
    v_and_b32 v40, 1, v125
    v_lshlrev_b32 v40, 11, v40
    v_lshrrev_b32 v41, 4, v125
    v_lshl_add_u32 v40, v41, 4, v40
    s_lshl_b32 s68, s85, 12
    s_lshl_b32 s69, s49, 9
    s_add_u32 s68, s68, s69
    s_add_u32 s68, s68, s90
    s_mov_b32 exec_lo, 0x00030003
    s_mov_b32 exec_hi, 0x00030003
    buffer_store_dwordx4 v[128:131], v40, s[40:43], s68 offen offset:0 sc1
    buffer_store_dwordx4 v[132:135], v40, s[40:43], s68 offen offset:64 sc1
    buffer_store_dwordx4 v[136:139], v40, s[40:43], s68 offen offset:128 sc1
    buffer_store_dwordx4 v[140:143], v40, s[40:43], s68 offen offset:192 sc1
    buffer_store_dwordx4 v[144:147], v40, s[40:43], s68 offen offset:256 sc1
    buffer_store_dwordx4 v[148:151], v40, s[40:43], s68 offen offset:320 sc1
    buffer_store_dwordx4 v[152:155], v40, s[40:43], s68 offen offset:384 sc1
    buffer_store_dwordx4 v[156:159], v40, s[40:43], s68 offen offset:448 sc1
    s_mov_b64 exec, -1
    s_waitcnt vmcnt(0)
    s_barrier
    s_lshl_b32 s68, s89, 8
    s_add_u32 s68, s68, 0x209000
    v_mov_b32 v40, 0
    v_mov_b32 v41, 1
    s_cmp_lg_u32 s49, 0
    s_cbranch_scc1 L_fnt65
    s_mov_b64 exec, 1
    buffer_atomic_add v41, v40, s[40:43], s68 offen sc0
    s_waitcnt vmcnt(0)
    ds_write_b32 v40, v41 offset:512
    s_waitcnt lgkmcnt(0)
    s_mov_b64 exec, -1
L_fnt65:
    s_barrier
    ds_read_b32 v41, v40 offset:512
    s_waitcnt lgkmcnt(0)
    v_readfirstlane_b32 s68, v41
    s_barrier
    s_cmp_lg_u32 s68, 42
    s_nop 1
    s_cbranch_scc1 L_fp62
    s_lshl_b32 s68, s49, 10
    v_add_u32 v40, s68, v250
    s_mov_b32 s68, s90
    buffer_load_dwordx4 v[0:3], v40, s[40:43], s68 offen sc1
    s_add_u32 s68, s68, 4096
    buffer_load_dwordx4 v[4:7], v40, s[40:43], s68 offen sc1
    s_add_u32 s68, s68, 4096
    buffer_load_dwordx4 v[8:11], v40, s[40:43], s68 offen sc1
    s_add_u32 s68, s68, 4096
    buffer_load_dwordx4 v[12:15], v40, s[40:43], s68 offen sc1
    s_add_u32 s68, s68, 4096
    buffer_load_dwordx4 v[16:19], v40, s[40:43], s68 offen sc1
    s_add_u32 s68, s68, 4096
    buffer_load_dwordx4 v[20:23], v40, s[40:43], s68 offen sc1
    s_add_u32 s68, s68, 4096
    buffer_load_dwordx4 v[24:27], v40, s[40:43], s68 offen sc1
    s_add_u32 s68, s68, 4096
    buffer_load_dwordx4 v[28:31], v40, s[40:43], s68 offen sc1
    s_add_u32 s68, s68, 4096
    buffer_load_dwordx4 v[32:35], v40, s[40:43], s68 offen sc1
    s_add_u32 s68, s68, 4096
    buffer_load_dwordx4 v[36:39], v40, s[40:43], s68 offen sc1
    s_add_u32 s68, s68, 4096
    buffer_load_dwordx4 v[48:51], v40, s[40:43], s68 offen sc1
    s_add_u32 s68, s68, 4096
    buffer_load_dwordx4 v[52:55], v40, s[40:43], s68 offen sc1
    s_add_u32 s68, s68, 4096
    buffer_load_dwordx4 v[56:59], v40, s[40:43], s68 offen sc1
    s_add_u32 s68, s68, 4096
    buffer_load_dwordx4 v[60:63], v40, s[40:43], s68 offen sc1
    s_add_u32 s68, s68, 4096
    buffer_load_dwordx4 v[64:67], v40, s[40:43], s68 offen sc1
    s_add_u32 s68, s68, 4096
    buffer_load_dwordx4 v[68:71], v40, s[40:43], s68 offen sc1
    s_add_u32 s68, s68, 4096
    buffer_load_dwordx4 v[72:75], v40, s[40:43], s68 offen sc1
    s_add_u32 s68, s68, 4096
    buffer_load_dwordx4 v[76:79], v40, s[40:43], s68 offen sc1
    s_add_u32 s68, s68, 4096
    buffer_load_dwordx4 v[80:83], v40, s[40:43], s68 offen sc1
    s_add_u32 s68, s68, 4096
    buffer_load_dwordx4 v[84:87], v40, s[40:43], s68 offen sc1
    s_add_u32 s68, s68, 4096
    buffer_load_dwordx4 v[88:91], v40, s[40:43], s68 offen sc1
    s_add_u32 s68, s68, 4096
    buffer_load_dwordx4 v[92:95], v40, s[40:43], s68 offen sc1
    s_add_u32 s68, s68, 4096
    buffer_load_dwordx4 v[96:99], v40, s[40:43], s68 offen sc1
    s_add_u32 s68, s68, 4096
    buffer_load_dwordx4 v[100:103], v40, s[40:43], s68 offen sc1
    s_add_u32 s68, s68, 4096
    buffer_load_dwordx4 v[104:107], v40, s[40:43], s68 offen sc1
    s_add_u32 s68, s68, 4096
    buffer_load_dwordx4 v[108:111], v40, s[40:43], s68 offen sc1
    s_add_u32 s68, s68, 4096
    buffer_load_dwordx4 v[112:115], v40, s[40:43], s68 offen sc1
    s_add_u32 s68, s68, 4096
    buffer_load_dwordx4 v[116:119], v40, s[40:43], s68 offen sc1
    s_add_u32 s68, s68, 4096
    buffer_load_dwordx4 v[128:131], v40, s[40:43], s68 offen sc1
    s_add_u32 s68, s68, 4096
    buffer_load_dwordx4 v[132:135], v40, s[40:43], s68 offen sc1
    s_add_u32 s68, s68, 4096
    buffer_load_dwordx4 v[136:139], v40, s[40:43], s68 offen sc1
    s_add_u32 s68, s68, 4096
    buffer_load_dwordx4 v[140:143], v40, s[40:43], s68 offen sc1
    s_add_u32 s68, s68, 4096
    buffer_load_dwordx4 v[144:147], v40, s[40:43], s68 offen sc1
    s_add_u32 s68, s68, 4096
    buffer_load_dwordx4 v[148:151], v40, s[40:43], s68 offen sc1
    s_add_u32 s68, s68, 4096
    buffer_load_dwordx4 v[152:155], v40, s[40:43], s68 offen sc1
    s_add_u32 s68, s68, 4096
    buffer_load_dwordx4 v[156:159], v40, s[40:43], s68 offen sc1
    s_add_u32 s68, s68, 4096
    buffer_load_dwordx4 v[160:163], v40, s[40:43], s68 offen sc1
    s_add_u32 s68, s68, 4096
    buffer_load_dwordx4 v[164:167], v40, s[40:43], s68 offen sc1
    s_add_u32 s68, s68, 4096
    buffer_load_dwordx4 v[168:171], v40, s[40:43], s68 offen sc1
    s_add_u32 s68, s68, 4096
    buffer_load_dwordx4 v[172:175], v40, s[40:43], s68 offen sc1
    s_add_u32 s68, s68, 4096
    buffer_load_dwordx4 v[176:179], v40, s[40:43], s68 offen sc1
    s_add_u32 s68, s68, 4096
    buffer_load_dwordx4 v[180:183], v40, s[40:43], s68 offen sc1
    s_add_u32 s68, s68, 4096
    buffer_load_dwordx4 v[184:187], v40, s[40:43], s68 offen sc1
    s_cmp_ge_u32 s49, 2
    s_cselect_b32 s70, s71, s70
    s_cselect_b32 s72, s73, s72
    s_cselect_b32 s71, s87, s86
    v_lshrrev_b32 v188, 5, v125
    s_and_b32 s68, s49, 1
    s_lshl_b32 s68, s68, 1
    v_add_u32 v188, s68, v188
    v_lshlrev_b32 v188, 7, v188
    v_and_b32 v189, 3, v125
    v_lshl_add_u32 v188, v189, 5, v188
    v_bfe_u32 v189, v125, 2, 3
    v_add_u32 v188, v188, v189
    v_lshlrev_b32 v189, 1, v188
    v_lshlrev_b32 v190, 2, v188
    s_lshl_b32 s72, s72, 10
    s_add_u32 s68, s72, 0x800000
    s_add_u32 s69, s72, 0x600000
    s_mov_b32 s74, 0x222800
    buffer_load_ushort v192, v189, s[40:43], s68 offen offset:0 sc1
    buffer_load_ushort v196, v189, s[40:43], s69 offen offset:0 sc1
    buffer_load_dword v200, v190, s[40:43], s74 offen offset:0 sc1
    buffer_load_ushort v193, v189, s[40:43], s68 offen offset:16 sc1
    buffer_load_ushort v197, v189, s[40:43], s69 offen offset:16 sc1
    buffer_load_dword v201, v190, s[40:43], s74 offen offset:32 sc1
    buffer_load_ushort v194, v189, s[40:43], s68 offen offset:32 sc1
    buffer_load_ushort v198, v189, s[40:43], s69 offen offset:32 sc1
    buffer_load_dword v202, v190, s[40:43], s74 offen offset:64 sc1
    buffer_load_ushort v195, v189, s[40:43], s68 offen offset:48 sc1
    buffer_load_ushort v199, v189, s[40:43], s69 offen offset:48 sc1
    buffer_load_dword v203, v190, s[40:43], s74 offen offset:96 sc1
    s_and_b32 s73, s71, 0x7ff
    s_sub_u32 s73, 2047, s73
    s_lshl_b32 s73, s73, 10
    s_add_u32 s68, s73, 0x800000
    s_add_u32 s69, s73, 0x600000
    s_mov_b32 s74, 0x222800
    buffer_load_ushort v40, v189, s[40:43], s68 offen offset:0 sc1
    buffer_load_ushort v44, v189, s[40:43], s69 offen offset:0 sc1
    buffer_load_dword v120, v190, s[40:43], s74 offen offset:0 sc1
    buffer_load_ushort v41, v189, s[40:43], s68 offen offset:16 sc1
    buffer_load_ushort v45, v189, s[40:43], s69 offen offset:16 sc1
    buffer_load_dword v121, v190, s[40:43], s74 offen offset:32 sc1
    buffer_load_ushort v42, v189, s[40:43], s68 offen offset:32 sc1
    buffer_load_ushort v46, v189, s[40:43], s69 offen offset:32 sc1
    buffer_load_dword v122, v190, s[40:43], s74 offen offset:64 sc1
    buffer_load_ushort v43, v189, s[40:43], s68 offen offset:48 sc1
    buffer_load_ushort v47, v189, s[40:43], s69 offen offset:48 sc1
    buffer_load_dword v123, v190, s[40:43], s74 offen offset:96 sc1
    s_waitcnt vmcnt(63)
    v_add_f32 v0, v0, v4
    v_add_f32 v1, v1, v5
    v_add_f32 v2, v2, v6
    v_add_f32 v3, v3, v7
    v_add_f32 v0, v0, v8
    v_add_f32 v1, v1, v9
    v_add_f32 v2, v2, v10
    v_add_f32 v3, v3, v11
    v_add_f32 v0, v0, v12
    v_add_f32 v1, v1, v13
    v_add_f32 v2, v2, v14
    v_add_f32 v3, v3, v15
    s_waitcnt vmcnt(62)
    v_add_f32 v0, v0, v16
    v_add_f32 v1, v1, v17
    v_add_f32 v2, v2, v18
    v_add_f32 v3, v3, v19
    s_waitcnt vmcnt(61)
    v_add_f32 v0, v0, v20
    v_add_f32 v1, v1, v21
    v_add_f32 v2, v2, v22
    v_add_f32 v3, v3, v23
    s_waitcnt vmcnt(60)
    v_add_f32 v0, v0, v24
    v_add_f32 v1, v1, v25
    v_add_f32 v2, v2, v26
    v_add_f32 v3, v3, v27
    s_waitcnt vmcnt(59)
    v_add_f32 v0, v0, v28
    v_add_f32 v1, v1, v29
    v_add_f32 v2, v2, v30
    v_add_f32 v3, v3, v31
    s_waitcnt vmcnt(58)
    v_add_f32 v0, v0, v32
    v_add_f32 v1, v1, v33
    v_add_f32 v2, v2, v34
    v_add_f32 v3, v3, v35
    s_waitcnt vmcnt(57)
    v_add_f32 v0, v0, v36
    v_add_f32 v1, v1, v37
    v_add_f32 v2, v2, v38
    v_add_f32 v3, v3, v39
    s_waitcnt vmcnt(56)
    v_add_f32 v0, v0, v48
    v_add_f32 v1, v1, v49
    v_add_f32 v2, v2, v50
    v_add_f32 v3, v3, v51
    s_waitcnt vmcnt(55)
    v_add_f32 v0, v0, v52
    v_add_f32 v1, v1, v53
    v_add_f32 v2, v2, v54
    v_add_f32 v3, v3, v55
    s_waitcnt vmcnt(54)
    v_add_f32 v0, v0, v56
    v_add_f32 v1, v1, v57
    v_add_f32 v2, v2, v58
    v_add_f32 v3, v3, v59
    s_waitcnt vmcnt(53)
    v_add_f32 v0, v0, v60
    v_add_f32 v1, v1, v61
    v_add_f32 v2, v2, v62
    v_add_f32 v3, v3, v63
    s_waitcnt vmcnt(52)
    v_add_f32 v0, v0, v64
    v_add_f32 v1, v1, v65
    v_add_f32 v2, v2, v66
    v_add_f32 v3, v3, v67
    s_waitcnt vmcnt(51)
    v_add_f32 v0, v0, v68
    v_add_f32 v1, v1, v69
    v_add_f32 v2, v2, v70
    v_add_f32 v3, v3, v71
    s_waitcnt vmcnt(50)
    v_add_f32 v0, v0, v72
    v_add_f32 v1, v1, v73
    v_add_f32 v2, v2, v74
    v_add_f32 v3, v3, v75
    s_waitcnt vmcnt(49)
    v_add_f32 v0, v0, v76
    v_add_f32 v1, v1, v77
    v_add_f32 v2, v2, v78
    v_add_f32 v3, v3, v79
    s_waitcnt vmcnt(48)
    v_add_f32 v0, v0, v80
    v_add_f32 v1, v1, v81
    v_add_f32 v2, v2, v82
    v_add_f32 v3, v3, v83
    s_waitcnt vmcnt(47)
    v_add_f32 v0, v0, v84
    v_add_f32 v1, v1, v85
    v_add_f32 v2, v2, v86
    v_add_f32 v3, v3, v87
    s_waitcnt vmcnt(46)
    v_add_f32 v0, v0, v88
    v_add_f32 v1, v1, v89
    v_add_f32 v2, v2, v90
    v_add_f32 v3, v3, v91
    s_waitcnt vmcnt(45)
    v_add_f32 v0, v0, v92
    v_add_f32 v1, v1, v93
    v_add_f32 v2, v2, v94
    v_add_f32 v3, v3, v95
    s_waitcnt vmcnt(44)
    v_add_f32 v0, v0, v96
    v_add_f32 v1, v1, v97
    v_add_f32 v2, v2, v98
    v_add_f32 v3, v3, v99
    s_waitcnt vmcnt(43)
    v_add_f32 v0, v0, v100
    v_add_f32 v1, v1, v101
    v_add_f32 v2, v2, v102
    v_add_f32 v3, v3, v103
    s_waitcnt vmcnt(42)
    v_add_f32 v0, v0, v104
    v_add_f32 v1, v1, v105
    v_add_f32 v2, v2, v106
    v_add_f32 v3, v3, v107
    s_waitcnt vmcnt(41)
    v_add_f32 v0, v0, v108
    v_add_f32 v1, v1, v109
    v_add_f32 v2, v2, v110
    v_add_f32 v3, v3, v111
    s_waitcnt vmcnt(40)
    v_add_f32 v0, v0, v112
    v_add_f32 v1, v1, v113
    v_add_f32 v2, v2, v114
    v_add_f32 v3, v3, v115
    s_waitcnt vmcnt(39)
    v_add_f32 v0, v0, v116
    v_add_f32 v1, v1, v117
    v_add_f32 v2, v2, v118
    v_add_f32 v3, v3, v119
    s_waitcnt vmcnt(38)
    v_add_f32 v0, v0, v128
    v_add_f32 v1, v1, v129
    v_add_f32 v2, v2, v130
    v_add_f32 v3, v3, v131
    s_waitcnt vmcnt(37)
    v_add_f32 v0, v0, v132
    v_add_f32 v1, v1, v133
    v_add_f32 v2, v2, v134
    v_add_f32 v3, v3, v135
    s_waitcnt vmcnt(36)
    v_add_f32 v0, v0, v136
    v_add_f32 v1, v1, v137
    v_add_f32 v2, v2, v138
    v_add_f32 v3, v3, v139
    s_waitcnt vmcnt(35)
    v_add_f32 v0, v0, v140
    v_add_f32 v1, v1, v141
    v_add_f32 v2, v2, v142
    v_add_f32 v3, v3, v143
    s_waitcnt vmcnt(34)
    v_add_f32 v0, v0, v144
    v_add_f32 v1, v1, v145
    v_add_f32 v2, v2, v146
    v_add_f32 v3, v3, v147
    s_waitcnt vmcnt(33)
    v_add_f32 v0, v0, v148
    v_add_f32 v1, v1, v149
    v_add_f32 v2, v2, v150
    v_add_f32 v3, v3, v151
    s_waitcnt vmcnt(32)
    v_add_f32 v0, v0, v152
    v_add_f32 v1, v1, v153
    v_add_f32 v2, v2, v154
    v_add_f32 v3, v3, v155
    s_waitcnt vmcnt(31)
    v_add_f32 v0, v0, v156
    v_add_f32 v1, v1, v157
    v_add_f32 v2, v2, v158
    v_add_f32 v3, v3, v159
    s_waitcnt vmcnt(30)
    v_add_f32 v0, v0, v160
    v_add_f32 v1, v1, v161
    v_add_f32 v2, v2, v162
    v_add_f32 v3, v3, v163
    s_waitcnt vmcnt(29)
    v_add_f32 v0, v0, v164
    v_add_f32 v1, v1, v165
    v_add_f32 v2, v2, v166
    v_add_f32 v3, v3, v167
    s_waitcnt vmcnt(28)
    v_add_f32 v0, v0, v168
    v_add_f32 v1, v1, v169
    v_add_f32 v2, v2, v170
    v_add_f32 v3, v3, v171
    s_waitcnt vmcnt(27)
    v_add_f32 v0, v0, v172
    v_add_f32 v1, v1, v173
    v_add_f32 v2, v2, v174
    v_add_f32 v3, v3, v175
    s_waitcnt vmcnt(26)
    v_add_f32 v0, v0, v176
    v_add_f32 v1, v1, v177
    v_add_f32 v2, v2, v178
    v_add_f32 v3, v3, v179
    s_waitcnt vmcnt(25)
    v_add_f32 v0, v0, v180
    v_add_f32 v1, v1, v181
    v_add_f32 v2, v2, v182
    v_add_f32 v3, v3, v183
    s_waitcnt vmcnt(24)
    v_add_f32 v0, v0, v184
    v_add_f32 v1, v1, v185
    v_add_f32 v2, v2, v186
    v_add_f32 v3, v3, v187
    s_and_b32 s68, s70, 0xffff0000
    s_not_b32 s69, s68
    s_and_b32 s69, s69, 0xffff0000
    s_xor_b32 s74, s68, 0x80000000
    s_bitcmp1_b32 s68, 31
    s_cselect_b32 s68, s74, s69
    v_mov_b32 v8, s68
    v_mul_f32 v8, 0xbfb8aa3b, v8
    v_exp_f32 v8, v8
    s_nop 0
    v_add_f32 v8, 1.0, v8
    v_rcp_f32 v8, v8
    s_nop 0
    v_cvt_pk_bf16_f32 v9, v8, v8
    v_lshlrev_b32 v8, 16, v9
    v_cvt_pk_bf16_f32 v9, v0, v1
    v_lshlrev_b32 v0, 16, v9
    v_and_b32 v1, 0xffff0000, v9
    v_cvt_pk_bf16_f32 v9, v2, v3
    v_lshlrev_b32 v2, 16, v9
    v_and_b32 v3, 0xffff0000, v9
    v_mul_f32 v0, v0, v8
    v_mul_f32 v1, v1, v8
    v_mul_f32 v2, v2, v8
    v_mul_f32 v3, v3, v8
    v_cvt_pk_bf16_f32 v9, v0, v1
    v_lshlrev_b32 v0, 16, v9
    v_and_b32 v1, 0xffff0000, v9
    v_cvt_pk_bf16_f32 v9, v2, v3
    v_lshlrev_b32 v2, 16, v9
    v_and_b32 v3, 0xffff0000, v9
    s_waitcnt vmcnt(23)
    v_lshlrev_b32 v192, 16, v192
    s_waitcnt vmcnt(22)
    v_lshlrev_b32 v196, 16, v196
    v_add_f32 v192, v0, v192
    s_waitcnt vmcnt(20)
    v_lshlrev_b32 v193, 16, v193
    s_waitcnt vmcnt(19)
    v_lshlrev_b32 v197, 16, v197
    v_add_f32 v193, v1, v193
    s_waitcnt vmcnt(17)
    v_lshlrev_b32 v194, 16, v194
    s_waitcnt vmcnt(16)
    v_lshlrev_b32 v198, 16, v198
    v_add_f32 v194, v2, v194
    s_waitcnt vmcnt(14)
    v_lshlrev_b32 v195, 16, v195
    s_waitcnt vmcnt(13)
    v_lshlrev_b32 v199, 16, v199
    v_add_f32 v195, v3, v195
    v_cvt_pk_bf16_f32 v9, v192, v193
    v_lshlrev_b32 v192, 16, v9
    v_and_b32 v193, 0xffff0000, v9
    v_cvt_pk_bf16_f32 v9, v194, v195
    v_lshlrev_b32 v194, 16, v9
    v_and_b32 v195, 0xffff0000, v9
    v_mul_f32 v192, v192, v200
    v_mul_f32 v193, v193, v201
    v_mul_f32 v194, v194, v202
    s_waitcnt vmcnt(12)
    v_mul_f32 v195, v195, v203
    v_cvt_pk_bf16_f32 v9, v192, v193
    v_lshlrev_b32 v192, 16, v9
    v_and_b32 v193, 0xffff0000, v9
    v_cvt_pk_bf16_f32 v9, v194, v195
    v_lshlrev_b32 v194, 16, v9
    v_and_b32 v195, 0xffff0000, v9
    v_add_f32 v192, v192, v196
    v_add_f32 v193, v193, v197
    v_add_f32 v194, v194, v198
    v_add_f32 v195, v195, v199
    s_mov_b32 s44, s32
    s_and_b32 s45, s33, 0xffff
    s_mov_b32 s46, 0x200000
    s_mov_b32 s47, 0x20000
    v_cvt_pk_bf16_f32 v192, v192, v192
    buffer_store_short v192, v189, s[44:47], s72 offen offset:0 sc1
    v_cvt_pk_bf16_f32 v193, v193, v193
    buffer_store_short v193, v189, s[44:47], s72 offen offset:16 sc1
    v_cvt_pk_bf16_f32 v194, v194, v194
    buffer_store_short v194, v189, s[44:47], s72 offen offset:32 sc1
    v_cvt_pk_bf16_f32 v195, v195, v195
    buffer_store_short v195, v189, s[44:47], s72 offen offset:48 sc1
    s_cmp_eq_u32 s71, s94
    s_cbranch_scc1 L_fk66
    s_cmp_eq_u32 s71, s95
    s_cbranch_scc1 L_fk66
    s_mov_b32 s70, 0x208500
    s_lshl_b32 s72, s89, 2
    v_mov_b32 v8, 0
    s_nop 1
L_w67:
    buffer_load_dword v9, v8, s[40:43], s70 offen sc1
    s_waitcnt vmcnt(0)
    v_readfirstlane_b32 s53, v9
    s_cmp_ge_u32 s53, s72
    s_nop 2
    s_cbranch_scc1 L_wd68
    s_add_u32 s60, s60, 1
    s_cmp_gt_u32 s60, 0x40000
    s_cbranch_scc1 L_exit
    s_sleep 2
    s_branch L_w67
L_wd68:
    v_lshlrev_b32 v40, 16, v40
    v_lshlrev_b32 v44, 16, v44
    v_lshlrev_b32 v41, 16, v41
    v_lshlrev_b32 v45, 16, v45
    v_lshlrev_b32 v42, 16, v42
    v_lshlrev_b32 v46, 16, v46
    v_lshlrev_b32 v43, 16, v43
    v_lshlrev_b32 v47, 16, v47
    v_cvt_pk_bf16_f32 v9, v40, v41
    v_lshlrev_b32 v40, 16, v9
    v_and_b32 v41, 0xffff0000, v9
    v_cvt_pk_bf16_f32 v9, v42, v43
    v_lshlrev_b32 v42, 16, v9
    v_and_b32 v43, 0xffff0000, v9
    v_mul_f32 v40, v40, v120
    v_mul_f32 v41, v41, v121
    v_mul_f32 v42, v42, v122
    v_mul_f32 v43, v43, v123
    v_cvt_pk_bf16_f32 v9, v40, v41
    v_lshlrev_b32 v40, 16, v9
    v_and_b32 v41, 0xffff0000, v9
    v_cvt_pk_bf16_f32 v9, v42, v43
    v_lshlrev_b32 v42, 16, v9
    v_and_b32 v43, 0xffff0000, v9
    v_add_f32 v40, v40, v44
    v_add_f32 v41, v41, v45
    v_add_f32 v42, v42, v46
    v_add_f32 v43, v43, v47
    s_mov_b32 s44, s32
    s_and_b32 s45, s33, 0xffff
    s_mov_b32 s46, 0x200000
    s_mov_b32 s47, 0x20000
    v_cvt_pk_bf16_f32 v40, v40, v40
    buffer_store_short v40, v189, s[44:47], s73 offen offset:0 sc1
    v_cvt_pk_bf16_f32 v41, v41, v41
    buffer_store_short v41, v189, s[44:47], s73 offen offset:16 sc1
    v_cvt_pk_bf16_f32 v42, v42, v42
    buffer_store_short v42, v189, s[44:47], s73 offen offset:32 sc1
    v_cvt_pk_bf16_f32 v43, v43, v43
    buffer_store_short v43, v189, s[44:47], s73 offen offset:48 sc1
    s_nop 0
L_fk66:
    s_waitcnt vmcnt(0)
    s_mov_b32 s68, 0x208500
    v_mov_b32 v8, 0
    v_mov_b32 v9, 1
    s_mov_b64 exec, 1
    buffer_atomic_add v9, v8, s[40:43], s68 offen
    s_mov_b64 exec, -1
L_fp62:
    s_add_u32 s89, s89, 1
L_fn61:
    s_add_u32 s88, s88, 1
    s_cmp_lt_u32 s88, 12
    s_cbranch_scc1 L_fl60
L_fdone59:
    s_waitcnt vmcnt(0)
    s_branch L_exit
L_chain:
    s_mov_b32 s48, s58
    v_and_b32 v100, 15, v125
    v_lshrrev_b32 v101, 4, v125
    v_and_b32 v102, 1, v125
    v_mov_b32 v112, 0x4444
    v_mov_b32 v113, 0xeeee
    v_cmp_eq_u32 vcc, 1, v102
    s_nop 1
    v_cndmask_b32 v112, v112, v113, vcc
    s_mul_i32 s53, s49, 36864
    v_lshlrev_b32 v114, 4, v125
    v_add_u32 v113, s53, v114
    s_lshl_b32 s53, s49, 11
    v_add_u32 v124, s53, v114
    v_add_u32 v114, 0x24000, v114
    v_add_u32 v115, s53, v114
    s_add_u32 s53, s49, 1
    s_and_b32 s53, s53, 3
    s_lshl_b32 s53, s53, 11
    v_add_u32 v116, s53, v114
    s_add_u32 s53, s49, 2
    s_and_b32 s53, s53, 3
    s_lshl_b32 s53, s53, 11
    v_add_u32 v117, s53, v114
    s_add_u32 s53, s49, 3
    s_and_b32 s53, s53, 3
    s_lshl_b32 s53, s53, 11
    v_add_u32 v118, s53, v114
    v_lshrrev_b32 v102, 2, v100
    v_lshlrev_b32 v119, 7, v102
    v_lshl_add_u32 v119, v101, 5, v119
    v_and_b32 v102, 3, v100
    v_lshl_add_u32 v119, v102, 2, v119
    s_lshl_b32 s53, s49, 9
    s_add_u32 s54, s53, 0x24000
    v_add_u32 v119, s54, v119
    v_and_b32 v102, 7, v100
    v_lshlrev_b32 v120, 4, v102
    v_lshl_add_u32 v120, v101, 7, v120
    v_add_u32 v120, 0x24000, v120
    v_add_u32 v121, s53, v120
    v_lshrrev_b32 v102, 3, v100
    v_lshl_add_u32 v120, v102, 10, v120
    v_lshrrev_b32 v102, 2, v100
    v_lshlrev_b32 v122, 5, v102
    v_and_b32 v102, 1, v100
    v_lshl_add_u32 v122, v102, 4, v122
    v_lshl_add_u32 v122, v101, 7, v122
    v_bfe_u32 v102, v100, 1, 1
    v_lshl_add_u32 v122, v102, 10, v122
    v_add_u32 v122, 0x24000, v122
    v_and_b32 v102, 7, v100
    v_lshlrev_b32 v123, 5, v102
    v_and_b32 v102, 1, v101
    v_lshl_add_u32 v123, v102, 4, v123
    v_lshrrev_b32 v102, 1, v101
    v_lshl_add_u32 v123, v102, 8, v123
    s_lshl_b32 s53, s49, 9
    s_add_u32 s53, s53, 0x24000
    v_add_u32 v123, s53, v123
    v_cmp_gt_u32 vcc, 8, v100
    s_nop 1
    v_cndmask_b32 v126, 0, -1, vcc
    v_not_b32 v127, v126
    v_mov_b32 v4, -1
    v_mov_b32 v5, -1
    v_mov_b32 v6, -1
    v_mov_b32 v7, -1
    v_mov_b32 v8, 0
    s_lshl_b32 s53, s48, 13
    s_add_u32 s53, s53, 0x100000
    buffer_store_dwordx4 v[4:7], v124, s[40:43], s53 offen sc1
    buffer_store_dwordx4 v[4:7], v124, s[40:43], s53 offen offset:1024 sc1
    v_lshlrev_b32 v9, 2, v125
    s_lshl_b32 s53, s48, 8
    s_add_u32 s53, s53, 0x40000
    buffer_store_dword v4, v9, s[40:43], s53 offen sc1
    v_mov_b32 v12, 0
    v_mov_b32 v13, 0
    v_mov_b32 v14, 0
    v_mov_b32 v15, 0
    v_lshlrev_b32 v9, 4, v125
    s_lshl_b32 s53, s48, 12
    s_lshl_b32 s54, s49, 10
    s_add_u32 s53, s53, s54
    s_add_u32 s53, s53, 0x200000
    buffer_store_dwordx4 v[12:15], v9, s[40:43], s53 offen sc1
    s_cmp_ge_u32 s48, 3
    s_cbranch_scc1 L_nomodp
    s_add_u32 s53, s53, 0x20000
    buffer_store_dwordx4 v[4:7], v9, s[40:43], s53 offen sc1
    s_nop 1
L_nomodp:
    v_lshrrev_b32 v101, 4, v125
    v_lshlrev_b32 v100, 13, v101
    v_and_b32 v101, 15, v125
    v_lshl_add_u32 v100, v101, 4, v100
    s_lshl_b32 s53, s48, 8
    s_lshl_b32 s54, s49, 17
    s_add_u32 s53, s53, s54
    v_add_u32 v100, s53, v100
    v_lshlrev_b32 v102, 2, v101
    v_lshrrev_b32 v101, 5, v125
    v_lshl_add_u32 v102, v101, 12, v102
    v_bfe_u32 v101, v125, 4, 1
    v_lshl_add_u32 v102, v101, 10, v102
    s_lshl_b32 s53, s49, 6
    v_add_u32 v102, s53, v102
    s_mov_b32 s66, 0x400000
    s_mov_b32 s67, 0x20000
    s_mov_b32 s61, 0
    s_mov_b32 s55, 20480
    s_mov_b32 s62, 20480
L_ldpro:
    s_cmp_ge_u32 s61, 24
    s_cbranch_scc1 L_dma1
    s_cmp_lt_u32 s61, 16
    s_cselect_b32 s64, s10, s12
    s_cselect_b32 s65, s11, s13
    s_cmp_lt_u32 s61, 8
    s_cselect_b32 s64, s8, s64
    s_cselect_b32 s65, s9, s65
    s_and_b32 s65, s65, 0xffff
    s_and_b32 s54, s61, 7
    s_lshl_b32 s54, s54, 19
    s_lshl_b32 s53, s49, 12
    s_add_u32 s53, s53, s55
    s_mov_b32 m0, s53
    s_nop 0
    buffer_load_dwordx4 v100, s[64:67], s54 offen nt lds
    s_add_u32 s53, s53, 1024
    s_add_u32 s54, s54, 0x8000
    s_mov_b32 m0, s53
    s_nop 0
    buffer_load_dwordx4 v100, s[64:67], s54 offen nt lds
    s_add_u32 s53, s53, 1024
    s_add_u32 s54, s54, 0x8000
    s_mov_b32 m0, s53
    s_nop 0
    buffer_load_dwordx4 v100, s[64:67], s54 offen nt lds
    s_add_u32 s53, s53, 1024
    s_add_u32 s54, s54, 0x8000
    s_mov_b32 m0, s53
    s_nop 0
    buffer_load_dwordx4 v100, s[64:67], s54 offen nt lds
L_dma1:
    s_add_u32 s61, s61, 1
    s_add_u32 s53, s55, 36864
    s_cmp_eq_u32 s55, 131072
    s_cselect_b32 s53, 147456, s53
    s_cmp_eq_u32 s55, 147456
    s_cselect_b32 s55, 20480, s53
    s_cmp_lt_u32 s61, 4
    s_cbranch_scc1 L_ldpro
    s_waitcnt vmcnt(16)
    s_barrier
    s_cmp_eq_u32 s56, 0
    s_cselect_b32 s53, 1, 0x10001
    v_mov_b32 v1, s53
    v_mov_b32 v2, 16
    s_cmp_lg_u32 s49, 0
    s_cbranch_scc1 L_ch1
    s_mov_b64 exec, 1
    global_atomic_add v2, v1, s[34:35]
    s_mov_b64 exec, -1
L_ch1:
    s_branch L_ldmain
L_ldsub:
    s_cmp_le_u32 s61, 24
    s_cbranch_scc1 L_ldw
    s_waitcnt vmcnt(0)
L_ldw:
    s_waitcnt vmcnt(12) lgkmcnt(0)
    s_barrier
    s_cmp_ge_u32 s61, 24
    s_cbranch_scc1 L_dma2
    s_cmp_lt_u32 s61, 16
    s_cselect_b32 s64, s10, s12
    s_cselect_b32 s65, s11, s13
    s_cmp_lt_u32 s61, 8
    s_cselect_b32 s64, s8, s64
    s_cselect_b32 s65, s9, s65
    s_and_b32 s65, s65, 0xffff
    s_and_b32 s54, s61, 7
    s_lshl_b32 s54, s54, 19
    s_lshl_b32 s53, s49, 12
    s_add_u32 s53, s53, s55
    s_mov_b32 m0, s53
    s_nop 0
    buffer_load_dwordx4 v100, s[64:67], s54 offen nt lds
    s_add_u32 s53, s53, 1024
    s_add_u32 s54, s54, 0x8000
    s_mov_b32 m0, s53
    s_nop 0
    buffer_load_dwordx4 v100, s[64:67], s54 offen nt lds
    s_add_u32 s53, s53, 1024
    s_add_u32 s54, s54, 0x8000
    s_mov_b32 m0, s53
    s_nop 0
    buffer_load_dwordx4 v100, s[64:67], s54 offen nt lds
    s_add_u32 s53, s53, 1024
    s_add_u32 s54, s54, 0x8000
    s_mov_b32 m0, s53
    s_nop 0
    buffer_load_dwordx4 v100, s[64:67], s54 offen nt lds
L_dma2:
    s_add_u32 s61, s61, 1
    s_add_u32 s53, s55, 36864
    s_cmp_eq_u32 s55, 131072
    s_cselect_b32 s53, 147456, s53
    s_cmp_eq_u32 s55, 147456
    s_cselect_b32 s55, 20480, s53
    v_add_u32 v103, s62, v102
    ds_read2st64_b32 v[0:1], v103 offset0:0 offset1:1
    ds_read2st64_b32 v[2:3], v103 offset0:8 offset1:9
    ds_read2st64_b32 v[4:5], v103 offset0:2 offset1:3
    ds_read2st64_b32 v[6:7], v103 offset0:10 offset1:11
    ds_read2st64_b32 v[8:9], v103 offset0:32 offset1:33
    ds_read2st64_b32 v[10:11], v103 offset0:40 offset1:41
    ds_read2st64_b32 v[12:13], v103 offset0:34 offset1:35
    ds_read2st64_b32 v[14:15], v103 offset0:42 offset1:43
    s_add_u32 s53, s62, 36864
    s_cmp_eq_u32 s62, 131072
    s_cselect_b32 s53, 147456, s53
    s_cmp_eq_u32 s62, 147456
    s_cselect_b32 s62, 20480, s53
    s_waitcnt lgkmcnt(7)
    v_perm_b32 v64, v1, v0, s50
    s_waitcnt lgkmcnt(6)
    v_perm_b32 v65, v3, v2, s50
    s_waitcnt lgkmcnt(5)
    v_perm_b32 v66, v5, v4, s50
    s_waitcnt lgkmcnt(4)
    v_perm_b32 v67, v7, v6, s50
    s_waitcnt lgkmcnt(3)
    v_perm_b32 v68, v9, v8, s50
    s_waitcnt lgkmcnt(2)
    v_perm_b32 v69, v11, v10, s50
    s_waitcnt lgkmcnt(1)
    v_perm_b32 v70, v13, v12, s50
    s_waitcnt lgkmcnt(0)
    v_perm_b32 v71, v15, v14, s50
    v_perm_b32 v72, v1, v0, s51
    v_perm_b32 v73, v3, v2, s51
    v_perm_b32 v74, v5, v4, s51
    v_perm_b32 v75, v7, v6, s51
    v_perm_b32 v76, v9, v8, s51
    v_perm_b32 v77, v11, v10, s51
    v_perm_b32 v78, v13, v12, s51
    v_perm_b32 v79, v15, v14, s51
    s_add_u32 s63, s63, 1
    s_setpc_b64 s[68:69]
L_ldmain:
    s_mov_b32 s63, 0
    s_cmp_eq_u32 s49, 0
    s_cbranch_scc1 L_ldq6
    s_cmp_eq_u32 s49, 1
    s_cbranch_scc1 L_ldq4
    s_cmp_eq_u32 s49, 2
    s_cbranch_scc1 L_ldq2
L_ldq0:
    s_call_b64 s[68:69], L_ldsub
    ds_write_b128 v113, v[64:67] offset:4096
    ds_write_b128 v113, v[68:71] offset:5120
    v_accvgpr_write_b32 a16, v72
    v_accvgpr_write_b32 a17, v73
    v_accvgpr_write_b32 a18, v74
    v_accvgpr_write_b32 a19, v75
    v_accvgpr_write_b32 a20, v76
    v_accvgpr_write_b32 a21, v77
    v_accvgpr_write_b32 a22, v78
    v_accvgpr_write_b32 a23, v79
    s_nop 1
L_ldq1:
    s_call_b64 s[68:69], L_ldsub
    ds_write_b128 v113, v[64:67] offset:6144
    ds_write_b128 v113, v[68:71] offset:7168
    v_accvgpr_write_b32 a24, v72
    v_accvgpr_write_b32 a25, v73
    v_accvgpr_write_b32 a26, v74
    v_accvgpr_write_b32 a27, v75
    v_accvgpr_write_b32 a28, v76
    v_accvgpr_write_b32 a29, v77
    v_accvgpr_write_b32 a30, v78
    v_accvgpr_write_b32 a31, v79
    s_nop 1
L_ldq2:
    s_call_b64 s[68:69], L_ldsub
    v_accvgpr_write_b32 a32, v64
    v_accvgpr_write_b32 a33, v65
    v_accvgpr_write_b32 a34, v66
    v_accvgpr_write_b32 a35, v67
    v_accvgpr_write_b32 a36, v68
    v_accvgpr_write_b32 a37, v69
    v_accvgpr_write_b32 a38, v70
    v_accvgpr_write_b32 a39, v71
    v_accvgpr_write_b32 a40, v72
    v_accvgpr_write_b32 a41, v73
    v_accvgpr_write_b32 a42, v74
    v_accvgpr_write_b32 a43, v75
    v_accvgpr_write_b32 a44, v76
    v_accvgpr_write_b32 a45, v77
    v_accvgpr_write_b32 a46, v78
    v_accvgpr_write_b32 a47, v79
    s_nop 1
L_ldq3:
    s_call_b64 s[68:69], L_ldsub
    v_accvgpr_write_b32 a48, v64
    v_accvgpr_write_b32 a49, v65
    v_accvgpr_write_b32 a50, v66
    v_accvgpr_write_b32 a51, v67
    v_accvgpr_write_b32 a52, v68
    v_accvgpr_write_b32 a53, v69
    v_accvgpr_write_b32 a54, v70
    v_accvgpr_write_b32 a55, v71
    ds_write_b128 v113, v[72:75] offset:8192
    ds_write_b128 v113, v[76:79] offset:9216
L_ldq4:
    s_call_b64 s[68:69], L_ldsub
    v_accvgpr_write_b32 a56, v64
    v_accvgpr_write_b32 a57, v65
    v_accvgpr_write_b32 a58, v66
    v_accvgpr_write_b32 a59, v67
    v_accvgpr_write_b32 a60, v68
    v_accvgpr_write_b32 a61, v69
    v_accvgpr_write_b32 a62, v70
    v_accvgpr_write_b32 a63, v71
    ds_write_b128 v113, v[72:75] offset:10240
    ds_write_b128 v113, v[76:79] offset:11264
L_ldq5:
    s_call_b64 s[68:69], L_ldsub
    v_accvgpr_write_b32 a64, v64
    v_accvgpr_write_b32 a65, v65
    v_accvgpr_write_b32 a66, v66
    v_accvgpr_write_b32 a67, v67
    v_accvgpr_write_b32 a68, v68
    v_accvgpr_write_b32 a69, v69
    v_accvgpr_write_b32 a70, v70
    v_accvgpr_write_b32 a71, v71
    v_accvgpr_write_b32 a72, v72
    v_accvgpr_write_b32 a73, v73
    v_accvgpr_write_b32 a74, v74
    v_accvgpr_write_b32 a75, v75
    v_accvgpr_write_b32 a76, v76
    v_accvgpr_write_b32 a77, v77
    v_accvgpr_write_b32 a78, v78
    v_accvgpr_write_b32 a79, v79
    s_nop 1
L_ldq6:
    s_call_b64 s[68:69], L_ldsub
    v_accvgpr_write_b32 a0, v64
    v_accvgpr_write_b32 a1, v65
    v_accvgpr_write_b32 a2, v66
    v_accvgpr_write_b32 a3, v67
    v_accvgpr_write_b32 a4, v68
    v_accvgpr_write_b32 a5, v69
    v_accvgpr_write_b32 a6, v70
    v_accvgpr_write_b32 a7, v71
    ds_write_b128 v113, v[72:75] offset:0
    ds_write_b128 v113, v[76:79] offset:1024
L_ldq7:
    s_call_b64 s[68:69], L_ldsub
    v_accvgpr_write_b32 a8, v64
    v_accvgpr_write_b32 a9, v65
    v_accvgpr_write_b32 a10, v66
    v_accvgpr_write_b32 a11, v67
    v_accvgpr_write_b32 a12, v68
    v_accvgpr_write_b32 a13, v69
    v_accvgpr_write_b32 a14, v70
    v_accvgpr_write_b32 a15, v71
    ds_write_b128 v113, v[72:75] offset:2048
    ds_write_b128 v113, v[76:79] offset:3072
    s_cmp_eq_u32 s63, 8
    s_cbranch_scc1 L_ldq_done
L_ldq8:
    s_call_b64 s[68:69], L_ldsub
    ds_write_b128 v113, v[64:67] offset:4096
    ds_write_b128 v113, v[68:71] offset:5120
    v_accvgpr_write_b32 a16, v72
    v_accvgpr_write_b32 a17, v73
    v_accvgpr_write_b32 a18, v74
    v_accvgpr_write_b32 a19, v75
    v_accvgpr_write_b32 a20, v76
    v_accvgpr_write_b32 a21, v77
    v_accvgpr_write_b32 a22, v78
    v_accvgpr_write_b32 a23, v79
    s_nop 1
L_ldq9:
    s_call_b64 s[68:69], L_ldsub
    ds_write_b128 v113, v[64:67] offset:6144
    ds_write_b128 v113, v[68:71] offset:7168
    v_accvgpr_write_b32 a24, v72
    v_accvgpr_write_b32 a25, v73
    v_accvgpr_write_b32 a26, v74
    v_accvgpr_write_b32 a27, v75
    v_accvgpr_write_b32 a28, v76
    v_accvgpr_write_b32 a29, v77
    v_accvgpr_write_b32 a30, v78
    v_accvgpr_write_b32 a31, v79
    s_cmp_eq_u32 s63, 8
    s_cbranch_scc1 L_ldq_done
L_ldq10:
    s_call_b64 s[68:69], L_ldsub
    v_accvgpr_write_b32 a32, v64
    v_accvgpr_write_b32 a33, v65
    v_accvgpr_write_b32 a34, v66
    v_accvgpr_write_b32 a35, v67
    v_accvgpr_write_b32 a36, v68
    v_accvgpr_write_b32 a37, v69
    v_accvgpr_write_b32 a38, v70
    v_accvgpr_write_b32 a39, v71
    v_accvgpr_write_b32 a40, v72
    v_accvgpr_write_b32 a41, v73
    v_accvgpr_write_b32 a42, v74
    v_accvgpr_write_b32 a43, v75
    v_accvgpr_write_b32 a44, v76
    v_accvgpr_write_b32 a45, v77
    v_accvgpr_write_b32 a46, v78
    v_accvgpr_write_b32 a47, v79
    s_nop 1
L_ldq11:
    s_call_b64 s[68:69], L_ldsub
    v_accvgpr_write_b32 a48, v64
    v_accvgpr_write_b32 a49, v65
    v_accvgpr_write_b32 a50, v66
    v_accvgpr_write_b32 a51, v67
    v_accvgpr_write_b32 a52, v68
    v_accvgpr_write_b32 a53, v69
    v_accvgpr_write_b32 a54, v70
    v_accvgpr_write_b32 a55, v71
    ds_write_b128 v113, v[72:75] offset:8192
    ds_write_b128 v113, v[76:79] offset:9216
    s_cmp_eq_u32 s63, 8
    s_cbranch_scc1 L_ldq_done
L_ldq12:
    s_call_b64 s[68:69], L_ldsub
    v_accvgpr_write_b32 a56, v64
    v_accvgpr_write_b32 a57, v65
    v_accvgpr_write_b32 a58, v66
    v_accvgpr_write_b32 a59, v67
    v_accvgpr_write_b32 a60, v68
    v_accvgpr_write_b32 a61, v69
    v_accvgpr_write_b32 a62, v70
    v_accvgpr_write_b32 a63, v71
    ds_write_b128 v113, v[72:75] offset:10240
    ds_write_b128 v113, v[76:79] offset:11264
L_ldq13:
    s_call_b64 s[68:69], L_ldsub
    v_accvgpr_write_b32 a64, v64
    v_accvgpr_write_b32 a65, v65
    v_accvgpr_write_b32 a66, v66
    v_accvgpr_write_b32 a67, v67
    v_accvgpr_write_b32 a68, v68
    v_accvgpr_write_b32 a69, v69
    v_accvgpr_write_b32 a70, v70
    v_accvgpr_write_b32 a71, v71
    v_accvgpr_write_b32 a72, v72
    v_accvgpr_write_b32 a73, v73
    v_accvgpr_write_b32 a74, v74
    v_accvgpr_write_b32 a75, v75
    v_accvgpr_write_b32 a76, v76
    v_accvgpr_write_b32 a77, v77
    v_accvgpr_write_b32 a78, v78
    v_accvgpr_write_b32 a79, v79
    s_nop 1
L_ldq_done:
    s_mov_b32 s63, 0
    s_cmp_eq_u32 s49, 0
    s_cbranch_scc1 L_ldk6
    s_cmp_eq_u32 s49, 1
    s_cbranch_scc1 L_ldk4
    s_cmp_eq_u32 s49, 2
    s_cbranch_scc1 L_ldk2
L_ldk0:
    s_call_b64 s[68:69], L_ldsub
    v_accvgpr_write_b32 a112, v64
    v_accvgpr_write_b32 a113, v65
    v_accvgpr_write_b32 a114, v66
    v_accvgpr_write_b32 a115, v67
    v_accvgpr_write_b32 a116, v68
    v_accvgpr_write_b32 a117, v69
    v_accvgpr_write_b32 a118, v70
    v_accvgpr_write_b32 a119, v71
    v_accvgpr_write_b32 a120, v72
    v_accvgpr_write_b32 a121, v73
    v_accvgpr_write_b32 a122, v74
    v_accvgpr_write_b32 a123, v75
    v_accvgpr_write_b32 a124, v76
    v_accvgpr_write_b32 a125, v77
    v_accvgpr_write_b32 a126, v78
    v_accvgpr_write_b32 a127, v79
    s_nop 1
L_ldk1:
    s_call_b64 s[68:69], L_ldsub
    ds_write_b128 v113, v[64:67] offset:12288
    ds_write_b128 v113, v[68:71] offset:13312
    v_accvgpr_write_b32 a128, v72
    v_accvgpr_write_b32 a129, v73
    v_accvgpr_write_b32 a130, v74
    v_accvgpr_write_b32 a131, v75
    v_accvgpr_write_b32 a132, v76
    v_accvgpr_write_b32 a133, v77
    v_accvgpr_write_b32 a134, v78
    v_accvgpr_write_b32 a135, v79
    s_nop 1
L_ldk2:
    s_call_b64 s[68:69], L_ldsub
    ds_write_b128 v113, v[64:67] offset:14336
    ds_write_b128 v113, v[68:71] offset:15360
    v_accvgpr_write_b32 a136, v72
    v_accvgpr_write_b32 a137, v73
    v_accvgpr_write_b32 a138, v74
    v_accvgpr_write_b32 a139, v75
    v_accvgpr_write_b32 a140, v76
    v_accvgpr_write_b32 a141, v77
    v_accvgpr_write_b32 a142, v78
    v_accvgpr_write_b32 a143, v79
    s_nop 1
L_ldk3:
    s_call_b64 s[68:69], L_ldsub
    v_accvgpr_write_b32 a144, v64
    v_accvgpr_write_b32 a145, v65
    v_accvgpr_write_b32 a146, v66
    v_accvgpr_write_b32 a147, v67
    v_accvgpr_write_b32 a148, v68
    v_accvgpr_write_b32 a149, v69
    v_accvgpr_write_b32 a150, v70
    v_accvgpr_write_b32 a151, v71
    v_accvgpr_write_b32 a152, v72
    v_accvgpr_write_b32 a153, v73
    v_accvgpr_write_b32 a154, v74
    v_accvgpr_write_b32 a155, v75
    v_accvgpr_write_b32 a156, v76
    v_accvgpr_write_b32 a157, v77
    v_accvgpr_write_b32 a158, v78
    v_accvgpr_write_b32 a159, v79
    s_nop 1
L_ldk4:
    s_call_b64 s[68:69], L_ldsub
    v_accvgpr_write_b32 a160, v64
    v_accvgpr_write_b32 a161, v65
    v_accvgpr_write_b32 a162, v66
    v_accvgpr_write_b32 a163, v67
    v_accvgpr_write_b32 a164, v68
    v_accvgpr_write_b32 a165, v69
    v_accvgpr_write_b32 a166, v70
    v_accvgpr_write_b32 a167, v71
    ds_write_b128 v113, v[72:75] offset:16384
    ds_write_b128 v113, v[76:79] offset:17408
L_ldk5:
    s_call_b64 s[68:69], L_ldsub
    v_accvgpr_write_b32 a168, v64
    v_accvgpr_write_b32 a169, v65
    v_accvgpr_write_b32 a170, v66
    v_accvgpr_write_b32 a171, v67
    v_accvgpr_write_b32 a172, v68
    v_accvgpr_write_b32 a173, v69
    v_accvgpr_write_b32 a174, v70
    v_accvgpr_write_b32 a175, v71
    ds_write_b128 v113, v[72:75] offset:18432
    ds_write_b128 v113, v[76:79] offset:19456
L_ldk6:
    s_call_b64 s[68:69], L_ldsub
    v_accvgpr_write_b32 a80, v64
    v_accvgpr_write_b32 a81, v65
    v_accvgpr_write_b32 a82, v66
    v_accvgpr_write_b32 a83, v67
    v_accvgpr_write_b32 a84, v68
    v_accvgpr_write_b32 a85, v69
    v_accvgpr_write_b32 a86, v70
    v_accvgpr_write_b32 a87, v71
    v_accvgpr_write_b32 a88, v72
    v_accvgpr_write_b32 a89, v73
    v_accvgpr_write_b32 a90, v74
    v_accvgpr_write_b32 a91, v75
    v_accvgpr_write_b32 a92, v76
    v_accvgpr_write_b32 a93, v77
    v_accvgpr_write_b32 a94, v78
    v_accvgpr_write_b32 a95, v79
    s_nop 1
L_ldk7:
    s_call_b64 s[68:69], L_ldsub
    v_accvgpr_write_b32 a96, v64
    v_accvgpr_write_b32 a97, v65
    v_accvgpr_write_b32 a98, v66
    v_accvgpr_write_b32 a99, v67
    v_accvgpr_write_b32 a100, v68
    v_accvgpr_write_b32 a101, v69
    v_accvgpr_write_b32 a102, v70
    v_accvgpr_write_b32 a103, v71
    v_accvgpr_write_b32 a104, v72
    v_accvgpr_write_b32 a105, v73
    v_accvgpr_write_b32 a106, v74
    v_accvgpr_write_b32 a107, v75
    v_accvgpr_write_b32 a108, v76
    v_accvgpr_write_b32 a109, v77
    v_accvgpr_write_b32 a110, v78
    v_accvgpr_write_b32 a111, v79
    s_cmp_eq_u32 s63, 8
    s_cbranch_scc1 L_ldk_done
L_ldk8:
    s_call_b64 s[68:69], L_ldsub
    v_accvgpr_write_b32 a112, v64
    v_accvgpr_write_b32 a113, v65
    v_accvgpr_write_b32 a114, v66
    v_accvgpr_write_b32 a115, v67
    v_accvgpr_write_b32 a116, v68
    v_accvgpr_write_b32 a117, v69
    v_accvgpr_write_b32 a118, v70
    v_accvgpr_write_b32 a119, v71
    v_accvgpr_write_b32 a120, v72
    v_accvgpr_write_b32 a121, v73
    v_accvgpr_write_b32 a122, v74
    v_accvgpr_write_b32 a123, v75
    v_accvgpr_write_b32 a124, v76
    v_accvgpr_write_b32 a125, v77
    v_accvgpr_write_b32 a126, v78
    v_accvgpr_write_b32 a127, v79
    s_nop 1
L_ldk9:
    s_call_b64 s[68:69], L_ldsub
    ds_write_b128 v113, v[64:67] offset:12288
    ds_write_b128 v113, v[68:71] offset:13312
    v_accvgpr_write_b32 a128, v72
    v_accvgpr_write_b32 a129, v73
    v_accvgpr_write_b32 a130, v74
    v_accvgpr_write_b32 a131, v75
    v_accvgpr_write_b32 a132, v76
    v_accvgpr_write_b32 a133, v77
    v_accvgpr_write_b32 a134, v78
    v_accvgpr_write_b32 a135, v79
    s_cmp_eq_u32 s63, 8
    s_cbranch_scc1 L_ldk_done
L_ldk10:
    s_call_b64 s[68:69], L_ldsub
    ds_write_b128 v113, v[64:67] offset:14336
    ds_write_b128 v113, v[68:71] offset:15360
    v_accvgpr_write_b32 a136, v72
    v_accvgpr_write_b32 a137, v73
    v_accvgpr_write_b32 a138, v74
    v_accvgpr_write_b32 a139, v75
    v_accvgpr_write_b32 a140, v76
    v_accvgpr_write_b32 a141, v77
    v_accvgpr_write_b32 a142, v78
    v_accvgpr_write_b32 a143, v79
    s_nop 1
L_ldk11:
    s_call_b64 s[68:69], L_ldsub
    v_accvgpr_write_b32 a144, v64
    v_accvgpr_write_b32 a145, v65
    v_accvgpr_write_b32 a146, v66
    v_accvgpr_write_b32 a147, v67
    v_accvgpr_write_b32 a148, v68
    v_accvgpr_write_b32 a149, v69
    v_accvgpr_write_b32 a150, v70
    v_accvgpr_write_b32 a151, v71
    v_accvgpr_write_b32 a152, v72
    v_accvgpr_write_b32 a153, v73
    v_accvgpr_write_b32 a154, v74
    v_accvgpr_write_b32 a155, v75
    v_accvgpr_write_b32 a156, v76
    v_accvgpr_write_b32 a157, v77
    v_accvgpr_write_b32 a158, v78
    v_accvgpr_write_b32 a159, v79
    s_cmp_eq_u32 s63, 8
    s_cbranch_scc1 L_ldk_done
L_ldk12:
    s_call_b64 s[68:69], L_ldsub
    v_accvgpr_write_b32 a160, v64
    v_accvgpr_write_b32 a161, v65
    v_accvgpr_write_b32 a162, v66
    v_accvgpr_write_b32 a163, v67
    v_accvgpr_write_b32 a164, v68
    v_accvgpr_write_b32 a165, v69
    v_accvgpr_write_b32 a166, v70
    v_accvgpr_write_b32 a167, v71
    ds_write_b128 v113, v[72:75] offset:16384
    ds_write_b128 v113, v[76:79] offset:17408
L_ldk13:
    s_call_b64 s[68:69], L_ldsub
    v_accvgpr_write_b32 a168, v64
    v_accvgpr_write_b32 a169, v65
    v_accvgpr_write_b32 a170, v66
    v_accvgpr_write_b32 a171, v67
    v_accvgpr_write_b32 a172, v68
    v_accvgpr_write_b32 a173, v69
    v_accvgpr_write_b32 a174, v70
    v_accvgpr_write_b32 a175, v71
    ds_write_b128 v113, v[72:75] offset:18432
    ds_write_b128 v113, v[76:79] offset:19456
L_ldk_done:
    s_mov_b32 s63, 0
    s_cmp_eq_u32 s49, 0
    s_cbranch_scc1 L_ldv6
    s_cmp_eq_u32 s49, 1
    s_cbranch_scc1 L_ldv4
    s_cmp_eq_u32 s49, 2
    s_cbranch_scc1 L_ldv2
L_ldv0:
    s_call_b64 s[68:69], L_ldsub
    v_accvgpr_write_b32 a208, v64
    v_accvgpr_write_b32 a209, v65
    v_accvgpr_write_b32 a210, v66
    v_accvgpr_write_b32 a211, v67
    v_accvgpr_write_b32 a212, v68
    v_accvgpr_write_b32 a213, v69
    v_accvgpr_write_b32 a214, v70
    v_accvgpr_write_b32 a215, v71
    v_accvgpr_write_b32 a216, v72
    v_accvgpr_write_b32 a217, v73
    v_accvgpr_write_b32 a218, v74
    v_accvgpr_write_b32 a219, v75
    v_accvgpr_write_b32 a220, v76
    v_accvgpr_write_b32 a221, v77
    v_accvgpr_write_b32 a222, v78
    v_accvgpr_write_b32 a223, v79
    s_nop 1
L_ldv1:
    s_call_b64 s[68:69], L_ldsub
    v_accvgpr_write_b32 a224, v64
    v_accvgpr_write_b32 a225, v65
    v_accvgpr_write_b32 a226, v66
    v_accvgpr_write_b32 a227, v67
    v_accvgpr_write_b32 a228, v68
    v_accvgpr_write_b32 a229, v69
    v_accvgpr_write_b32 a230, v70
    v_accvgpr_write_b32 a231, v71
    v_accvgpr_write_b32 a232, v72
    v_accvgpr_write_b32 a233, v73
    v_accvgpr_write_b32 a234, v74
    v_accvgpr_write_b32 a235, v75
    v_accvgpr_write_b32 a236, v76
    v_accvgpr_write_b32 a237, v77
    v_accvgpr_write_b32 a238, v78
    v_accvgpr_write_b32 a239, v79
    s_nop 1
L_ldv2:
    s_call_b64 s[68:69], L_ldsub
    v_accvgpr_write_b32 a240, v64
    v_accvgpr_write_b32 a241, v65
    v_accvgpr_write_b32 a242, v66
    v_accvgpr_write_b32 a243, v67
    v_accvgpr_write_b32 a244, v68
    v_accvgpr_write_b32 a245, v69
    v_accvgpr_write_b32 a246, v70
    v_accvgpr_write_b32 a247, v71
    v_accvgpr_write_b32 a248, v72
    v_accvgpr_write_b32 a249, v73
    v_accvgpr_write_b32 a250, v74
    v_accvgpr_write_b32 a251, v75
    v_accvgpr_write_b32 a252, v76
    v_accvgpr_write_b32 a253, v77
    v_accvgpr_write_b32 a254, v78
    v_accvgpr_write_b32 a255, v79
    s_nop 1
L_ldv3:
    s_call_b64 s[68:69], L_ldsub
    v_mov_b32 v144, v64
    v_mov_b32 v145, v65
    v_mov_b32 v146, v66
    v_mov_b32 v147, v67
    v_mov_b32 v148, v68
    v_mov_b32 v149, v69
    v_mov_b32 v150, v70
    v_mov_b32 v151, v71
    v_mov_b32 v152, v72
    v_mov_b32 v153, v73
    v_mov_b32 v154, v74
    v_mov_b32 v155, v75
    v_mov_b32 v156, v76
    v_mov_b32 v157, v77
    v_mov_b32 v158, v78
    v_mov_b32 v159, v79
    s_nop 1
L_ldv4:
    s_call_b64 s[68:69], L_ldsub
    v_mov_b32 v160, v64
    v_mov_b32 v161, v65
    v_mov_b32 v162, v66
    v_mov_b32 v163, v67
    v_mov_b32 v164, v68
    v_mov_b32 v165, v69
    v_mov_b32 v166, v70
    v_mov_b32 v167, v71
    v_mov_b32 v168, v72
    v_mov_b32 v169, v73
    v_mov_b32 v170, v74
    v_mov_b32 v171, v75
    v_mov_b32 v172, v76
    v_mov_b32 v173, v77
    v_mov_b32 v174, v78
    v_mov_b32 v175, v79
    s_nop 1
L_ldv5:
    s_call_b64 s[68:69], L_ldsub
    v_mov_b32 v176, v64
    v_mov_b32 v177, v65
    v_mov_b32 v178, v66
    v_mov_b32 v179, v67
    v_mov_b32 v180, v68
    v_mov_b32 v181, v69
    v_mov_b32 v182, v70
    v_mov_b32 v183, v71
    v_mov_b32 v184, v72
    v_mov_b32 v185, v73
    v_mov_b32 v186, v74
    v_mov_b32 v187, v75
    v_mov_b32 v188, v76
    v_mov_b32 v189, v77
    v_mov_b32 v190, v78
    v_mov_b32 v191, v79
    s_nop 1
L_ldv6:
    s_call_b64 s[68:69], L_ldsub
    v_accvgpr_write_b32 a176, v64
    v_accvgpr_write_b32 a177, v65
    v_accvgpr_write_b32 a178, v66
    v_accvgpr_write_b32 a179, v67
    v_accvgpr_write_b32 a180, v68
    v_accvgpr_write_b32 a181, v69
    v_accvgpr_write_b32 a182, v70
    v_accvgpr_write_b32 a183, v71
    v_accvgpr_write_b32 a184, v72
    v_accvgpr_write_b32 a185, v73
    v_accvgpr_write_b32 a186, v74
    v_accvgpr_write_b32 a187, v75
    v_accvgpr_write_b32 a188, v76
    v_accvgpr_write_b32 a189, v77
    v_accvgpr_write_b32 a190, v78
    v_accvgpr_write_b32 a191, v79
    s_nop 1
L_ldv7:
    s_call_b64 s[68:69], L_ldsub
    v_accvgpr_write_b32 a192, v64
    v_accvgpr_write_b32 a193, v65
    v_accvgpr_write_b32 a194, v66
    v_accvgpr_write_b32 a195, v67
    v_accvgpr_write_b32 a196, v68
    v_accvgpr_write_b32 a197, v69
    v_accvgpr_write_b32 a198, v70
    v_accvgpr_write_b32 a199, v71
    v_accvgpr_write_b32 a200, v72
    v_accvgpr_write_b32 a201, v73
    v_accvgpr_write_b32 a202, v74
    v_accvgpr_write_b32 a203, v75
    v_accvgpr_write_b32 a204, v76
    v_accvgpr_write_b32 a205, v77
    v_accvgpr_write_b32 a206, v78
    v_accvgpr_write_b32 a207, v79
    s_cmp_eq_u32 s63, 8
    s_cbranch_scc1 L_ldv_done
L_ldv8:
    s_call_b64 s[68:69], L_ldsub
    v_accvgpr_write_b32 a208, v64
    v_accvgpr_write_b32 a209, v65
    v_accvgpr_write_b32 a210, v66
    v_accvgpr_write_b32 a211, v67
    v_accvgpr_write_b32 a212, v68
    v_accvgpr_write_b32 a213, v69
    v_accvgpr_write_b32 a214, v70
    v_accvgpr_write_b32 a215, v71
    v_accvgpr_write_b32 a216, v72
    v_accvgpr_write_b32 a217, v73
    v_accvgpr_write_b32 a218, v74
    v_accvgpr_write_b32 a219, v75
    v_accvgpr_write_b32 a220, v76
    v_accvgpr_write_b32 a221, v77
    v_accvgpr_write_b32 a222, v78
    v_accvgpr_write_b32 a223, v79
    s_nop 1
L_ldv9:
    s_call_b64 s[68:69], L_ldsub
    v_accvgpr_write_b32 a224, v64
    v_accvgpr_write_b32 a225, v65
    v_accvgpr_write_b32 a226, v66
    v_accvgpr_write_b32 a227, v67
    v_accvgpr_write_b32 a228, v68
    v_accvgpr_write_b32 a229, v69
    v_accvgpr_write_b32 a230, v70
    v_accvgpr_write_b32 a231, v71
    v_accvgpr_write_b32 a232, v72
    v_accvgpr_write_b32 a233, v73
    v_accvgpr_write_b32 a234, v74
    v_accvgpr_write_b32 a235, v75
    v_accvgpr_write_b32 a236, v76
    v_accvgpr_write_b32 a237, v77
    v_accvgpr_write_b32 a238, v78
    v_accvgpr_write_b32 a239, v79
    s_cmp_eq_u32 s63, 8
    s_cbranch_scc1 L_ldv_done
L_ldv10:
    s_call_b64 s[68:69], L_ldsub
    v_accvgpr_write_b32 a240, v64
    v_accvgpr_write_b32 a241, v65
    v_accvgpr_write_b32 a242, v66
    v_accvgpr_write_b32 a243, v67
    v_accvgpr_write_b32 a244, v68
    v_accvgpr_write_b32 a245, v69
    v_accvgpr_write_b32 a246, v70
    v_accvgpr_write_b32 a247, v71
    v_accvgpr_write_b32 a248, v72
    v_accvgpr_write_b32 a249, v73
    v_accvgpr_write_b32 a250, v74
    v_accvgpr_write_b32 a251, v75
    v_accvgpr_write_b32 a252, v76
    v_accvgpr_write_b32 a253, v77
    v_accvgpr_write_b32 a254, v78
    v_accvgpr_write_b32 a255, v79
    s_nop 1
L_ldv11:
    s_call_b64 s[68:69], L_ldsub
    v_mov_b32 v144, v64
    v_mov_b32 v145, v65
    v_mov_b32 v146, v66
    v_mov_b32 v147, v67
    v_mov_b32 v148, v68
    v_mov_b32 v149, v69
    v_mov_b32 v150, v70
    v_mov_b32 v151, v71
    v_mov_b32 v152, v72
    v_mov_b32 v153, v73
    v_mov_b32 v154, v74
    v_mov_b32 v155, v75
    v_mov_b32 v156, v76
    v_mov_b32 v157, v77
    v_mov_b32 v158, v78
    v_mov_b32 v159, v79
    s_cmp_eq_u32 s63, 8
    s_cbranch_scc1 L_ldv_done
L_ldv12:
    s_call_b64 s[68:69], L_ldsub
    v_mov_b32 v160, v64
    v_mov_b32 v161, v65
    v_mov_b32 v162, v66
    v_mov_b32 v163, v67
    v_mov_b32 v164, v68
    v_mov_b32 v165, v69
    v_mov_b32 v166, v70
    v_mov_b32 v167, v71
    v_mov_b32 v168, v72
    v_mov_b32 v169, v73
    v_mov_b32 v170, v74
    v_mov_b32 v171, v75
    v_mov_b32 v172, v76
    v_mov_b32 v173, v77
    v_mov_b32 v174, v78
    v_mov_b32 v175, v79
    s_nop 1
L_ldv13:
    s_call_b64 s[68:69], L_ldsub
    v_mov_b32 v176, v64
    v_mov_b32 v177, v65
    v_mov_b32 v178, v66
    v_mov_b32 v179, v67
    v_mov_b32 v180, v68
    v_mov_b32 v181, v69
    v_mov_b32 v182, v70
    v_mov_b32 v183, v71
    v_mov_b32 v184, v72
    v_mov_b32 v185, v73
    v_mov_b32 v186, v74
    v_mov_b32 v187, v75
    v_mov_b32 v188, v76
    v_mov_b32 v189, v77
    v_mov_b32 v190, v78
    v_mov_b32 v191, v79
    s_nop 1
L_ldv_done:
    s_waitcnt vmcnt(0) lgkmcnt(0)
    s_barrier
    s_lshl_b32 s53, s49, 6
    v_add_u32 v97, s53, v125
    s_getpc_b64 s[96:97]
L_pc_c2:
    v_lshlrev_b32 v98, 7, v97
    s_mov_b32 s98, L_fast_end-L_pc_c2-4
    v_min_u32 v99, s98, v98
    global_load_dword v111, v99, s[96:97]
    v_lshrrev_b32 v101, 5, v125
    v_lshlrev_b32 v100, 14, v101
    v_bfe_u32 v101, v125, 4, 1
    v_lshl_add_u32 v100, v101, 12, v100
    v_and_b32 v101, 15, v125
    v_lshl_add_u32 v100, v101, 3, v100
    s_lshl_b32 s53, s48, 17
    s_lshl_b32 s54, s49, 7
    s_add_u32 s53, s53, s54
    v_add_u32 v100, s53, v100
    s_mov_b32 s44, s14
    s_and_b32 s45, s15, 0xffff
    s_mov_b32 s46, 0x400000
    s_mov_b32 s47, 0x20000
    s_mov_b32 s54, 0x0
    buffer_load_dwordx2 v[0:1], v100, s[44:47], s54 offen
    s_mov_b32 s54, 0x400
    buffer_load_dwordx2 v[2:3], v100, s[44:47], s54 offen
    s_mov_b32 s54, 0x2000
    buffer_load_dwordx2 v[4:5], v100, s[44:47], s54 offen
    s_mov_b32 s54, 0x2400
    buffer_load_dwordx2 v[6:7], v100, s[44:47], s54 offen
    s_mov_b32 s54, 0x800
    buffer_load_dwordx2 v[8:9], v100, s[44:47], s54 offen
    s_mov_b32 s54, 0xc00
    buffer_load_dwordx2 v[10:11], v100, s[44:47], s54 offen
    s_mov_b32 s54, 0x2800
    buffer_load_dwordx2 v[12:13], v100, s[44:47], s54 offen
    s_mov_b32 s54, 0x2c00
    buffer_load_dwordx2 v[14:15], v100, s[44:47], s54 offen
    s_mov_b32 s54, 0x8000
    buffer_load_dwordx2 v[16:17], v100, s[44:47], s54 offen
    s_mov_b32 s54, 0x8400
    buffer_load_dwordx2 v[18:19], v100, s[44:47], s54 offen
    s_mov_b32 s54, 0xa000
    buffer_load_dwordx2 v[20:21], v100, s[44:47], s54 offen
    s_mov_b32 s54, 0xa400
    buffer_load_dwordx2 v[22:23], v100, s[44:47], s54 offen
    s_mov_b32 s54, 0x8800
    buffer_load_dwordx2 v[24:25], v100, s[44:47], s54 offen
    s_mov_b32 s54, 0x8c00
    buffer_load_dwordx2 v[26:27], v100, s[44:47], s54 offen
    s_mov_b32 s54, 0xa800
    buffer_load_dwordx2 v[28:29], v100, s[44:47], s54 offen
    s_mov_b32 s54, 0xac00
    buffer_load_dwordx2 v[30:31], v100, s[44:47], s54 offen
    s_mov_b32 s54, 0x10000
    buffer_load_dwordx2 v[32:33], v100, s[44:47], s54 offen
    s_mov_b32 s54, 0x10400
    buffer_load_dwordx2 v[34:35], v100, s[44:47], s54 offen
    s_mov_b32 s54, 0x12000
    buffer_load_dwordx2 v[36:37], v100, s[44:47], s54 offen
    s_mov_b32 s54, 0x12400
    buffer_load_dwordx2 v[38:39], v100, s[44:47], s54 offen
    s_mov_b32 s54, 0x10800
    buffer_load_dwordx2 v[40:41], v100, s[44:47], s54 offen
    s_mov_b32 s54, 0x10c00
    buffer_load_dwordx2 v[42:43], v100, s[44:47], s54 offen
    s_mov_b32 s54, 0x12800
    buffer_load_dwordx2 v[44:45], v100, s[44:47], s54 offen
    s_mov_b32 s54, 0x12c00
    buffer_load_dwordx2 v[46:47], v100, s[44:47], s54 offen
    s_mov_b32 s54, 0x18000
    buffer_load_dwordx2 v[48:49], v100, s[44:47], s54 offen
    s_mov_b32 s54, 0x18400
    buffer_load_dwordx2 v[50:51], v100, s[44:47], s54 offen
    s_mov_b32 s54, 0x1a000
    buffer_load_dwordx2 v[52:53], v100, s[44:47], s54 offen
    s_mov_b32 s54, 0x1a400
    buffer_load_dwordx2 v[54:55], v100, s[44:47], s54 offen
    s_mov_b32 s54, 0x18800
    buffer_load_dwordx2 v[56:57], v100, s[44:47], s54 offen
    s_mov_b32 s54, 0x18c00
    buffer_load_dwordx2 v[58:59], v100, s[44:47], s54 offen
    s_mov_b32 s54, 0x1a800
    buffer_load_dwordx2 v[60:61], v100, s[44:47], s54 offen
    s_mov_b32 s54, 0x1ac00
    buffer_load_dwordx2 v[62:63], v100, s[44:47], s54 offen
    s_mov_b32 s54, 0x200
    buffer_load_dwordx2 v[64:65], v100, s[44:47], s54 offen
    s_mov_b32 s54, 0x600
    buffer_load_dwordx2 v[66:67], v100, s[44:47], s54 offen
    s_mov_b32 s54, 0x2200
    buffer_load_dwordx2 v[68:69], v100, s[44:47], s54 offen
    s_mov_b32 s54, 0x2600
    buffer_load_dwordx2 v[70:71], v100, s[44:47], s54 offen
    s_mov_b32 s54, 0xa00
    buffer_load_dwordx2 v[72:73], v100, s[44:47], s54 offen
    s_mov_b32 s54, 0xe00
    buffer_load_dwordx2 v[74:75], v100, s[44:47], s54 offen
    s_mov_b32 s54, 0x2a00
    buffer_load_dwordx2 v[76:77], v100, s[44:47], s54 offen
    s_mov_b32 s54, 0x2e00
    buffer_load_dwordx2 v[78:79], v100, s[44:47], s54 offen
    s_mov_b32 s54, 0x8200
    buffer_load_dwordx2 v[80:81], v100, s[44:47], s54 offen
    s_mov_b32 s54, 0x8600
    buffer_load_dwordx2 v[82:83], v100, s[44:47], s54 offen
    s_mov_b32 s54, 0xa200
    buffer_load_dwordx2 v[84:85], v100, s[44:47], s54 offen
    s_mov_b32 s54, 0xa600
    buffer_load_dwordx2 v[86:87], v100, s[44:47], s54 offen
    s_mov_b32 s54, 0x8a00
    buffer_load_dwordx2 v[88:89], v100, s[44:47], s54 offen
    s_mov_b32 s54, 0x8e00
    buffer_load_dwordx2 v[90:91], v100, s[44:47], s54 offen
    s_mov_b32 s54, 0xaa00
    buffer_load_dwordx2 v[92:93], v100, s[44:47], s54 offen
    s_mov_b32 s54, 0xae00
    buffer_load_dwordx2 v[94:95], v100, s[44:47], s54 offen
    s_waitcnt vmcnt(46)
    v_perm_b32 v192, v2, v0, s50
    s_waitcnt vmcnt(44)
    v_perm_b32 v193, v6, v4, s50
    s_waitcnt vmcnt(42)
    v_perm_b32 v194, v10, v8, s50
    s_waitcnt vmcnt(40)
    v_perm_b32 v195, v14, v12, s50
    s_waitcnt vmcnt(38)
    v_perm_b32 v196, v18, v16, s50
    s_waitcnt vmcnt(36)
    v_perm_b32 v197, v22, v20, s50
    s_waitcnt vmcnt(34)
    v_perm_b32 v198, v26, v24, s50
    s_waitcnt vmcnt(32)
    v_perm_b32 v199, v30, v28, s50
    v_perm_b32 v200, v2, v0, s51
    v_perm_b32 v201, v6, v4, s51
    v_perm_b32 v202, v10, v8, s51
    v_perm_b32 v203, v14, v12, s51
    v_perm_b32 v204, v18, v16, s51
    v_perm_b32 v205, v22, v20, s51
    v_perm_b32 v206, v26, v24, s51
    v_perm_b32 v207, v30, v28, s51
    v_perm_b32 v208, v3, v1, s50
    v_perm_b32 v209, v7, v5, s50
    v_perm_b32 v210, v11, v9, s50
    v_perm_b32 v211, v15, v13, s50
    v_perm_b32 v212, v19, v17, s50
    v_perm_b32 v213, v23, v21, s50
    v_perm_b32 v214, v27, v25, s50
    v_perm_b32 v215, v31, v29, s50
    v_perm_b32 v216, v3, v1, s51
    v_perm_b32 v217, v7, v5, s51
    v_perm_b32 v218, v11, v9, s51
    v_perm_b32 v219, v15, v13, s51
    v_perm_b32 v220, v19, v17, s51
    v_perm_b32 v221, v23, v21, s51
    v_perm_b32 v222, v27, v25, s51
    v_perm_b32 v223, v31, v29, s51
    s_mov_b32 s54, 0x10200
    buffer_load_dwordx2 v[0:1], v100, s[44:47], s54 offen
    s_mov_b32 s54, 0x10600
    buffer_load_dwordx2 v[2:3], v100, s[44:47], s54 offen
    s_mov_b32 s54, 0x12200
    buffer_load_dwordx2 v[4:5], v100, s[44:47], s54 offen
    s_mov_b32 s54, 0x12600
    buffer_load_dwordx2 v[6:7], v100, s[44:47], s54 offen
    s_mov_b32 s54, 0x10a00
    buffer_load_dwordx2 v[8:9], v100, s[44:47], s54 offen
    s_mov_b32 s54, 0x10e00
    buffer_load_dwordx2 v[10:11], v100, s[44:47], s54 offen
    s_mov_b32 s54, 0x12a00
    buffer_load_dwordx2 v[12:13], v100, s[44:47], s54 offen
    s_mov_b32 s54, 0x12e00
    buffer_load_dwordx2 v[14:15], v100, s[44:47], s54 offen
    s_mov_b32 s54, 0x18200
    buffer_load_dwordx2 v[16:17], v100, s[44:47], s54 offen
    s_mov_b32 s54, 0x18600
    buffer_load_dwordx2 v[18:19], v100, s[44:47], s54 offen
    s_mov_b32 s54, 0x1a200
    buffer_load_dwordx2 v[20:21], v100, s[44:47], s54 offen
    s_mov_b32 s54, 0x1a600
    buffer_load_dwordx2 v[22:23], v100, s[44:47], s54 offen
    s_mov_b32 s54, 0x18a00
    buffer_load_dwordx2 v[24:25], v100, s[44:47], s54 offen
    s_mov_b32 s54, 0x18e00
    buffer_load_dwordx2 v[26:27], v100, s[44:47], s54 offen
    s_mov_b32 s54, 0x1aa00
    buffer_load_dwordx2 v[28:29], v100, s[44:47], s54 offen
    s_mov_b32 s54, 0x1ae00
    buffer_load_dwordx2 v[30:31], v100, s[44:47], s54 offen
    s_waitcnt vmcnt(46)
    v_perm_b32 v128, v34, v32, s50
    s_waitcnt vmcnt(44)
    v_perm_b32 v129, v38, v36, s50
    s_waitcnt vmcnt(42)
    v_perm_b32 v130, v42, v40, s50
    s_waitcnt vmcnt(40)
    v_perm_b32 v131, v46, v44, s50
    s_waitcnt vmcnt(38)
    v_perm_b32 v132, v50, v48, s50
    s_waitcnt vmcnt(36)
    v_perm_b32 v133, v54, v52, s50
    s_waitcnt vmcnt(34)
    v_perm_b32 v134, v58, v56, s50
    s_waitcnt vmcnt(32)
    v_perm_b32 v135, v62, v60, s50
    ds_write_b128 v113, v[128:131] offset:20480
    ds_write_b128 v113, v[132:135] offset:21504
    v_perm_b32 v136, v34, v32, s51
    v_perm_b32 v137, v38, v36, s51
    v_perm_b32 v138, v42, v40, s51
    v_perm_b32 v139, v46, v44, s51
    v_perm_b32 v140, v50, v48, s51
    v_perm_b32 v141, v54, v52, s51
    v_perm_b32 v142, v58, v56, s51
    v_perm_b32 v143, v62, v60, s51
    ds_write_b128 v113, v[136:139] offset:22528
    ds_write_b128 v113, v[140:143] offset:23552
    v_perm_b32 v128, v35, v33, s50
    v_perm_b32 v129, v39, v37, s50
    v_perm_b32 v130, v43, v41, s50
    v_perm_b32 v131, v47, v45, s50
    v_perm_b32 v132, v51, v49, s50
    v_perm_b32 v133, v55, v53, s50
    v_perm_b32 v134, v59, v57, s50
    v_perm_b32 v135, v63, v61, s50
    ds_write_b128 v113, v[128:131] offset:24576
    ds_write_b128 v113, v[132:135] offset:25600
    v_perm_b32 v136, v35, v33, s51
    v_perm_b32 v137, v39, v37, s51
    v_perm_b32 v138, v43, v41, s51
    v_perm_b32 v139, v47, v45, s51
    v_perm_b32 v140, v51, v49, s51
    v_perm_b32 v141, v55, v53, s51
    v_perm_b32 v142, v59, v57, s51
    v_perm_b32 v143, v63, v61, s51
    ds_write_b128 v113, v[136:139] offset:26624
    ds_write_b128 v113, v[140:143] offset:27648
    s_waitcnt vmcnt(30)
    v_perm_b32 v224, v66, v64, s50
    s_waitcnt vmcnt(28)
    v_perm_b32 v225, v70, v68, s50
    s_waitcnt vmcnt(26)
    v_perm_b32 v226, v74, v72, s50
    s_waitcnt vmcnt(24)
    v_perm_b32 v227, v78, v76, s50
    s_waitcnt vmcnt(22)
    v_perm_b32 v228, v82, v80, s50
    s_waitcnt vmcnt(20)
    v_perm_b32 v229, v86, v84, s50
    s_waitcnt vmcnt(18)
    v_perm_b32 v230, v90, v88, s50
    s_waitcnt vmcnt(16)
    v_perm_b32 v231, v94, v92, s50
    v_perm_b32 v232, v66, v64, s51
    v_perm_b32 v233, v70, v68, s51
    v_perm_b32 v234, v74, v72, s51
    v_perm_b32 v235, v78, v76, s51
    v_perm_b32 v236, v82, v80, s51
    v_perm_b32 v237, v86, v84, s51
    v_perm_b32 v238, v90, v88, s51
    v_perm_b32 v239, v94, v92, s51
    v_perm_b32 v240, v67, v65, s50
    v_perm_b32 v241, v71, v69, s50
    v_perm_b32 v242, v75, v73, s50
    v_perm_b32 v243, v79, v77, s50
    v_perm_b32 v244, v83, v81, s50
    v_perm_b32 v245, v87, v85, s50
    v_perm_b32 v246, v91, v89, s50
    v_perm_b32 v247, v95, v93, s50
    v_perm_b32 v248, v67, v65, s51
    v_perm_b32 v249, v71, v69, s51
    v_perm_b32 v250, v75, v73, s51
    v_perm_b32 v251, v79, v77, s51
    v_perm_b32 v252, v83, v81, s51
    v_perm_b32 v253, v87, v85, s51
    v_perm_b32 v254, v91, v89, s51
    v_perm_b32 v255, v95, v93, s51
    s_waitcnt vmcnt(14)
    v_perm_b32 v128, v2, v0, s50
    s_waitcnt vmcnt(12)
    v_perm_b32 v129, v6, v4, s50
    s_waitcnt vmcnt(10)
    v_perm_b32 v130, v10, v8, s50
    s_waitcnt vmcnt(8)
    v_perm_b32 v131, v14, v12, s50
    s_waitcnt vmcnt(6)
    v_perm_b32 v132, v18, v16, s50
    s_waitcnt vmcnt(4)
    v_perm_b32 v133, v22, v20, s50
    s_waitcnt vmcnt(2)
    v_perm_b32 v134, v26, v24, s50
    s_waitcnt vmcnt(0)
    v_perm_b32 v135, v30, v28, s50
    ds_write_b128 v113, v[128:131] offset:28672
    ds_write_b128 v113, v[132:135] offset:29696
    v_perm_b32 v136, v2, v0, s51
    v_perm_b32 v137, v6, v4, s51
    v_perm_b32 v138, v10, v8, s51
    v_perm_b32 v139, v14, v12, s51
    v_perm_b32 v140, v18, v16, s51
    v_perm_b32 v141, v22, v20, s51
    v_perm_b32 v142, v26, v24, s51
    v_perm_b32 v143, v30, v28, s51
    ds_write_b128 v113, v[136:139] offset:30720
    ds_write_b128 v113, v[140:143] offset:31744
    v_perm_b32 v128, v3, v1, s50
    v_perm_b32 v129, v7, v5, s50
    v_perm_b32 v130, v11, v9, s50
    v_perm_b32 v131, v15, v13, s50
    v_perm_b32 v132, v19, v17, s50
    v_perm_b32 v133, v23, v21, s50
    v_perm_b32 v134, v27, v25, s50
    v_perm_b32 v135, v31, v29, s50
    ds_write_b128 v113, v[128:131] offset:32768
    ds_write_b128 v113, v[132:135] offset:33792
    v_perm_b32 v136, v3, v1, s51
    v_perm_b32 v137, v7, v5, s51
    v_perm_b32 v138, v11, v9, s51
    v_perm_b32 v139, v15, v13, s51
    v_perm_b32 v140, v19, v17, s51
    v_perm_b32 v141, v23, v21, s51
    v_perm_b32 v142, v27, v25, s51
    v_perm_b32 v143, v31, v29, s51
    ds_write_b128 v113, v[136:139] offset:34816
    ds_write_b128 v113, v[140:143] offset:35840
    s_mov_b32 s72, 0x00ff00ff
    s_mov_b32 s73, 0
    s_mov_b32 s74, 0xff00ff00
    s_mov_b32 s75, 0xff00ff00
    s_mov_b32 s76, 0x3e0293ee
    s_lshl_b32 s77, s49, 10
    s_lshl_b32 s62, s49, 15
    s_mov_b32 s52, 0
    s_mov_b32 s60, 0
    s_mov_b32 s64, 0x40000
    s_lshl_b32 s65, s48, 8
    s_add_u32 s65, s65, 0x40000
    s_lshl_b32 s54, s48, 13
    s_add_u32 s67, s54, 0x100000
    s_lshl_b32 s54, s48, 6
    s_add_u32 s68, s54, 0x100000
    s_add_u32 s69, s68, 0x20000
    s_lshl_b32 s54, s48, 13
    s_add_u32 s70, s54, 0x1040000
    s_lshl_b32 s54, s48, 12
    s_add_u32 s71, s54, 0x40bc000
    s_lshl_b32 s81, s48, 9
    s_add_u32 s81, s81, 0x201000
    s_lshl_b32 s66, s48, 7
    s_add_u32 s66, s66, 0x207000
    v_mov_b32 v2, 16
    s_nop 1
L_fi69:
    global_load_dword v3, v2, s[34:35] sc1
    s_waitcnt vmcnt(0)
    v_readfirstlane_b32 s54, v3
    s_and_b32 s53, s54, 0xffff
    s_cmp_ge_u32 s53, 32
    s_nop 1
    s_cbranch_scc1 L_fd70
    s_add_u32 s60, s60, 1
    s_cmp_gt_u32 s60, 0x40000
    s_cbranch_scc1 L_exit
    s_sleep 2
    s_branch L_fi69
L_fd70:
    s_lshr_b32 s56, s54, 16
    v_mbcnt_lo_u32_b32 v96, -1, 0
    v_mbcnt_hi_u32_b32 v96, -1, v96
    v_min_u32 v96, 6, v96
    v_lshlrev_b32 v97, 6, v96
    s_nop 1
L_init_hzl:
    buffer_load_dword v98, v97, s[40:43], s81 offen sc1
    s_waitcnt vmcnt(0)
    v_mul_u32_u24 v98, 7, v98
    v_add_u32 v98, v98, v96
    s_nop 0
    v_readlane_b32 s80, v98, 0
    v_readlane_b32 s54, v98, 1
    s_min_u32 s80, s80, s54
    v_readlane_b32 s54, v98, 2
    s_min_u32 s80, s80, s54
    v_readlane_b32 s54, v98, 3
    s_min_u32 s80, s80, s54
    v_readlane_b32 s54, v98, 4
    s_min_u32 s80, s80, s54
    v_readlane_b32 s54, v98, 5
    s_min_u32 s80, s80, s54
    v_readlane_b32 s54, v98, 6
    s_min_u32 s80, s80, s54
    s_cmp_ge_u32 s80, 64
    s_cselect_b32 s80, 0x100, s80
    s_add_u32 s53, s52, 3
    s_cmp_lt_u32 s53, s80
    s_cbranch_scc1 L_init_hzd
    s_add_u32 s60, s60, 1
    s_cmp_gt_u32 s60, 0x40000
    s_cbranch_scc1 L_exit
    s_sleep 4
    s_branch L_init_hzl
L_init_hzd:
    s_sub_u32 s53, s70, 0x40000
    buffer_load_dwordx4 v[72:75], v124, s[40:43], s53 offen
    buffer_load_dwordx4 v[76:79], v124, s[40:43], s53 offen offset:1024
    s_add_u32 s53, s53, 0x1000000
    buffer_load_dwordx4 v[80:83], v124, s[40:43], s53 offen
    buffer_load_dwordx4 v[84:87], v124, s[40:43], s53 offen offset:1024
    v_bfe_u32 v100, v125, 1, 3
    v_lshlrev_b32 v100, 10, v100
    v_lshrrev_b32 v101, 4, v125
    v_lshl_add_u32 v100, v101, 5, v100
    v_and_b32 v101, 1, v125
    v_lshl_add_u32 v100, v101, 4, v100
    s_lshl_b32 s53, s49, 8
    v_add_u32 v100, s53, v100
    global_load_dwordx4 v[0:3], v100, s[6:7] offset:0
    global_load_dwordx4 v[4:7], v100, s[6:7] offset:128
    ds_read_b128 v[32:35], v113 offset:0
    ds_read_b128 v[36:39], v113 offset:1024
    ds_read_b128 v[40:43], v113 offset:2048
    ds_read_b128 v[44:47], v113 offset:3072
    v_mov_b32 v48, 0
    v_mov_b32 v49, 0
    v_mov_b32 v50, 0
    v_mov_b32 v51, 0
    v_mov_b32 v52, 0
    v_mov_b32 v53, 0
    v_mov_b32 v54, 0
    v_mov_b32 v55, 0
    v_mov_b32 v56, 0
    v_mov_b32 v57, 0
    v_mov_b32 v58, 0
    v_mov_b32 v59, 0
    v_mov_b32 v60, 0
    v_mov_b32 v61, 0
    v_mov_b32 v62, 0
    v_mov_b32 v63, 0
    v_mov_b32 v64, 0
    v_mov_b32 v65, 0
    v_mov_b32 v66, 0
    v_mov_b32 v67, 0
    v_mov_b32 v68, 0
    v_mov_b32 v69, 0
    v_mov_b32 v70, 0
    v_mov_b32 v71, 0
    v_mov_b32 v128, 0
    v_mov_b32 v129, 0
    v_mov_b32 v130, 0
    v_mov_b32 v131, 0
    v_mov_b32 v132, 0
    v_mov_b32 v133, 0
    v_mov_b32 v134, 0
    v_mov_b32 v135, 0
    v_bfe_u32 v127, v125, 2, 2
    v_lshlrev_b32 v127, 13, v127
    v_lshrrev_b32 v104, 4, v125
    v_lshl_add_u32 v127, v104, 11, v127
    v_and_b32 v104, 3, v125
    v_lshl_add_u32 v127, v104, 4, v127
    v_add_u32 v127, s62, v127
    v_and_b32 v105, 1, v125
    v_lshlrev_b32 v105, 4, v105
    v_mov_b32 v106, 0x3f80
    v_lshlrev_b32 v105, v105, v106
    v_bfe_u32 v106, v125, 1, 3
    v_cmp_eq_u32 vcc, 0, v106
    s_nop 1
    v_cndmask_b32 v136, 0, v105, vcc
    v_cmp_eq_u32 vcc, 1, v106
    s_nop 1
    v_cndmask_b32 v137, 0, v105, vcc
    v_cmp_eq_u32 vcc, 2, v106
    s_nop 1
    v_cndmask_b32 v138, 0, v105, vcc
    v_cmp_eq_u32 vcc, 3, v106
    s_nop 1
    v_cndmask_b32 v139, 0, v105, vcc
    v_bfe_u32 v140, v125, 2, 1
    v_lshlrev_b32 v140, 5, v140
    v_bfe_u32 v105, v125, 1, 1
    v_lshl_add_u32 v140, v105, 4, v140
    v_and_b32 v105, 1, v125
    v_lshl_add_u32 v140, v105, 3, v140
    v_bfe_u32 v105, v125, 4, 1
    v_lshl_add_u32 v140, v105, 2, v140
    s_lshl_b32 s53, s49, 6
    v_add_u32 v140, s53, v140
    v_lshrrev_b32 v141, 5, v125
    v_add_u32 v141, 1, v141
    v_lshlrev_b32 v141, 18, v141
    v_bfe_u32 v105, v125, 4, 1
    v_lshl_add_u32 v141, v105, 24, v141
    v_and_b32 v105, 15, v125
    v_lshl_add_u32 v141, v105, 7, v141
    s_lshl_b32 s53, s49, 11
    v_add_u32 v141, s53, v141
    v_mov_b32 v142, 0
    v_mov_b32 v143, 0
    v_add_u32 v125, s77, v114
    s_mov_b32 s38, 0xf0f0f0f0
    s_mov_b32 s39, 0xf0f0f0f0
    s_waitcnt lgkmcnt(0)
    s_waitcnt vmcnt(0)
    s_cmp_lg_u32 s56, 0
    s_cbranch_scc1 L_s0_go
    s_branch L_f0_go
L_f0_rt:
    s_waitcnt vmcnt(0)
    v_bitop3_b32 v104, v0, v1, v2 bitop3:0x80
    v_bitop3_b32 v105, v3, v4, v5 bitop3:0x80
    v_bitop3_b32 v104, v104, v6, v7 bitop3:0x80
    v_bitop3_b32 v104, v104, v105, 1 bitop3:0x80
    v_cmp_eq_u32 vcc, 0, v104
    s_nop 0
    s_cbranch_vccz L_f0_go
    s_add_u32 s60, s60, 1
    s_cmp_gt_u32 s60, 0x40000
    s_cbranch_scc1 L_exit
    s_mov_b64 exec, vcc
    buffer_load_dwordx4 v[0:3], v124, s[40:43], s64 offen sc1
    buffer_load_dwordx4 v[4:7], v124, s[40:43], s64 offen offset:1024 sc1
    s_mov_b64 exec, -1
    s_branch L_f0_rt
L_f0_top:
    s_waitcnt vmcnt(2)
    v_bitop3_b32 v104, v0, v1, v2 bitop3:0x80
    v_bitop3_b32 v105, v3, v4, v5 bitop3:0x80
    v_bitop3_b32 v104, v104, v6, v7 bitop3:0x80
    v_bitop3_b32 v104, v104, v105, 1 bitop3:0x80
    v_cmp_eq_u32 vcc, 0, v104
    s_nop 0
    s_cbranch_vccnz L_f0_rt
L_f0_go:
    v_smfmac_f32_16x16x64_bf16 v[48:51], v[0:3], a[0:7], v112
    ds_write_b128 v115, v[0:3] offset:0
    v_smfmac_f32_16x16x64_bf16 v[52:55], v[0:3], v[32:39], v112
    ds_write_b128 v115, v[4:7] offset:1024
    v_smfmac_f32_16x16x64_bf16 v[48:51], v[4:7], a[8:15], v112
    ds_read_b128 v[32:35], v113 offset:4096
    v_smfmac_f32_16x16x64_bf16 v[52:55], v[4:7], v[40:47], v112
    ds_read_b128 v[36:39], v113 offset:5120
    v_smfmac_f32_16x16x64_bf16 v[56:59], v[0:3], a[80:87], v112
    ds_read_b128 v[40:43], v113 offset:6144
    v_smfmac_f32_16x16x64_bf16 v[60:63], v[0:3], a[88:95], v112
    ds_read_b128 v[44:47], v113 offset:7168
    v_smfmac_f32_16x16x64_bf16 v[56:59], v[4:7], a[96:103], v112
    s_waitcnt lgkmcnt(4)
    s_barrier
    ds_read_b128 v[8:11], v116 offset:0
    v_smfmac_f32_16x16x64_bf16 v[60:63], v[4:7], a[104:111], v112
    ds_read_b128 v[12:15], v116 offset:1024
    v_smfmac_f32_16x16x64_bf16 v[64:67], v[0:3], a[176:183], v112
    ds_read_b128 v[16:19], v117 offset:0
    buffer_store_dwordx4 v[128:131], v125, s[40:43], s71 offen sc1
    v_smfmac_f32_16x16x64_bf16 v[68:71], v[0:3], a[184:191], v112
    ds_read_b128 v[20:23], v117 offset:1024
    v_smfmac_f32_16x16x64_bf16 v[64:67], v[4:7], a[192:199], v112
    ds_read_b128 v[24:27], v118 offset:0
    buffer_load_dword v126, v141, s[40:43], s70 offen
    v_smfmac_f32_16x16x64_bf16 v[68:71], v[4:7], a[200:207], v112
    ds_read_b128 v[28:31], v118 offset:1024
    s_waitcnt lgkmcnt(5)
    v_smfmac_f32_16x16x64_bf16 v[48:51], v[8:11], v[32:39], v112
    v_smfmac_f32_16x16x64_bf16 v[52:55], v[8:11], a[16:23], v112
    ds_read_b128 v[32:35], v113 offset:8192
    s_waitcnt lgkmcnt(5)
    v_smfmac_f32_16x16x64_bf16 v[48:51], v[12:15], v[40:47], v112
    ds_read_b128 v[36:39], v113 offset:9216
    v_smfmac_f32_16x16x64_bf16 v[52:55], v[12:15], a[24:31], v112
    ds_read_b128 v[40:43], v113 offset:10240
    s_waitcnt lgkmcnt(6)
    v_smfmac_f32_16x16x64_bf16 v[48:51], v[16:19], a[32:39], v112
    ds_read_b128 v[44:47], v113 offset:11264
    v_smfmac_f32_16x16x64_bf16 v[52:55], v[16:19], a[40:47], v112
    s_waitcnt lgkmcnt(6)
    v_smfmac_f32_16x16x64_bf16 v[48:51], v[20:23], a[48:55], v112
    s_waitcnt lgkmcnt(2)
    v_smfmac_f32_16x16x64_bf16 v[52:55], v[20:23], v[32:39], v112
    v_smfmac_f32_16x16x64_bf16 v[48:51], v[24:27], a[56:63], v112
    ds_read_b128 v[32:35], v113 offset:12288
    s_waitcnt lgkmcnt(1)
    v_smfmac_f32_16x16x64_bf16 v[52:55], v[24:27], v[40:47], v112
    ds_read_b128 v[36:39], v113 offset:13312
    v_smfmac_f32_16x16x64_bf16 v[48:51], v[28:31], a[64:71], v112
    ds_read_b128 v[40:43], v113 offset:14336
    v_smfmac_f32_16x16x64_bf16 v[52:55], v[28:31], a[72:79], v112
    ds_read_b128 v[44:47], v113 offset:15360
    v_smfmac_f32_16x16x64_bf16 v[56:59], v[8:11], a[112:119], v112
    v_smfmac_f32_16x16x64_bf16 v[60:63], v[8:11], a[120:127], v112
    s_nop 2
    v_add_f32 v48, v48, v49
    s_nop 0
    v_add_f32 v52, v52, v53
    v_add_f32 v50, v50, v51
    v_add_f32 v54, v54, v55
    v_cvt_pk_bf16_f32 v104, v48, v52
    v_cvt_pk_bf16_f32 v105, v50, v54
    ds_write_b32 v119, v104 offset:8192
    ds_write_b32 v119, v105 offset:8208
    ds_read_b128 v[108:111], v121 offset:8192
    s_waitcnt lgkmcnt(5)
    v_smfmac_f32_16x16x64_bf16 v[56:59], v[12:15], v[32:39], v112
    v_smfmac_f32_16x16x64_bf16 v[60:63], v[12:15], a[128:135], v112
    ds_read_b128 v[32:35], v113 offset:16384
    s_waitcnt lgkmcnt(4)
    v_smfmac_f32_16x16x64_bf16 v[56:59], v[16:19], v[40:47], v112
    ds_read_b128 v[36:39], v113 offset:17408
    v_smfmac_f32_16x16x64_bf16 v[60:63], v[16:19], a[136:143], v112
    ds_read_b128 v[40:43], v113 offset:18432
    s_waitcnt lgkmcnt(3)
    v_mfma_f32_16x16x32_bf16 v[48:51], v[72:75], v[108:111], 0
    ds_read_b128 v[44:47], v113 offset:19456
    v_mfma_f32_16x16x32_bf16 v[52:55], v[76:79], v[108:111], 0
    v_smfmac_f32_16x16x64_bf16 v[56:59], v[20:23], a[144:151], v112
    v_smfmac_f32_16x16x64_bf16 v[60:63], v[20:23], a[152:159], v112
    v_smfmac_f32_16x16x64_bf16 v[56:59], v[24:27], a[160:167], v112
    s_not_b64 exec, s[74:75]
    s_nop 1
    ds_write_b128 v125, v[48:51] offset:12288
    s_mov_b64 exec, s[74:75]
    ds_write_b128 v125, v[52:55] offset:12288
    s_mov_b64 exec, -1
    s_waitcnt lgkmcnt(4)
    v_smfmac_f32_16x16x64_bf16 v[60:63], v[24:27], v[32:39], v112
    v_smfmac_f32_16x16x64_bf16 v[56:59], v[28:31], a[168:175], v112
    s_waitcnt lgkmcnt(2)
    v_smfmac_f32_16x16x64_bf16 v[60:63], v[28:31], v[40:47], v112
    s_waitcnt lgkmcnt(0)
    s_barrier
    v_smfmac_f32_16x16x64_bf16 v[64:67], v[8:11], a[208:215], v112
    ds_read_b128 v[48:51], v114 offset:12288
    v_smfmac_f32_16x16x64_bf16 v[68:71], v[8:11], a[216:223], v112
    ds_read_b128 v[52:55], v114 offset:13312
    v_smfmac_f32_16x16x64_bf16 v[64:67], v[12:15], a[224:231], v112
    ds_read_b128 v[108:111], v114 offset:14336
    v_add_f32 v56, v56, v57
    v_add_f32 v60, v60, v61
    v_add_f32 v58, v58, v59
    v_add_f32 v62, v62, v63
    v_cvt_pk_bf16_f32 v128, v56, v60
    v_cvt_pk_bf16_f32 v129, v58, v62
    ds_write_b32 v119, v128 offset:10240
    ds_write_b32 v119, v129 offset:10256
    v_smfmac_f32_16x16x64_bf16 v[68:71], v[12:15], a[232:239], v112
    ds_read_b128 v[60:63], v114 offset:15360
    v_smfmac_f32_16x16x64_bf16 v[64:67], v[16:19], a[240:247], v112
    ds_read_b128 v[96:99], v120 offset:8192
    v_smfmac_f32_16x16x64_bf16 v[68:71], v[16:19], a[248:255], v112
    ds_read_b128 v[100:103], v120 offset:8704
    v_smfmac_f32_16x16x64_bf16 v[64:67], v[20:23], v[144:151], v112
    s_waitcnt lgkmcnt(6)
    v_add_f32 v48, v48, v52
    s_waitcnt lgkmcnt(3)
    s_barrier
    ds_read_b128 v[88:91], v122 offset:10240
    v_smfmac_f32_16x16x64_bf16 v[68:71], v[20:23], v[152:159], v112
    ds_read_b128 v[92:95], v122 offset:10752
    v_add_f32 v49, v49, v53
    v_smfmac_f32_16x16x64_bf16 v[64:67], v[24:27], v[160:167], v112
    v_add_f32 v50, v50, v54
    v_smfmac_f32_16x16x64_bf16 v[68:71], v[24:27], v[168:175], v112
    v_add_f32 v51, v51, v55
    v_smfmac_f32_16x16x64_bf16 v[64:67], v[28:31], v[176:183], v112
    s_waitcnt lgkmcnt(4)
    v_add_f32 v108, v108, v60
    v_smfmac_f32_16x16x64_bf16 v[68:71], v[28:31], v[184:191], v112
    v_add_f32 v109, v109, v61
    s_waitcnt lgkmcnt(1)
    v_mfma_f32_16x16x32_bf16 v[56:59], v[88:91], v[96:99], 0
    v_add_f32 v110, v110, v62
    s_waitcnt lgkmcnt(0)
    v_mfma_f32_16x16x32_bf16 v[56:59], v[92:95], v[100:103], v[56:59]
    v_add_f32 v111, v111, v63
    v_add_f32 v104, v48, v108
    ds_read_b128 v[32:35], v113 offset:20480
    v_add_f32 v105, v49, v109
    v_add_f32 v106, v50, v110
    v_add_f32 v107, v51, v111
    v_max3_f32 v108, v104, v105, v106
    ds_read_b128 v[36:39], v113 offset:21504
    v_add_f32_dpp v109, v58, v56 row_ror:8 row_mask:0xf bank_mask:0x3
    v_add_f32_dpp v109, v57, v59 row_ror:8 row_mask:0xf bank_mask:0xc
    v_max3_f32 v108, v108, v107, v109
    v_add_f32 v64, v64, v65
    ds_read_b128 v[40:43], v113 offset:22528
    v_add_f32 v66, v66, v67
    v_max_f32_dpp v108, v108, v108 row_ror:8 row_mask:0xf bank_mask:0xf
    v_mov_b32 v110, v108
    v_cvt_pk_bf16_f32 v130, v64, v66
    ds_read_b128 v[44:47], v113 offset:23552
    v_add_f32 v68, v68, v69
    v_permlane16_swap_b32 v108, v110
    v_max_f32 v108, v108, v110
    v_mov_b32 v110, v108
    v_add_f32 v70, v70, v71
    v_cvt_pk_bf16_f32 v131, v68, v70
    v_permlane32_swap_b32 v108, v110
    v_max_f32 v108, v108, v110
    v_mul_f32 v108, s76, v108
    v_fma_f32 v109, v109, s76, -v108
    v_fma_f32 v104, v104, s76, -v108
    v_fma_f32 v105, v105, s76, -v108
    v_fma_f32 v106, v106, s76, -v108
    v_fma_f32 v107, v107, s76, -v108
    v_exp_f32 v109, v109
    v_exp_f32 v104, v104
    v_exp_f32 v105, v105
    v_exp_f32 v106, v106
    v_exp_f32 v107, v107
    v_cvt_pk_bf16_f32 v60, v104, v105
    v_mov_b32_dpp v110, v109 row_ror:8 row_mask:0xf bank_mask:0xf
    v_cvt_pk_bf16_f32 v61, v106, v107
    v_mov_b32_dpp v62, v60 row_ror:8 row_mask:0xf bank_mask:0xf
    v_cvt_pk_bf16_f32 v132, v109, v110
    v_mov_b32_dpp v63, v61 row_ror:8 row_mask:0xf bank_mask:0xf
    v_cvt_pk_bf16_f32 v135, v109, v110
    s_nop 0
    v_mfma_f32_16x16x32_bf16 v[48:51], v[80:83], v[60:63], 0
    v_mfma_f32_16x16x32_bf16 v[52:55], v[84:87], v[60:63], 0
    v_add_f32 v111, v104, v105
    v_add_f32 v110, v106, v107
    v_add_f32 v111, v111, v109
    s_nop 1
    v_mfma_f32_16x16x16_bf16 v[48:51], v[130:131], v[132:133], v[48:51]
    v_add_f32 v111, v111, v110
    v_mfma_f32_16x16x16_bf16 v[52:55], v[130:131], v[134:135], v[52:55]
    v_mov_b32 v24, 0
    v_mov_b32 v25, 0
    v_add_f32_dpp v111, v111, v111 row_ror:8 row_mask:0xf bank_mask:0xf
    v_mov_b32 v110, v111
    v_mov_b32 v26, 0
    v_mov_b32 v27, 0
    v_permlane16_swap_b32 v111, v110
    v_add_f32 v111, v111, v110
    v_mov_b32 v110, v111
    v_mov_b32 v28, 0
    v_mov_b32 v29, 0
    v_permlane32_swap_b32 v111, v110
    v_add_f32 v111, v111, v110
    v_rcp_f32 v111, v111
    s_nop 0
    v_pk_mul_f32 v[48:49], v[48:49], v[110:111] op_sel:[0,1] op_sel_hi:[1,1]
    v_pk_mul_f32 v[52:53], v[52:53], v[110:111] op_sel:[0,1] op_sel_hi:[1,1]
    v_pk_mul_f32 v[50:51], v[50:51], v[110:111] op_sel:[0,1] op_sel_hi:[1,1]
    v_pk_mul_f32 v[54:55], v[54:55], v[110:111] op_sel:[0,1] op_sel_hi:[1,1]
    v_cvt_pk_bf16_f32 v104, v48, v52
    v_cvt_pk_bf16_f32 v105, v49, v53
    v_cvt_pk_bf16_f32 v106, v50, v54
    v_cvt_pk_bf16_f32 v107, v51, v55
    s_not_b64 exec, s[74:75]
    ds_write_b128 v123, v[104:107] offset:0
    s_mov_b64 exec, -1
    v_mov_b32 v30, 0
    v_mov_b32 v31, 0
    v_mov_b32 v64, 0
    v_mov_b32 v65, 0
    v_mov_b32 v66, 0
    v_mov_b32 v67, 0
    v_mov_b32 v68, 0
    v_mov_b32 v69, 0
    v_mov_b32 v70, 0
    v_mov_b32 v71, 0
    v_mov_b32 v56, 0
    v_mov_b32 v57, 0
    v_mov_b32 v58, 0
    v_mov_b32 v59, 0
    v_mov_b32 v60, 0
    v_mov_b32 v61, 0
    v_mov_b32 v62, 0
    v_mov_b32 v63, 0
    v_mov_b32 v48, 0
    v_mov_b32 v49, 0
    v_mov_b32 v50, 0
    v_mov_b32 v51, 0
    v_mov_b32 v52, 0
    v_mov_b32 v53, 0
    v_mov_b32 v54, 0
    v_mov_b32 v55, 0
    s_waitcnt lgkmcnt(0)
    s_barrier
    ds_read_b128 v[104:107], v114 offset:0
    ds_read_b128 v[108:111], v114 offset:1024
    s_waitcnt lgkmcnt(1)
    v_smfmac_f32_16x16x64_bf16 v[64:67], v[104:107], v[192:199], v112
    ds_read_b128 v[0:3], v113 offset:24576
    s_waitcnt lgkmcnt(1)
    v_smfmac_f32_16x16x64_bf16 v[64:67], v[108:111], v[32:39], v112
    ds_read_b128 v[4:7], v113 offset:25600
    v_smfmac_f32_16x16x64_bf16 v[68:71], v[104:107], v[200:207], v112
    ds_read_b128 v[8:11], v113 offset:26624
    v_smfmac_f32_16x16x64_bf16 v[68:71], v[108:111], v[40:47], v112
    ds_read_b128 v[12:15], v113 offset:27648
    v_smfmac_f32_16x16x64_bf16 v[24:27], v[104:107], v[208:215], v112
    ds_read_b128 v[16:19], v113 offset:28672
    s_nop 0
    v_add_f32 v64, v64, v65
    s_waitcnt lgkmcnt(3)
    v_smfmac_f32_16x16x64_bf16 v[24:27], v[108:111], v[0:7], v112
    ds_read_b128 v[20:23], v113 offset:29696
    v_add_f32 v66, v66, v67
    v_cvt_pk_bf16_f32 v40, v64, v66
    v_and_b32 v40, -2, v40
    v_smfmac_f32_16x16x64_bf16 v[28:31], v[104:107], v[216:223], v112
    ds_read_b128 v[88:91], v113 offset:30720
    v_add_f32 v68, v68, v69
    s_waitcnt lgkmcnt(3)
    v_smfmac_f32_16x16x64_bf16 v[28:31], v[108:111], v[8:15], v112
    ds_read_b128 v[92:95], v113 offset:31744
    v_add_f32 v70, v70, v71
    v_cvt_pk_bf16_f32 v41, v68, v70
    v_and_b32 v41, -2, v41
    v_smfmac_f32_16x16x64_bf16 v[56:59], v[104:107], v[224:231], v112
    ds_read_b128 v[96:99], v113 offset:32768
    v_add_f32 v24, v24, v25
    s_waitcnt lgkmcnt(3)
    v_smfmac_f32_16x16x64_bf16 v[56:59], v[108:111], v[16:23], v112
    ds_read_b128 v[100:103], v113 offset:33792
    v_add_f32 v26, v26, v27
    v_cvt_pk_bf16_f32 v42, v24, v26
    v_and_b32 v42, -2, v42
    v_smfmac_f32_16x16x64_bf16 v[60:63], v[104:107], v[232:239], v112
    ds_read_b128 v[32:35], v113 offset:34816
    v_add_f32 v28, v28, v29
    s_waitcnt lgkmcnt(3)
    v_smfmac_f32_16x16x64_bf16 v[60:63], v[108:111], v[88:95], v112
    ds_read_b128 v[36:39], v113 offset:35840
    v_add_f32 v30, v30, v31
    v_cvt_pk_bf16_f32 v43, v28, v30
    v_and_b32 v43, -2, v43
    buffer_store_dwordx4 v[40:43], v127, s[40:43], s68 offen
    v_smfmac_f32_16x16x64_bf16 v[48:51], v[104:107], v[240:247], v112
    v_add_f32 v56, v56, v57
    s_waitcnt lgkmcnt(2)
    v_smfmac_f32_16x16x64_bf16 v[48:51], v[108:111], v[96:103], v112
    v_add_f32 v58, v58, v59
    v_cvt_pk_bf16_f32 v44, v56, v58
    v_and_b32 v44, -2, v44
    v_smfmac_f32_16x16x64_bf16 v[52:55], v[104:107], v[248:255], v112
    v_add_f32 v60, v60, v61
    s_waitcnt lgkmcnt(0)
    v_smfmac_f32_16x16x64_bf16 v[52:55], v[108:111], v[32:39], v112
    v_add_f32 v62, v62, v63
    v_cvt_pk_bf16_f32 v45, v60, v62
    v_and_b32 v45, -2, v45
    v_add_f32 v48, v48, v49
    v_add_f32 v50, v50, v51
    v_cvt_pk_bf16_f32 v46, v48, v50
    v_and_b32 v46, -2, v46
    s_nop 0
    v_add_f32 v52, v52, v53
    v_add_f32 v54, v54, v55
    v_cvt_pk_bf16_f32 v47, v52, v54
    v_and_b32 v47, -2, v47
    buffer_store_dwordx4 v[44:47], v127, s[40:43], s69 offen
    v_mov_b32 v48, 0
    v_mov_b32 v49, 0
    v_mov_b32 v50, 0
    v_mov_b32 v51, 0
    ds_read_b128 v[32:35], v113 offset:0
    v_mov_b32 v52, 0
    v_mov_b32 v53, 0
    v_mov_b32 v54, 0
    v_mov_b32 v55, 0
    ds_read_b128 v[36:39], v113 offset:1024
    v_mov_b32 v56, 0
    v_mov_b32 v57, 0
    v_mov_b32 v58, 0
    v_mov_b32 v59, 0
    ds_read_b128 v[40:43], v113 offset:2048
    v_mov_b32 v60, 0
    v_mov_b32 v61, 0
    v_mov_b32 v62, 0
    v_mov_b32 v63, 0
    ds_read_b128 v[44:47], v113 offset:3072
    v_mov_b32 v64, 0
    v_mov_b32 v65, 0
    v_mov_b32 v66, 0
    v_mov_b32 v67, 0
    v_mov_b32 v68, 0
    v_mov_b32 v69, 0
    v_mov_b32 v70, 0
    v_mov_b32 v71, 0
    s_sleep 2
    buffer_load_dwordx4 v[88:91], v124, s[40:43], s67 offen sc1
    buffer_load_dwordx4 v[92:95], v124, s[40:43], s67 offen offset:1024 sc1
    s_sleep 2
    buffer_load_dwordx4 v[88:91], v124, s[40:43], s67 offen sc1
    buffer_load_dwordx4 v[92:95], v124, s[40:43], s67 offen offset:1024 sc1
    s_waitcnt vmcnt(2) lgkmcnt(0)
    s_branch L_f0_poll1c
L_f0_poll1:
    s_waitcnt vmcnt(0)
    v_or3_b32 v96, v88, v89, v90
    v_or3_b32 v97, v91, v92, v93
    v_or3_b32 v96, v96, v94, v95
    v_bitop3_b32 v96, v96, v97, 1 bitop3:0xa8
    v_cmp_ne_u32 vcc, 0, v96
    s_nop 0
    s_cbranch_vccz L_f0_poll1g
    s_add_u32 s60, s60, 1
    s_cmp_gt_u32 s60, 0x40000
    s_cbranch_scc1 L_exit
    s_mov_b64 exec, vcc
    buffer_load_dwordx4 v[88:91], v124, s[40:43], s67 offen sc1
    buffer_load_dwordx4 v[92:95], v124, s[40:43], s67 offen offset:1024 sc1
    s_mov_b64 exec, -1
    s_branch L_f0_poll1
L_f0_poll1c:
    v_or3_b32 v96, v88, v89, v90
    v_or3_b32 v97, v91, v92, v93
    v_or3_b32 v96, v96, v94, v95
    v_bitop3_b32 v96, v96, v97, 1 bitop3:0xa8
    v_cmp_ne_u32 vcc, 0, v96
    s_nop 0
    s_cbranch_vccnz L_f0_poll1
L_f0_poll1g:
    v_mfma_f32_16x16x32_bf16 v[104:107], v[136:139], v[88:91], 0
    v_mfma_f32_16x16x32_bf16 v[104:107], v[136:139], v[92:95], v[104:107]
    s_nop 7
    v_add_f32_dpp v104, v104, v104 row_ror:8 row_mask:0xf bank_mask:0xf
    v_add_f32_dpp v105, v105, v105 row_ror:8 row_mask:0xf bank_mask:0xf
    v_add_f32_dpp v106, v106, v106 row_ror:8 row_mask:0xf bank_mask:0xf
    v_add_f32_dpp v107, v107, v107 row_ror:8 row_mask:0xf bank_mask:0xf
    v_add_f32_dpp v108, v104, v104 row_ror:4 row_mask:0xf bank_mask:0x5
    v_add_f32_dpp v109, v106, v106 row_ror:4 row_mask:0xf bank_mask:0x5
    v_add_f32_dpp v108, v105, v105 row_ror:4 row_mask:0xf bank_mask:0xa
    v_add_f32_dpp v109, v107, v107 row_ror:4 row_mask:0xf bank_mask:0xa
    s_mov_b64 exec, s[72:73]
    v_cvt_pk_bf16_f32 v104, v108, v109
    v_and_b32 v104, -2, v104
    buffer_store_dword v104, v140, s[40:43], s65 offen
    s_mov_b64 exec, -1
    s_add_u32 s53, s70, 0x1000000
    s_sub_u32 s54, s70, 0x0
    buffer_load_dwordx4 v[72:75], v124, s[40:43], s54 offen
    buffer_load_dwordx4 v[76:79], v124, s[40:43], s54 offen offset:1024
    buffer_load_dwordx4 v[80:83], v124, s[40:43], s53 offen
    buffer_load_dwordx4 v[84:87], v124, s[40:43], s53 offen offset:1024
    s_add_u32 s52, s52, 1
    s_add_u32 s70, s70, 0x40000
    s_add_u32 s71, s71, 0x20000
    s_sleep 4
    buffer_load_dwordx4 v[0:3], v124, s[40:43], s64 offen sc1
    buffer_load_dwordx4 v[4:7], v124, s[40:43], s64 offen offset:1024 sc1
    s_sleep 2
    buffer_load_dwordx4 v[0:3], v124, s[40:43], s64 offen sc1
    buffer_load_dwordx4 v[4:7], v124, s[40:43], s64 offen offset:1024 sc1
    s_branch L_f1_top
L_f1_rt:
    s_waitcnt vmcnt(0)
    v_or3_b32 v104, v0, v1, v2
    v_or3_b32 v105, v3, v4, v5
    v_or3_b32 v104, v104, v6, v7
    v_bitop3_b32 v104, v104, v105, 1 bitop3:0xa8
    v_cmp_ne_u32 vcc, 0, v104
    s_nop 0
    s_cbranch_vccz L_f1_go
    s_add_u32 s60, s60, 1
    s_cmp_gt_u32 s60, 0x40000
    s_cbranch_scc1 L_exit
    s_mov_b64 exec, vcc
    buffer_load_dwordx4 v[0:3], v124, s[40:43], s64 offen sc1
    buffer_load_dwordx4 v[4:7], v124, s[40:43], s64 offen offset:1024 sc1
    s_mov_b64 exec, -1
    s_branch L_f1_rt
L_f1_top:
    s_waitcnt vmcnt(2)
    v_or3_b32 v104, v0, v1, v2
    v_or3_b32 v105, v3, v4, v5
    v_or3_b32 v104, v104, v6, v7
    v_bitop3_b32 v104, v104, v105, 1 bitop3:0xa8
    v_cmp_ne_u32 vcc, 0, v104
    s_nop 0
    s_cbranch_vccnz L_f1_rt
L_f1_go:
    v_smfmac_f32_16x16x64_bf16 v[48:51], v[0:3], a[0:7], v112
    ds_write_b128 v115, v[0:3] offset:0
    v_smfmac_f32_16x16x64_bf16 v[52:55], v[0:3], v[32:39], v112
    ds_write_b128 v115, v[4:7] offset:1024
    v_smfmac_f32_16x16x64_bf16 v[48:51], v[4:7], a[8:15], v112
    ds_read_b128 v[32:35], v113 offset:4096
    v_smfmac_f32_16x16x64_bf16 v[52:55], v[4:7], v[40:47], v112
    ds_read_b128 v[36:39], v113 offset:5120
    v_smfmac_f32_16x16x64_bf16 v[56:59], v[0:3], a[80:87], v112
    ds_read_b128 v[40:43], v113 offset:6144
    v_smfmac_f32_16x16x64_bf16 v[60:63], v[0:3], a[88:95], v112
    ds_read_b128 v[44:47], v113 offset:7168
    v_smfmac_f32_16x16x64_bf16 v[56:59], v[4:7], a[96:103], v112
    s_waitcnt lgkmcnt(4)
    s_barrier
    ds_read_b128 v[8:11], v116 offset:0
    v_smfmac_f32_16x16x64_bf16 v[60:63], v[4:7], a[104:111], v112
    ds_read_b128 v[12:15], v116 offset:1024
    s_sub_u32 s53, s52, 1
    v_mov_b32 v111, s53
    s_mov_b64 exec, 1
    buffer_store_dword v111, v143, s[40:43], s66 offen sc1
    s_mov_b64 exec, -1
    v_smfmac_f32_16x16x64_bf16 v[64:67], v[0:3], a[176:183], v112
    ds_read_b128 v[16:19], v117 offset:0
    v_mbcnt_lo_u32_b32 v110, -1, 0
    v_smfmac_f32_16x16x64_bf16 v[68:71], v[0:3], a[184:191], v112
    ds_read_b128 v[20:23], v117 offset:1024
    v_min_u32 v110, 6, v110
    buffer_store_dwordx4 v[128:131], v125, s[40:43], s71 offen sc1
    v_smfmac_f32_16x16x64_bf16 v[64:67], v[4:7], a[192:199], v112
    ds_read_b128 v[24:27], v118 offset:0
    v_lshlrev_b32 v110, 6, v110
    v_smfmac_f32_16x16x64_bf16 v[68:71], v[4:7], a[200:207], v112
    ds_read_b128 v[28:31], v118 offset:1024
    s_waitcnt lgkmcnt(5)
    v_smfmac_f32_16x16x64_bf16 v[48:51], v[8:11], v[32:39], v112
    v_smfmac_f32_16x16x64_bf16 v[52:55], v[8:11], a[16:23], v112
    ds_read_b128 v[32:35], v113 offset:8192
    buffer_load_dword v126, v110, s[40:43], s81 offen sc1
    s_waitcnt lgkmcnt(5)
    v_smfmac_f32_16x16x64_bf16 v[48:51], v[12:15], v[40:47], v112
    ds_read_b128 v[36:39], v113 offset:9216
    v_smfmac_f32_16x16x64_bf16 v[52:55], v[12:15], a[24:31], v112
    ds_read_b128 v[40:43], v113 offset:10240
    s_waitcnt lgkmcnt(6)
    v_smfmac_f32_16x16x64_bf16 v[48:51], v[16:19], a[32:39], v112
    ds_read_b128 v[44:47], v113 offset:11264
    v_smfmac_f32_16x16x64_bf16 v[52:55], v[16:19], a[40:47], v112
    s_waitcnt lgkmcnt(6)
    v_smfmac_f32_16x16x64_bf16 v[48:51], v[20:23], a[48:55], v112
    s_waitcnt lgkmcnt(2)
    v_smfmac_f32_16x16x64_bf16 v[52:55], v[20:23], v[32:39], v112
    v_smfmac_f32_16x16x64_bf16 v[48:51], v[24:27], a[56:63], v112
    ds_read_b128 v[32:35], v113 offset:12288
    s_waitcnt lgkmcnt(1)
    v_smfmac_f32_16x16x64_bf16 v[52:55], v[24:27], v[40:47], v112
    ds_read_b128 v[36:39], v113 offset:13312
    v_smfmac_f32_16x16x64_bf16 v[48:51], v[28:31], a[64:71], v112
    ds_read_b128 v[40:43], v113 offset:14336
    v_smfmac_f32_16x16x64_bf16 v[52:55], v[28:31], a[72:79], v112
    ds_read_b128 v[44:47], v113 offset:15360
    v_smfmac_f32_16x16x64_bf16 v[56:59], v[8:11], a[112:119], v112
    v_smfmac_f32_16x16x64_bf16 v[60:63], v[8:11], a[120:127], v112
    s_nop 2
    v_add_f32 v48, v48, v49
    s_nop 0
    v_add_f32 v52, v52, v53
    v_add_f32 v50, v50, v51
    v_add_f32 v54, v54, v55
    v_cvt_pk_bf16_f32 v104, v48, v52
    v_cvt_pk_bf16_f32 v105, v50, v54
    ds_write_b32 v119, v104 offset:8192
    ds_write_b32 v119, v105 offset:8208
    ds_read_b128 v[108:111], v121 offset:8192
    s_waitcnt lgkmcnt(5)
    v_smfmac_f32_16x16x64_bf16 v[56:59], v[12:15], v[32:39], v112
    v_smfmac_f32_16x16x64_bf16 v[60:63], v[12:15], a[128:135], v112
    ds_read_b128 v[32:35], v113 offset:16384
    s_waitcnt lgkmcnt(4)
    v_smfmac_f32_16x16x64_bf16 v[56:59], v[16:19], v[40:47], v112
    ds_read_b128 v[36:39], v113 offset:17408
    v_smfmac_f32_16x16x64_bf16 v[60:63], v[16:19], a[136:143], v112
    ds_read_b128 v[40:43], v113 offset:18432
    s_waitcnt lgkmcnt(3)
    v_mfma_f32_16x16x32_bf16 v[48:51], v[72:75], v[108:111], 0
    ds_read_b128 v[44:47], v113 offset:19456
    v_mfma_f32_16x16x32_bf16 v[52:55], v[76:79], v[108:111], 0
    v_smfmac_f32_16x16x64_bf16 v[56:59], v[20:23], a[144:151], v112
    v_smfmac_f32_16x16x64_bf16 v[60:63], v[20:23], a[152:159], v112
    v_smfmac_f32_16x16x64_bf16 v[56:59], v[24:27], a[160:167], v112
    s_not_b64 exec, s[74:75]
    s_nop 1
    ds_write_b128 v125, v[48:51] offset:12288
    s_mov_b64 exec, s[74:75]
    ds_write_b128 v125, v[52:55] offset:12288
    s_mov_b64 exec, -1
    s_waitcnt lgkmcnt(4)
    v_smfmac_f32_16x16x64_bf16 v[60:63], v[24:27], v[32:39], v112
    v_smfmac_f32_16x16x64_bf16 v[56:59], v[28:31], a[168:175], v112
    s_waitcnt lgkmcnt(2)
    v_smfmac_f32_16x16x64_bf16 v[60:63], v[28:31], v[40:47], v112
    s_waitcnt lgkmcnt(0)
    s_barrier
    v_smfmac_f32_16x16x64_bf16 v[64:67], v[8:11], a[208:215], v112
    ds_read_b128 v[48:51], v114 offset:12288
    v_smfmac_f32_16x16x64_bf16 v[68:71], v[8:11], a[216:223], v112
    ds_read_b128 v[52:55], v114 offset:13312
    v_smfmac_f32_16x16x64_bf16 v[64:67], v[12:15], a[224:231], v112
    ds_read_b128 v[108:111], v114 offset:14336
    v_add_f32 v56, v56, v57
    v_add_f32 v60, v60, v61
    v_add_f32 v58, v58, v59
    v_add_f32 v62, v62, v63
    v_cvt_pk_bf16_f32 v128, v56, v60
    v_cvt_pk_bf16_f32 v129, v58, v62
    ds_write_b32 v119, v128 offset:10240
    ds_write_b32 v119, v129 offset:10256
    v_smfmac_f32_16x16x64_bf16 v[68:71], v[12:15], a[232:239], v112
    ds_read_b128 v[60:63], v114 offset:15360
    v_smfmac_f32_16x16x64_bf16 v[64:67], v[16:19], a[240:247], v112
    ds_read_b128 v[96:99], v120 offset:8192
    v_smfmac_f32_16x16x64_bf16 v[68:71], v[16:19], a[248:255], v112
    ds_read_b128 v[100:103], v120 offset:8704
    v_smfmac_f32_16x16x64_bf16 v[64:67], v[20:23], v[144:151], v112
    s_waitcnt lgkmcnt(6)
    v_add_f32 v48, v48, v52
    s_waitcnt lgkmcnt(3)
    s_barrier
    ds_read_b128 v[88:91], v122 offset:10240
    v_smfmac_f32_16x16x64_bf16 v[68:71], v[20:23], v[152:159], v112
    ds_read_b128 v[92:95], v122 offset:10752
    v_add_f32 v49, v49, v53
    v_smfmac_f32_16x16x64_bf16 v[64:67], v[24:27], v[160:167], v112
    v_add_f32 v50, v50, v54
    v_smfmac_f32_16x16x64_bf16 v[68:71], v[24:27], v[168:175], v112
    v_add_f32 v51, v51, v55
    v_smfmac_f32_16x16x64_bf16 v[64:67], v[28:31], v[176:183], v112
    s_waitcnt lgkmcnt(4)
    v_add_f32 v108, v108, v60
    v_smfmac_f32_16x16x64_bf16 v[68:71], v[28:31], v[184:191], v112
    v_add_f32 v109, v109, v61
    s_waitcnt lgkmcnt(1)
    v_mfma_f32_16x16x32_bf16 v[56:59], v[88:91], v[96:99], 0
    v_add_f32 v110, v110, v62
    s_waitcnt lgkmcnt(0)
    v_mfma_f32_16x16x32_bf16 v[56:59], v[92:95], v[100:103], v[56:59]
    v_add_f32 v111, v111, v63
    s_cmp_eq_u32 s52, 63
    s_cbranch_scc1 L_f_last
    v_add_f32 v104, v48, v108
    ds_read_b128 v[32:35], v113 offset:20480
    v_add_f32 v105, v49, v109
    v_add_f32 v106, v50, v110
    v_add_f32 v107, v51, v111
    v_max3_f32 v108, v104, v105, v106
    ds_read_b128 v[36:39], v113 offset:21504
    v_add_f32_dpp v109, v58, v56 row_ror:8 row_mask:0xf bank_mask:0x3
    v_add_f32_dpp v109, v57, v59 row_ror:8 row_mask:0xf bank_mask:0xc
    v_max3_f32 v108, v108, v107, v109
    v_add_f32 v64, v64, v65
    ds_read_b128 v[40:43], v113 offset:22528
    v_add_f32 v66, v66, v67
    v_max_f32_dpp v108, v108, v108 row_ror:8 row_mask:0xf bank_mask:0xf
    v_mov_b32 v110, v108
    v_cvt_pk_bf16_f32 v130, v64, v66
    ds_read_b128 v[44:47], v113 offset:23552
    v_add_f32 v68, v68, v69
    v_permlane16_swap_b32 v108, v110
    v_max_f32 v108, v108, v110
    v_mov_b32 v110, v108
    v_add_f32 v70, v70, v71
    v_cvt_pk_bf16_f32 v131, v68, v70
    v_permlane32_swap_b32 v108, v110
    v_max_f32 v108, v108, v110
    v_mul_f32 v108, s76, v108
    v_fma_f32 v109, v109, s76, -v108
    v_fma_f32 v104, v104, s76, -v108
    v_fma_f32 v105, v105, s76, -v108
    v_fma_f32 v106, v106, s76, -v108
    v_fma_f32 v107, v107, s76, -v108
    v_exp_f32 v109, v109
    v_exp_f32 v104, v104
    v_exp_f32 v105, v105
    v_exp_f32 v106, v106
    v_exp_f32 v107, v107
    v_cvt_pk_bf16_f32 v60, v104, v105
    v_mov_b32_dpp v110, v109 row_ror:8 row_mask:0xf bank_mask:0xf
    v_cvt_pk_bf16_f32 v61, v106, v107
    v_mov_b32_dpp v62, v60 row_ror:8 row_mask:0xf bank_mask:0xf
    v_cvt_pk_bf16_f32 v132, v109, v110
    v_mov_b32_dpp v63, v61 row_ror:8 row_mask:0xf bank_mask:0xf
    v_cvt_pk_bf16_f32 v135, v109, v110
    s_nop 0
    v_mfma_f32_16x16x32_bf16 v[48:51], v[80:83], v[60:63], 0
    v_mfma_f32_16x16x32_bf16 v[52:55], v[84:87], v[60:63], 0
    v_add_f32 v111, v104, v105
    v_add_f32 v110, v106, v107
    v_add_f32 v111, v111, v109
    s_nop 1
    v_mfma_f32_16x16x16_bf16 v[48:51], v[130:131], v[132:133], v[48:51]
    v_add_f32 v111, v111, v110
    v_mfma_f32_16x16x16_bf16 v[52:55], v[130:131], v[134:135], v[52:55]
    v_mov_b32 v24, 0
    v_mov_b32 v25, 0
    v_add_f32_dpp v111, v111, v111 row_ror:8 row_mask:0xf bank_mask:0xf
    v_mov_b32 v110, v111
    v_mov_b32 v26, 0
    v_mov_b32 v27, 0
    v_permlane16_swap_b32 v111, v110
    v_add_f32 v111, v111, v110
    v_mov_b32 v110, v111
    v_mov_b32 v28, 0
    v_mov_b32 v29, 0
    v_permlane32_swap_b32 v111, v110
    v_add_f32 v111, v111, v110
    v_rcp_f32 v111, v111
    s_nop 0
    v_pk_mul_f32 v[48:49], v[48:49], v[110:111] op_sel:[0,1] op_sel_hi:[1,1]
    v_pk_mul_f32 v[52:53], v[52:53], v[110:111] op_sel:[0,1] op_sel_hi:[1,1]
    v_pk_mul_f32 v[50:51], v[50:51], v[110:111] op_sel:[0,1] op_sel_hi:[1,1]
    v_pk_mul_f32 v[54:55], v[54:55], v[110:111] op_sel:[0,1] op_sel_hi:[1,1]
    v_cvt_pk_bf16_f32 v104, v48, v52
    v_cvt_pk_bf16_f32 v105, v49, v53
    v_cvt_pk_bf16_f32 v106, v50, v54
    v_cvt_pk_bf16_f32 v107, v51, v55
    s_not_b64 exec, s[74:75]
    ds_write_b128 v123, v[104:107] offset:0
    s_mov_b64 exec, -1
    v_mov_b32 v30, 0
    v_mov_b32 v31, 0
    v_mov_b32 v64, 0
    v_mov_b32 v65, 0
    v_mov_b32 v66, 0
    v_mov_b32 v67, 0
    v_mov_b32 v68, 0
    v_mov_b32 v69, 0
    v_mov_b32 v70, 0
    v_mov_b32 v71, 0
    v_mov_b32 v56, 0
    v_mov_b32 v57, 0
    v_mov_b32 v58, 0
    v_mov_b32 v59, 0
    v_mov_b32 v60, 0
    v_mov_b32 v61, 0
    v_mov_b32 v62, 0
    v_mov_b32 v63, 0
    v_mov_b32 v48, 0
    v_mov_b32 v49, 0
    v_mov_b32 v50, 0
    v_mov_b32 v51, 0
    v_mov_b32 v52, 0
    v_mov_b32 v53, 0
    v_mov_b32 v54, 0
    v_mov_b32 v55, 0
    s_waitcnt lgkmcnt(0)
    s_barrier
    ds_read_b128 v[104:107], v114 offset:0
    ds_read_b128 v[108:111], v114 offset:1024
    s_waitcnt lgkmcnt(1)
    v_smfmac_f32_16x16x64_bf16 v[64:67], v[104:107], v[192:199], v112
    ds_read_b128 v[0:3], v113 offset:24576
    s_waitcnt lgkmcnt(1)
    v_smfmac_f32_16x16x64_bf16 v[64:67], v[108:111], v[32:39], v112
    ds_read_b128 v[4:7], v113 offset:25600
    v_smfmac_f32_16x16x64_bf16 v[68:71], v[104:107], v[200:207], v112
    ds_read_b128 v[8:11], v113 offset:26624
    v_smfmac_f32_16x16x64_bf16 v[68:71], v[108:111], v[40:47], v112
    ds_read_b128 v[12:15], v113 offset:27648
    v_smfmac_f32_16x16x64_bf16 v[24:27], v[104:107], v[208:215], v112
    ds_read_b128 v[16:19], v113 offset:28672
    s_nop 0
    v_add_f32 v64, v64, v65
    s_waitcnt lgkmcnt(3)
    v_smfmac_f32_16x16x64_bf16 v[24:27], v[108:111], v[0:7], v112
    ds_read_b128 v[20:23], v113 offset:29696
    v_add_f32 v66, v66, v67
    v_cvt_pk_bf16_f32 v40, v64, v66
    v_or_b32 v40, 1, v40
    v_smfmac_f32_16x16x64_bf16 v[28:31], v[104:107], v[216:223], v112
    ds_read_b128 v[88:91], v113 offset:30720
    v_add_f32 v68, v68, v69
    s_waitcnt lgkmcnt(3)
    v_smfmac_f32_16x16x64_bf16 v[28:31], v[108:111], v[8:15], v112
    ds_read_b128 v[92:95], v113 offset:31744
    v_add_f32 v70, v70, v71
    v_cvt_pk_bf16_f32 v41, v68, v70
    v_or_b32 v41, 1, v41
    v_smfmac_f32_16x16x64_bf16 v[56:59], v[104:107], v[224:231], v112
    ds_read_b128 v[96:99], v113 offset:32768
    v_add_f32 v24, v24, v25
    s_waitcnt lgkmcnt(3)
    v_smfmac_f32_16x16x64_bf16 v[56:59], v[108:111], v[16:23], v112
    ds_read_b128 v[100:103], v113 offset:33792
    v_add_f32 v26, v26, v27
    v_cvt_pk_bf16_f32 v42, v24, v26
    v_or_b32 v42, 1, v42
    v_smfmac_f32_16x16x64_bf16 v[60:63], v[104:107], v[232:239], v112
    ds_read_b128 v[32:35], v113 offset:34816
    v_add_f32 v28, v28, v29
    s_waitcnt lgkmcnt(3)
    v_smfmac_f32_16x16x64_bf16 v[60:63], v[108:111], v[88:95], v112
    ds_read_b128 v[36:39], v113 offset:35840
    v_add_f32 v30, v30, v31
    v_cvt_pk_bf16_f32 v43, v28, v30
    v_or_b32 v43, 1, v43
    buffer_store_dwordx4 v[40:43], v127, s[40:43], s68 offen
    v_smfmac_f32_16x16x64_bf16 v[48:51], v[104:107], v[240:247], v112
    v_add_f32 v56, v56, v57
    s_waitcnt lgkmcnt(2)
    v_smfmac_f32_16x16x64_bf16 v[48:51], v[108:111], v[96:103], v112
    v_add_f32 v58, v58, v59
    v_cvt_pk_bf16_f32 v44, v56, v58
    v_or_b32 v44, 1, v44
    v_smfmac_f32_16x16x64_bf16 v[52:55], v[104:107], v[248:255], v112
    v_add_f32 v60, v60, v61
    s_waitcnt lgkmcnt(0)
    v_smfmac_f32_16x16x64_bf16 v[52:55], v[108:111], v[32:39], v112
    v_add_f32 v62, v62, v63
    v_cvt_pk_bf16_f32 v45, v60, v62
    v_or_b32 v45, 1, v45
    v_add_f32 v48, v48, v49
    v_add_f32 v50, v50, v51
    v_cvt_pk_bf16_f32 v46, v48, v50
    v_or_b32 v46, 1, v46
    s_nop 0
    v_add_f32 v52, v52, v53
    v_add_f32 v54, v54, v55
    v_cvt_pk_bf16_f32 v47, v52, v54
    v_or_b32 v47, 1, v47
    buffer_store_dwordx4 v[44:47], v127, s[40:43], s69 offen
    v_mov_b32 v48, 0
    v_mov_b32 v49, 0
    v_mov_b32 v50, 0
    v_mov_b32 v51, 0
    ds_read_b128 v[32:35], v113 offset:0
    v_mov_b32 v52, 0
    v_mov_b32 v53, 0
    v_mov_b32 v54, 0
    v_mov_b32 v55, 0
    ds_read_b128 v[36:39], v113 offset:1024
    v_mov_b32 v56, 0
    v_mov_b32 v57, 0
    v_mov_b32 v58, 0
    v_mov_b32 v59, 0
    ds_read_b128 v[40:43], v113 offset:2048
    v_mov_b32 v60, 0
    v_mov_b32 v61, 0
    v_mov_b32 v62, 0
    v_mov_b32 v63, 0
    ds_read_b128 v[44:47], v113 offset:3072
    v_mov_b32 v64, 0
    v_mov_b32 v65, 0
    v_mov_b32 v66, 0
    v_mov_b32 v67, 0
    v_mov_b32 v68, 0
    v_mov_b32 v69, 0
    v_mov_b32 v70, 0
    v_mov_b32 v71, 0
    s_sleep 2
    buffer_load_dwordx4 v[88:91], v124, s[40:43], s67 offen sc1
    buffer_load_dwordx4 v[92:95], v124, s[40:43], s67 offen offset:1024 sc1
    s_sleep 2
    buffer_load_dwordx4 v[88:91], v124, s[40:43], s67 offen sc1
    buffer_load_dwordx4 v[92:95], v124, s[40:43], s67 offen offset:1024 sc1
    s_waitcnt vmcnt(2) lgkmcnt(0)
    s_branch L_f1_poll1c
L_f1_poll1:
    s_waitcnt vmcnt(0)
    v_bitop3_b32 v96, v88, v89, v90 bitop3:0x80
    v_bitop3_b32 v97, v91, v92, v93 bitop3:0x80
    v_bitop3_b32 v96, v96, v94, v95 bitop3:0x80
    v_bitop3_b32 v96, v96, v97, 1 bitop3:0x80
    v_cmp_eq_u32 vcc, 0, v96
    s_nop 0
    s_cbranch_vccz L_f1_poll1g
    s_add_u32 s60, s60, 1
    s_cmp_gt_u32 s60, 0x40000
    s_cbranch_scc1 L_exit
    s_mov_b64 exec, vcc
    buffer_load_dwordx4 v[88:91], v124, s[40:43], s67 offen sc1
    buffer_load_dwordx4 v[92:95], v124, s[40:43], s67 offen offset:1024 sc1
    s_mov_b64 exec, -1
    s_branch L_f1_poll1
L_f1_poll1c:
    v_bitop3_b32 v96, v88, v89, v90 bitop3:0x80
    v_bitop3_b32 v97, v91, v92, v93 bitop3:0x80
    v_bitop3_b32 v96, v96, v94, v95 bitop3:0x80
    v_bitop3_b32 v96, v96, v97, 1 bitop3:0x80
    v_cmp_eq_u32 vcc, 0, v96
    s_nop 0
    s_cbranch_vccnz L_f1_poll1
L_f1_poll1g:
    v_mfma_f32_16x16x32_bf16 v[104:107], v[136:139], v[88:91], 0
    v_mfma_f32_16x16x32_bf16 v[104:107], v[136:139], v[92:95], v[104:107]
    s_nop 7
    v_add_f32_dpp v104, v104, v104 row_ror:8 row_mask:0xf bank_mask:0xf
    v_add_f32_dpp v105, v105, v105 row_ror:8 row_mask:0xf bank_mask:0xf
    v_add_f32_dpp v106, v106, v106 row_ror:8 row_mask:0xf bank_mask:0xf
    v_add_f32_dpp v107, v107, v107 row_ror:8 row_mask:0xf bank_mask:0xf
    v_add_f32_dpp v108, v104, v104 row_ror:4 row_mask:0xf bank_mask:0x5
    v_add_f32_dpp v109, v106, v106 row_ror:4 row_mask:0xf bank_mask:0x5
    v_add_f32_dpp v108, v105, v105 row_ror:4 row_mask:0xf bank_mask:0xa
    v_add_f32_dpp v109, v107, v107 row_ror:4 row_mask:0xf bank_mask:0xa
    s_mov_b64 exec, s[72:73]
    v_cvt_pk_bf16_f32 v104, v108, v109
    v_or_b32 v104, 1, v104
    buffer_store_dword v104, v140, s[40:43], s65 offen
    s_mov_b64 exec, -1
    s_add_u32 s53, s70, 0x1000000
    s_sub_u32 s54, s70, 0x0
    buffer_load_dwordx4 v[72:75], v124, s[40:43], s54 offen
    buffer_load_dwordx4 v[76:79], v124, s[40:43], s54 offen offset:1024
    buffer_load_dwordx4 v[80:83], v124, s[40:43], s53 offen
    buffer_load_dwordx4 v[84:87], v124, s[40:43], s53 offen offset:1024
    s_add_u32 s52, s52, 1
    s_add_u32 s70, s70, 0x40000
    s_add_u32 s71, s71, 0x20000
    s_cmp_ge_u32 s80, 64
    s_cbranch_scc1 L_f1_hz
    v_readlane_b32 s80, v126, 0
    s_mul_i32 s80, s80, 7
    v_readlane_b32 s54, v126, 1
    s_mul_i32 s54, s54, 7
    s_add_u32 s54, s54, 1
    s_min_u32 s80, s80, s54
    v_readlane_b32 s54, v126, 2
    s_mul_i32 s54, s54, 7
    s_add_u32 s54, s54, 2
    s_min_u32 s80, s80, s54
    v_readlane_b32 s54, v126, 3
    s_mul_i32 s54, s54, 7
    s_add_u32 s54, s54, 3
    s_min_u32 s80, s80, s54
    v_readlane_b32 s54, v126, 4
    s_mul_i32 s54, s54, 7
    s_add_u32 s54, s54, 4
    s_min_u32 s80, s80, s54
    v_readlane_b32 s54, v126, 5
    s_mul_i32 s54, s54, 7
    s_add_u32 s54, s54, 5
    s_min_u32 s80, s80, s54
    v_readlane_b32 s54, v126, 6
    s_mul_i32 s54, s54, 7
    s_add_u32 s54, s54, 6
    s_min_u32 s80, s80, s54
    s_cmp_ge_u32 s80, 64
    s_cselect_b32 s80, 0x100, s80
    s_add_u32 s53, s52, 3
    s_cmp_lt_u32 s53, s80
    s_cbranch_scc1 L_f1_hz
    v_mbcnt_lo_u32_b32 v96, -1, 0
    v_mbcnt_hi_u32_b32 v96, -1, v96
    v_min_u32 v96, 6, v96
    v_lshlrev_b32 v97, 6, v96
    s_nop 1
L_f1_hzl:
    buffer_load_dword v98, v97, s[40:43], s81 offen sc1
    s_waitcnt vmcnt(0)
    v_mul_u32_u24 v98, 7, v98
    v_add_u32 v98, v98, v96
    s_nop 0
    v_readlane_b32 s80, v98, 0
    v_readlane_b32 s54, v98, 1
    s_min_u32 s80, s80, s54
    v_readlane_b32 s54, v98, 2
    s_min_u32 s80, s80, s54
    v_readlane_b32 s54, v98, 3
    s_min_u32 s80, s80, s54
    v_readlane_b32 s54, v98, 4
    s_min_u32 s80, s80, s54
    v_readlane_b32 s54, v98, 5
    s_min_u32 s80, s80, s54
    v_readlane_b32 s54, v98, 6
    s_min_u32 s80, s80, s54
    s_cmp_ge_u32 s80, 64
    s_cselect_b32 s80, 0x100, s80
    s_add_u32 s53, s52, 3
    s_cmp_lt_u32 s53, s80
    s_cbranch_scc1 L_f1_hzd
    s_add_u32 s60, s60, 1
    s_cmp_gt_u32 s60, 0x40000
    s_cbranch_scc1 L_exit
    s_sleep 4
    s_branch L_f1_hzl
L_f1_hzd:
L_f1_hz:
    s_sleep 4
    buffer_load_dwordx4 v[0:3], v124, s[40:43], s64 offen sc1
    buffer_load_dwordx4 v[4:7], v124, s[40:43], s64 offen offset:1024 sc1
    s_sleep 2
    buffer_load_dwordx4 v[0:3], v124, s[40:43], s64 offen sc1
    buffer_load_dwordx4 v[4:7], v124, s[40:43], s64 offen offset:1024 sc1
    s_branch L_f0_top
L_f_last:
    s_nop 7
    v_add_f32 v64, v64, v65
    v_add_f32 v66, v66, v67
    v_cvt_pk_bf16_f32 v130, v64, v66
    v_add_f32 v68, v68, v69
    v_add_f32 v70, v70, v71
    v_cvt_pk_bf16_f32 v131, v68, v70
    s_waitcnt lgkmcnt(0)
    s_add_u32 s71, s71, 0x20000
    buffer_store_dwordx4 v[128:131], v125, s[40:43], s71 offen sc1
    s_waitcnt vmcnt(0) lgkmcnt(0)
    s_barrier
    v_mov_b32 v110, 64
    v_mov_b32 v111, 0
    s_mov_b64 exec, 1
    buffer_store_dword v110, v111, s[40:43], s66 offen sc1
    s_mov_b64 exec, -1
    s_waitcnt vmcnt(0)
    s_branch L_chain_done
L_fast_end:
L_s0_rt:
    s_waitcnt vmcnt(0)
    v_bitop3_b32 v104, v0, v1, v2 bitop3:0x80
    v_bitop3_b32 v105, v3, v4, v5 bitop3:0x80
    v_bitop3_b32 v104, v104, v6, v7 bitop3:0x80
    v_bitop3_b32 v104, v104, v105, 1 bitop3:0x80
    v_cmp_eq_u32 vcc, 0, v104
    s_nop 0
    s_cbranch_vccz L_s0_go
    s_add_u32 s60, s60, 1
    s_cmp_gt_u32 s60, 0x40000
    s_cbranch_scc1 L_exit
    s_mov_b64 exec, vcc
    buffer_load_dwordx4 v[0:3], v124, s[40:43], s64 offen sc1
    buffer_load_dwordx4 v[4:7], v124, s[40:43], s64 offen offset:1024 sc1
    s_mov_b64 exec, -1
    s_branch L_s0_rt
L_s0_top:
    s_waitcnt vmcnt(2)
    v_bitop3_b32 v104, v0, v1, v2 bitop3:0x80
    v_bitop3_b32 v105, v3, v4, v5 bitop3:0x80
    v_bitop3_b32 v104, v104, v6, v7 bitop3:0x80
    v_bitop3_b32 v104, v104, v105, 1 bitop3:0x80
    v_cmp_eq_u32 vcc, 0, v104
    s_nop 0
    s_cbranch_vccnz L_s0_rt
L_s0_go:
    v_smfmac_f32_16x16x64_bf16 v[48:51], v[0:3], a[0:7], v112
    ds_write_b128 v115, v[0:3] offset:0
    v_smfmac_f32_16x16x64_bf16 v[52:55], v[0:3], v[32:39], v112
    ds_write_b128 v115, v[4:7] offset:1024
    v_smfmac_f32_16x16x64_bf16 v[48:51], v[4:7], a[8:15], v112
    ds_read_b128 v[32:35], v113 offset:4096
    v_smfmac_f32_16x16x64_bf16 v[52:55], v[4:7], v[40:47], v112
    ds_read_b128 v[36:39], v113 offset:5120
    v_smfmac_f32_16x16x64_bf16 v[56:59], v[0:3], a[80:87], v112
    ds_read_b128 v[40:43], v113 offset:6144
    v_smfmac_f32_16x16x64_bf16 v[60:63], v[0:3], a[88:95], v112
    ds_read_b128 v[44:47], v113 offset:7168
    v_smfmac_f32_16x16x64_bf16 v[56:59], v[4:7], a[96:103], v112
    s_waitcnt lgkmcnt(4)
    s_barrier
    ds_read_b128 v[8:11], v116 offset:0
    v_smfmac_f32_16x16x64_bf16 v[60:63], v[4:7], a[104:111], v112
    ds_read_b128 v[12:15], v116 offset:1024
    v_smfmac_f32_16x16x64_bf16 v[64:67], v[0:3], a[176:183], v112
    ds_read_b128 v[16:19], v117 offset:0
    buffer_store_dwordx4 v[128:131], v125, s[40:43], s71 offen sc1
    v_smfmac_f32_16x16x64_bf16 v[68:71], v[0:3], a[184:191], v112
    ds_read_b128 v[20:23], v117 offset:1024
    v_smfmac_f32_16x16x64_bf16 v[64:67], v[4:7], a[192:199], v112
    ds_read_b128 v[24:27], v118 offset:0
    buffer_load_dword v126, v141, s[40:43], s70 offen
    v_smfmac_f32_16x16x64_bf16 v[68:71], v[4:7], a[200:207], v112
    ds_read_b128 v[28:31], v118 offset:1024
    s_waitcnt lgkmcnt(5)
    v_smfmac_f32_16x16x64_bf16 v[48:51], v[8:11], v[32:39], v112
    v_smfmac_f32_16x16x64_bf16 v[52:55], v[8:11], a[16:23], v112
    ds_read_b128 v[32:35], v113 offset:8192
    s_waitcnt lgkmcnt(5)
    v_smfmac_f32_16x16x64_bf16 v[48:51], v[12:15], v[40:47], v112
    ds_read_b128 v[36:39], v113 offset:9216
    v_smfmac_f32_16x16x64_bf16 v[52:55], v[12:15], a[24:31], v112
    ds_read_b128 v[40:43], v113 offset:10240
    s_waitcnt lgkmcnt(6)
    v_smfmac_f32_16x16x64_bf16 v[48:51], v[16:19], a[32:39], v112
    ds_read_b128 v[44:47], v113 offset:11264
    v_smfmac_f32_16x16x64_bf16 v[52:55], v[16:19], a[40:47], v112
    s_waitcnt lgkmcnt(6)
    v_smfmac_f32_16x16x64_bf16 v[48:51], v[20:23], a[48:55], v112
    s_waitcnt lgkmcnt(2)
    v_smfmac_f32_16x16x64_bf16 v[52:55], v[20:23], v[32:39], v112
    v_smfmac_f32_16x16x64_bf16 v[48:51], v[24:27], a[56:63], v112
    ds_read_b128 v[32:35], v113 offset:12288
    s_waitcnt lgkmcnt(1)
    v_smfmac_f32_16x16x64_bf16 v[52:55], v[24:27], v[40:47], v112
    ds_read_b128 v[36:39], v113 offset:13312
    v_smfmac_f32_16x16x64_bf16 v[48:51], v[28:31], a[64:71], v112
    ds_read_b128 v[40:43], v113 offset:14336
    v_smfmac_f32_16x16x64_bf16 v[52:55], v[28:31], a[72:79], v112
    ds_read_b128 v[44:47], v113 offset:15360
    v_smfmac_f32_16x16x64_bf16 v[56:59], v[8:11], a[112:119], v112
    v_smfmac_f32_16x16x64_bf16 v[60:63], v[8:11], a[120:127], v112
    s_nop 2
    v_add_f32 v48, v48, v49
    s_nop 0
    v_add_f32 v52, v52, v53
    v_add_f32 v50, v50, v51
    v_add_f32 v54, v54, v55
    v_cvt_pk_bf16_f32 v104, v48, v52
    v_cvt_pk_bf16_f32 v105, v50, v54
    ds_write_b32 v119, v104 offset:8192
    ds_write_b32 v119, v105 offset:8208
    ds_read_b128 v[108:111], v121 offset:8192
    s_waitcnt lgkmcnt(5)
    v_smfmac_f32_16x16x64_bf16 v[56:59], v[12:15], v[32:39], v112
    v_smfmac_f32_16x16x64_bf16 v[60:63], v[12:15], a[128:135], v112
    ds_read_b128 v[32:35], v113 offset:16384
    s_waitcnt lgkmcnt(4)
    v_smfmac_f32_16x16x64_bf16 v[56:59], v[16:19], v[40:47], v112
    ds_read_b128 v[36:39], v113 offset:17408
    v_smfmac_f32_16x16x64_bf16 v[60:63], v[16:19], a[136:143], v112
    ds_read_b128 v[40:43], v113 offset:18432
    s_waitcnt lgkmcnt(3)
    v_mfma_f32_16x16x32_bf16 v[48:51], v[72:75], v[108:111], 0
    ds_read_b128 v[44:47], v113 offset:19456
    v_mfma_f32_16x16x32_bf16 v[52:55], v[76:79], v[108:111], 0
    v_smfmac_f32_16x16x64_bf16 v[56:59], v[20:23], a[144:151], v112
    v_smfmac_f32_16x16x64_bf16 v[60:63], v[20:23], a[152:159], v112
    v_smfmac_f32_16x16x64_bf16 v[56:59], v[24:27], a[160:167], v112
    s_not_b64 exec, s[74:75]
    s_nop 1
    ds_write_b128 v125, v[48:51] offset:12288
    s_mov_b64 exec, s[74:75]
    ds_write_b128 v125, v[52:55] offset:12288
    s_mov_b64 exec, -1
    s_waitcnt lgkmcnt(4)
    v_smfmac_f32_16x16x64_bf16 v[60:63], v[24:27], v[32:39], v112
    v_smfmac_f32_16x16x64_bf16 v[56:59], v[28:31], a[168:175], v112
    s_waitcnt lgkmcnt(2)
    v_smfmac_f32_16x16x64_bf16 v[60:63], v[28:31], v[40:47], v112
    s_waitcnt lgkmcnt(0)
    s_barrier
    v_smfmac_f32_16x16x64_bf16 v[64:67], v[8:11], a[208:215], v112
    ds_read_b128 v[48:51], v114 offset:12288
    v_smfmac_f32_16x16x64_bf16 v[68:71], v[8:11], a[216:223], v112
    ds_read_b128 v[52:55], v114 offset:13312
    v_smfmac_f32_16x16x64_bf16 v[64:67], v[12:15], a[224:231], v112
    ds_read_b128 v[108:111], v114 offset:14336
    v_add_f32 v56, v56, v57
    v_add_f32 v60, v60, v61
    v_add_f32 v58, v58, v59
    v_add_f32 v62, v62, v63
    v_cvt_pk_bf16_f32 v128, v56, v60
    v_cvt_pk_bf16_f32 v129, v58, v62
    ds_write_b32 v119, v128 offset:10240
    ds_write_b32 v119, v129 offset:10256
    v_smfmac_f32_16x16x64_bf16 v[68:71], v[12:15], a[232:239], v112
    ds_read_b128 v[60:63], v114 offset:15360
    v_smfmac_f32_16x16x64_bf16 v[64:67], v[16:19], a[240:247], v112
    ds_read_b128 v[96:99], v120 offset:8192
    v_smfmac_f32_16x16x64_bf16 v[68:71], v[16:19], a[248:255], v112
    ds_read_b128 v[100:103], v120 offset:8704
    v_smfmac_f32_16x16x64_bf16 v[64:67], v[20:23], v[144:151], v112
    s_waitcnt lgkmcnt(6)
    v_add_f32 v48, v48, v52
    s_waitcnt lgkmcnt(3)
    s_barrier
    ds_read_b128 v[88:91], v122 offset:10240
    v_smfmac_f32_16x16x64_bf16 v[68:71], v[20:23], v[152:159], v112
    ds_read_b128 v[92:95], v122 offset:10752
    v_add_f32 v49, v49, v53
    v_smfmac_f32_16x16x64_bf16 v[64:67], v[24:27], v[160:167], v112
    v_add_f32 v50, v50, v54
    v_smfmac_f32_16x16x64_bf16 v[68:71], v[24:27], v[168:175], v112
    v_add_f32 v51, v51, v55
    v_smfmac_f32_16x16x64_bf16 v[64:67], v[28:31], v[176:183], v112
    s_waitcnt lgkmcnt(4)
    v_add_f32 v108, v108, v60
    v_smfmac_f32_16x16x64_bf16 v[68:71], v[28:31], v[184:191], v112
    v_add_f32 v109, v109, v61
    s_waitcnt lgkmcnt(1)
    v_mfma_f32_16x16x32_bf16 v[56:59], v[88:91], v[96:99], 0
    v_add_f32 v110, v110, v62
    s_waitcnt lgkmcnt(0)
    v_mfma_f32_16x16x32_bf16 v[56:59], v[92:95], v[100:103], v[56:59]
    v_add_f32 v111, v111, v63
    v_add_f32 v104, v48, v108
    ds_read_b128 v[32:35], v113 offset:20480
    v_add_f32 v105, v49, v109
    v_add_f32 v106, v50, v110
    v_add_f32 v107, v51, v111
    v_max3_f32 v108, v104, v105, v106
    ds_read_b128 v[36:39], v113 offset:21504
    v_add_f32_dpp v109, v58, v56 row_ror:8 row_mask:0xf bank_mask:0x3
    v_add_f32_dpp v109, v57, v59 row_ror:8 row_mask:0xf bank_mask:0xc
    v_max3_f32 v108, v108, v107, v109
    v_add_f32 v64, v64, v65
    ds_read_b128 v[40:43], v113 offset:22528
    v_add_f32 v66, v66, v67
    v_max_f32_dpp v108, v108, v108 row_ror:8 row_mask:0xf bank_mask:0xf
    v_mov_b32 v110, v108
    v_cvt_pk_bf16_f32 v130, v64, v66
    ds_read_b128 v[44:47], v113 offset:23552
    v_add_f32 v68, v68, v69
    v_permlane16_swap_b32 v108, v110
    v_max_f32 v108, v108, v110
    v_mov_b32 v110, v108
    v_add_f32 v70, v70, v71
    v_cvt_pk_bf16_f32 v131, v68, v70
    v_permlane32_swap_b32 v108, v110
    v_max_f32 v108, v108, v110
    v_mul_f32 v108, s76, v108
    v_fma_f32 v109, v109, s76, -v108
    v_fma_f32 v104, v104, s76, -v108
    v_fma_f32 v105, v105, s76, -v108
    v_fma_f32 v106, v106, s76, -v108
    v_fma_f32 v107, v107, s76, -v108
    v_exp_f32 v109, v109
    v_exp_f32 v104, v104
    v_exp_f32 v105, v105
    v_exp_f32 v106, v106
    v_exp_f32 v107, v107
    v_cvt_pk_bf16_f32 v60, v104, v105
    v_mov_b32_dpp v110, v109 row_ror:8 row_mask:0xf bank_mask:0xf
    v_cvt_pk_bf16_f32 v61, v106, v107
    v_mov_b32_dpp v62, v60 row_ror:8 row_mask:0xf bank_mask:0xf
    v_cvt_pk_bf16_f32 v132, v109, v110
    v_mov_b32_dpp v63, v61 row_ror:8 row_mask:0xf bank_mask:0xf
    v_cvt_pk_bf16_f32 v135, v109, v110
    s_nop 0
    v_mfma_f32_16x16x32_bf16 v[48:51], v[80:83], v[60:63], 0
    v_mfma_f32_16x16x32_bf16 v[52:55], v[84:87], v[60:63], 0
    v_add_f32 v111, v104, v105
    v_add_f32 v110, v106, v107
    v_add_f32 v111, v111, v109
    s_nop 1
    v_mfma_f32_16x16x16_bf16 v[48:51], v[130:131], v[132:133], v[48:51]
    v_add_f32 v111, v111, v110
    v_mfma_f32_16x16x16_bf16 v[52:55], v[130:131], v[134:135], v[52:55]
    v_mov_b32 v24, 0
    v_mov_b32 v25, 0
    v_add_f32_dpp v111, v111, v111 row_ror:8 row_mask:0xf bank_mask:0xf
    v_mov_b32 v110, v111
    v_mov_b32 v26, 0
    v_mov_b32 v27, 0
    v_permlane16_swap_b32 v111, v110
    v_add_f32 v111, v111, v110
    v_mov_b32 v110, v111
    v_mov_b32 v28, 0
    v_mov_b32 v29, 0
    v_permlane32_swap_b32 v111, v110
    v_add_f32 v111, v111, v110
    v_rcp_f32 v111, v111
    s_nop 0
    v_pk_mul_f32 v[48:49], v[48:49], v[110:111] op_sel:[0,1] op_sel_hi:[1,1]
    v_pk_mul_f32 v[52:53], v[52:53], v[110:111] op_sel:[0,1] op_sel_hi:[1,1]
    v_pk_mul_f32 v[50:51], v[50:51], v[110:111] op_sel:[0,1] op_sel_hi:[1,1]
    v_pk_mul_f32 v[54:55], v[54:55], v[110:111] op_sel:[0,1] op_sel_hi:[1,1]
    v_cvt_pk_bf16_f32 v104, v48, v52
    v_cvt_pk_bf16_f32 v105, v49, v53
    v_cvt_pk_bf16_f32 v106, v50, v54
    v_cvt_pk_bf16_f32 v107, v51, v55
    s_not_b64 exec, s[74:75]
    ds_write_b128 v123, v[104:107] offset:0
    s_mov_b64 exec, -1
    v_mov_b32 v30, 0
    v_mov_b32 v31, 0
    v_mov_b32 v64, 0
    v_mov_b32 v65, 0
    v_mov_b32 v66, 0
    v_mov_b32 v67, 0
    v_mov_b32 v68, 0
    v_mov_b32 v69, 0
    v_mov_b32 v70, 0
    v_mov_b32 v71, 0
    v_mov_b32 v56, 0
    v_mov_b32 v57, 0
    v_mov_b32 v58, 0
    v_mov_b32 v59, 0
    v_mov_b32 v60, 0
    v_mov_b32 v61, 0
    v_mov_b32 v62, 0
    v_mov_b32 v63, 0
    v_mov_b32 v48, 0
    v_mov_b32 v49, 0
    v_mov_b32 v50, 0
    v_mov_b32 v51, 0
    v_mov_b32 v52, 0
    v_mov_b32 v53, 0
    v_mov_b32 v54, 0
    v_mov_b32 v55, 0
    s_waitcnt lgkmcnt(0)
    s_barrier
    ds_read_b128 v[104:107], v114 offset:0
    ds_read_b128 v[108:111], v114 offset:1024
    s_waitcnt lgkmcnt(1)
    v_smfmac_f32_16x16x64_bf16 v[64:67], v[104:107], v[192:199], v112
    ds_read_b128 v[0:3], v113 offset:24576
    s_waitcnt lgkmcnt(1)
    v_smfmac_f32_16x16x64_bf16 v[64:67], v[108:111], v[32:39], v112
    ds_read_b128 v[4:7], v113 offset:25600
    v_smfmac_f32_16x16x64_bf16 v[68:71], v[104:107], v[200:207], v112
    ds_read_b128 v[8:11], v113 offset:26624
    v_smfmac_f32_16x16x64_bf16 v[68:71], v[108:111], v[40:47], v112
    ds_read_b128 v[12:15], v113 offset:27648
    v_smfmac_f32_16x16x64_bf16 v[24:27], v[104:107], v[208:215], v112
    ds_read_b128 v[16:19], v113 offset:28672
    s_nop 0
    v_add_f32 v64, v64, v65
    s_waitcnt lgkmcnt(3)
    v_smfmac_f32_16x16x64_bf16 v[24:27], v[108:111], v[0:7], v112
    ds_read_b128 v[20:23], v113 offset:29696
    v_add_f32 v66, v66, v67
    v_cvt_pk_bf16_f32 v40, v64, v66
    v_and_b32 v40, -2, v40
    v_smfmac_f32_16x16x64_bf16 v[28:31], v[104:107], v[216:223], v112
    ds_read_b128 v[88:91], v113 offset:30720
    v_add_f32 v68, v68, v69
    s_waitcnt lgkmcnt(3)
    v_smfmac_f32_16x16x64_bf16 v[28:31], v[108:111], v[8:15], v112
    ds_read_b128 v[92:95], v113 offset:31744
    v_add_f32 v70, v70, v71
    v_cvt_pk_bf16_f32 v41, v68, v70
    v_and_b32 v41, -2, v41
    v_smfmac_f32_16x16x64_bf16 v[56:59], v[104:107], v[224:231], v112
    ds_read_b128 v[96:99], v113 offset:32768
    v_add_f32 v24, v24, v25
    s_waitcnt lgkmcnt(3)
    v_smfmac_f32_16x16x64_bf16 v[56:59], v[108:111], v[16:23], v112
    ds_read_b128 v[100:103], v113 offset:33792
    v_add_f32 v26, v26, v27
    v_cvt_pk_bf16_f32 v42, v24, v26
    v_and_b32 v42, -2, v42
    v_smfmac_f32_16x16x64_bf16 v[60:63], v[104:107], v[232:239], v112
    ds_read_b128 v[32:35], v113 offset:34816
    v_add_f32 v28, v28, v29
    s_waitcnt lgkmcnt(3)
    v_smfmac_f32_16x16x64_bf16 v[60:63], v[108:111], v[88:95], v112
    ds_read_b128 v[36:39], v113 offset:35840
    v_add_f32 v30, v30, v31
    v_cvt_pk_bf16_f32 v43, v28, v30
    v_and_b32 v43, -2, v43
    buffer_store_dwordx4 v[40:43], v127, s[40:43], s68 offen sc1
    v_smfmac_f32_16x16x64_bf16 v[48:51], v[104:107], v[240:247], v112
    v_add_f32 v56, v56, v57
    s_waitcnt lgkmcnt(2)
    v_smfmac_f32_16x16x64_bf16 v[48:51], v[108:111], v[96:103], v112
    v_add_f32 v58, v58, v59
    v_cvt_pk_bf16_f32 v44, v56, v58
    v_and_b32 v44, -2, v44
    v_smfmac_f32_16x16x64_bf16 v[52:55], v[104:107], v[248:255], v112
    v_add_f32 v60, v60, v61
    s_waitcnt lgkmcnt(0)
    v_smfmac_f32_16x16x64_bf16 v[52:55], v[108:111], v[32:39], v112
    v_add_f32 v62, v62, v63
    v_cvt_pk_bf16_f32 v45, v60, v62
    v_and_b32 v45, -2, v45
    v_add_f32 v48, v48, v49
    v_add_f32 v50, v50, v51
    v_cvt_pk_bf16_f32 v46, v48, v50
    v_and_b32 v46, -2, v46
    s_nop 0
    v_add_f32 v52, v52, v53
    v_add_f32 v54, v54, v55
    v_cvt_pk_bf16_f32 v47, v52, v54
    v_and_b32 v47, -2, v47
    buffer_store_dwordx4 v[44:47], v127, s[40:43], s69 offen sc1
    v_mov_b32 v48, 0
    v_mov_b32 v49, 0
    v_mov_b32 v50, 0
    v_mov_b32 v51, 0
    ds_read_b128 v[32:35], v113 offset:0
    v_mov_b32 v52, 0
    v_mov_b32 v53, 0
    v_mov_b32 v54, 0
    v_mov_b32 v55, 0
    ds_read_b128 v[36:39], v113 offset:1024
    v_mov_b32 v56, 0
    v_mov_b32 v57, 0
    v_mov_b32 v58, 0
    v_mov_b32 v59, 0
    ds_read_b128 v[40:43], v113 offset:2048
    v_mov_b32 v60, 0
    v_mov_b32 v61, 0
    v_mov_b32 v62, 0
    v_mov_b32 v63, 0
    ds_read_b128 v[44:47], v113 offset:3072
    v_mov_b32 v64, 0
    v_mov_b32 v65, 0
    v_mov_b32 v66, 0
    v_mov_b32 v67, 0
    v_mov_b32 v68, 0
    v_mov_b32 v69, 0
    v_mov_b32 v70, 0
    v_mov_b32 v71, 0
    s_sleep 2
    buffer_load_dwordx4 v[88:91], v124, s[40:43], s67 offen sc1
    buffer_load_dwordx4 v[92:95], v124, s[40:43], s67 offen offset:1024 sc1
    s_sleep 2
    buffer_load_dwordx4 v[88:91], v124, s[40:43], s67 offen sc1
    buffer_load_dwordx4 v[92:95], v124, s[40:43], s67 offen offset:1024 sc1
    s_waitcnt vmcnt(2) lgkmcnt(0)
    s_branch L_s0_poll1c
L_s0_poll1:
    s_waitcnt vmcnt(0)
    v_or3_b32 v96, v88, v89, v90
    v_or3_b32 v97, v91, v92, v93
    v_or3_b32 v96, v96, v94, v95
    v_bitop3_b32 v96, v96, v97, 1 bitop3:0xa8
    v_cmp_ne_u32 vcc, 0, v96
    s_nop 0
    s_cbranch_vccz L_s0_poll1g
    s_add_u32 s60, s60, 1
    s_cmp_gt_u32 s60, 0x40000
    s_cbranch_scc1 L_exit
    s_mov_b64 exec, vcc
    buffer_load_dwordx4 v[88:91], v124, s[40:43], s67 offen sc1
    buffer_load_dwordx4 v[92:95], v124, s[40:43], s67 offen offset:1024 sc1
    s_mov_b64 exec, -1
    s_branch L_s0_poll1
L_s0_poll1c:
    v_or3_b32 v96, v88, v89, v90
    v_or3_b32 v97, v91, v92, v93
    v_or3_b32 v96, v96, v94, v95
    v_bitop3_b32 v96, v96, v97, 1 bitop3:0xa8
    v_cmp_ne_u32 vcc, 0, v96
    s_nop 0
    s_cbranch_vccnz L_s0_poll1
L_s0_poll1g:
    v_mfma_f32_16x16x32_bf16 v[104:107], v[136:139], v[88:91], 0
    v_mfma_f32_16x16x32_bf16 v[104:107], v[136:139], v[92:95], v[104:107]
    s_nop 7
    v_add_f32_dpp v104, v104, v104 row_ror:8 row_mask:0xf bank_mask:0xf
    v_add_f32_dpp v105, v105, v105 row_ror:8 row_mask:0xf bank_mask:0xf
    v_add_f32_dpp v106, v106, v106 row_ror:8 row_mask:0xf bank_mask:0xf
    v_add_f32_dpp v107, v107, v107 row_ror:8 row_mask:0xf bank_mask:0xf
    v_add_f32_dpp v108, v104, v104 row_ror:4 row_mask:0xf bank_mask:0x5
    v_add_f32_dpp v109, v106, v106 row_ror:4 row_mask:0xf bank_mask:0x5
    v_add_f32_dpp v108, v105, v105 row_ror:4 row_mask:0xf bank_mask:0xa
    v_add_f32_dpp v109, v107, v107 row_ror:4 row_mask:0xf bank_mask:0xa
    s_mov_b64 exec, s[72:73]
    v_cvt_pk_bf16_f32 v104, v108, v109
    v_and_b32 v104, -2, v104
    buffer_store_dword v104, v140, s[40:43], s65 offen sc1
    s_mov_b64 exec, -1
    s_add_u32 s53, s70, 0x1000000
    s_sub_u32 s54, s70, 0x0
    buffer_load_dwordx4 v[72:75], v124, s[40:43], s54 offen
    buffer_load_dwordx4 v[76:79], v124, s[40:43], s54 offen offset:1024
    buffer_load_dwordx4 v[80:83], v124, s[40:43], s53 offen
    buffer_load_dwordx4 v[84:87], v124, s[40:43], s53 offen offset:1024
    s_add_u32 s52, s52, 1
    s_add_u32 s70, s70, 0x40000
    s_add_u32 s71, s71, 0x20000
    s_sleep 4
    buffer_load_dwordx4 v[0:3], v124, s[40:43], s64 offen sc1
    buffer_load_dwordx4 v[4:7], v124, s[40:43], s64 offen offset:1024 sc1
    s_sleep 2
    buffer_load_dwordx4 v[0:3], v124, s[40:43], s64 offen sc1
    buffer_load_dwordx4 v[4:7], v124, s[40:43], s64 offen offset:1024 sc1
    s_branch L_s1_top
L_s1_rt:
    s_waitcnt vmcnt(0)
    v_or3_b32 v104, v0, v1, v2
    v_or3_b32 v105, v3, v4, v5
    v_or3_b32 v104, v104, v6, v7
    v_bitop3_b32 v104, v104, v105, 1 bitop3:0xa8
    v_cmp_ne_u32 vcc, 0, v104
    s_nop 0
    s_cbranch_vccz L_s1_go
    s_add_u32 s60, s60, 1
    s_cmp_gt_u32 s60, 0x40000
    s_cbranch_scc1 L_exit
    s_mov_b64 exec, vcc
    buffer_load_dwordx4 v[0:3], v124, s[40:43], s64 offen sc1
    buffer_load_dwordx4 v[4:7], v124, s[40:43], s64 offen offset:1024 sc1
    s_mov_b64 exec, -1
    s_branch L_s1_rt
L_s1_top:
    s_waitcnt vmcnt(2)
    v_or3_b32 v104, v0, v1, v2
    v_or3_b32 v105, v3, v4, v5
    v_or3_b32 v104, v104, v6, v7
    v_bitop3_b32 v104, v104, v105, 1 bitop3:0xa8
    v_cmp_ne_u32 vcc, 0, v104
    s_nop 0
    s_cbranch_vccnz L_s1_rt
L_s1_go:
    v_smfmac_f32_16x16x64_bf16 v[48:51], v[0:3], a[0:7], v112
    ds_write_b128 v115, v[0:3] offset:0
    v_smfmac_f32_16x16x64_bf16 v[52:55], v[0:3], v[32:39], v112
    ds_write_b128 v115, v[4:7] offset:1024
    v_smfmac_f32_16x16x64_bf16 v[48:51], v[4:7], a[8:15], v112
    ds_read_b128 v[32:35], v113 offset:4096
    v_smfmac_f32_16x16x64_bf16 v[52:55], v[4:7], v[40:47], v112
    ds_read_b128 v[36:39], v113 offset:5120
    v_smfmac_f32_16x16x64_bf16 v[56:59], v[0:3], a[80:87], v112
    ds_read_b128 v[40:43], v113 offset:6144
    v_smfmac_f32_16x16x64_bf16 v[60:63], v[0:3], a[88:95], v112
    ds_read_b128 v[44:47], v113 offset:7168
    v_smfmac_f32_16x16x64_bf16 v[56:59], v[4:7], a[96:103], v112
    s_waitcnt lgkmcnt(4)
    s_barrier
    ds_read_b128 v[8:11], v116 offset:0
    v_smfmac_f32_16x16x64_bf16 v[60:63], v[4:7], a[104:111], v112
    ds_read_b128 v[12:15], v116 offset:1024
    s_sub_u32 s53, s52, 1
    v_mov_b32 v111, s53
    s_mov_b64 exec, 1
    buffer_store_dword v111, v143, s[40:43], s66 offen sc1
    s_mov_b64 exec, -1
    v_smfmac_f32_16x16x64_bf16 v[64:67], v[0:3], a[176:183], v112
    ds_read_b128 v[16:19], v117 offset:0
    v_mbcnt_lo_u32_b32 v110, -1, 0
    v_smfmac_f32_16x16x64_bf16 v[68:71], v[0:3], a[184:191], v112
    ds_read_b128 v[20:23], v117 offset:1024
    v_min_u32 v110, 6, v110
    buffer_store_dwordx4 v[128:131], v125, s[40:43], s71 offen sc1
    v_smfmac_f32_16x16x64_bf16 v[64:67], v[4:7], a[192:199], v112
    ds_read_b128 v[24:27], v118 offset:0
    v_lshlrev_b32 v110, 6, v110
    v_smfmac_f32_16x16x64_bf16 v[68:71], v[4:7], a[200:207], v112
    ds_read_b128 v[28:31], v118 offset:1024
    s_waitcnt lgkmcnt(5)
    v_smfmac_f32_16x16x64_bf16 v[48:51], v[8:11], v[32:39], v112
    v_smfmac_f32_16x16x64_bf16 v[52:55], v[8:11], a[16:23], v112
    ds_read_b128 v[32:35], v113 offset:8192
    buffer_load_dword v126, v110, s[40:43], s81 offen sc1
    s_waitcnt lgkmcnt(5)
    v_smfmac_f32_16x16x64_bf16 v[48:51], v[12:15], v[40:47], v112
    ds_read_b128 v[36:39], v113 offset:9216
    v_smfmac_f32_16x16x64_bf16 v[52:55], v[12:15], a[24:31], v112
    ds_read_b128 v[40:43], v113 offset:10240
    s_waitcnt lgkmcnt(6)
    v_smfmac_f32_16x16x64_bf16 v[48:51], v[16:19], a[32:39], v112
    ds_read_b128 v[44:47], v113 offset:11264
    v_smfmac_f32_16x16x64_bf16 v[52:55], v[16:19], a[40:47], v112
    s_waitcnt lgkmcnt(6)
    v_smfmac_f32_16x16x64_bf16 v[48:51], v[20:23], a[48:55], v112
    s_waitcnt lgkmcnt(2)
    v_smfmac_f32_16x16x64_bf16 v[52:55], v[20:23], v[32:39], v112
    v_smfmac_f32_16x16x64_bf16 v[48:51], v[24:27], a[56:63], v112
    ds_read_b128 v[32:35], v113 offset:12288
    s_waitcnt lgkmcnt(1)
    v_smfmac_f32_16x16x64_bf16 v[52:55], v[24:27], v[40:47], v112
    ds_read_b128 v[36:39], v113 offset:13312
    v_smfmac_f32_16x16x64_bf16 v[48:51], v[28:31], a[64:71], v112
    ds_read_b128 v[40:43], v113 offset:14336
    v_smfmac_f32_16x16x64_bf16 v[52:55], v[28:31], a[72:79], v112
    ds_read_b128 v[44:47], v113 offset:15360
    v_smfmac_f32_16x16x64_bf16 v[56:59], v[8:11], a[112:119], v112
    v_smfmac_f32_16x16x64_bf16 v[60:63], v[8:11], a[120:127], v112
    s_nop 2
    v_add_f32 v48, v48, v49
    s_nop 0
    v_add_f32 v52, v52, v53
    v_add_f32 v50, v50, v51
    v_add_f32 v54, v54, v55
    v_cvt_pk_bf16_f32 v104, v48, v52
    v_cvt_pk_bf16_f32 v105, v50, v54
    ds_write_b32 v119, v104 offset:8192
    ds_write_b32 v119, v105 offset:8208
    ds_read_b128 v[108:111], v121 offset:8192
    s_waitcnt lgkmcnt(5)
    v_smfmac_f32_16x16x64_bf16 v[56:59], v[12:15], v[32:39], v112
    v_smfmac_f32_16x16x64_bf16 v[60:63], v[12:15], a[128:135], v112
    ds_read_b128 v[32:35], v113 offset:16384
    s_waitcnt lgkmcnt(4)
    v_smfmac_f32_16x16x64_bf16 v[56:59], v[16:19], v[40:47], v112
    ds_read_b128 v[36:39], v113 offset:17408
    v_smfmac_f32_16x16x64_bf16 v[60:63], v[16:19], a[136:143], v112
    ds_read_b128 v[40:43], v113 offset:18432
    s_waitcnt lgkmcnt(3)
    v_mfma_f32_16x16x32_bf16 v[48:51], v[72:75], v[108:111], 0
    ds_read_b128 v[44:47], v113 offset:19456
    v_mfma_f32_16x16x32_bf16 v[52:55], v[76:79], v[108:111], 0
    v_smfmac_f32_16x16x64_bf16 v[56:59], v[20:23], a[144:151], v112
    v_smfmac_f32_16x16x64_bf16 v[60:63], v[20:23], a[152:159], v112
    v_smfmac_f32_16x16x64_bf16 v[56:59], v[24:27], a[160:167], v112
    s_not_b64 exec, s[74:75]
    s_nop 1
    ds_write_b128 v125, v[48:51] offset:12288
    s_mov_b64 exec, s[74:75]
    ds_write_b128 v125, v[52:55] offset:12288
    s_mov_b64 exec, -1
    s_waitcnt lgkmcnt(4)
    v_smfmac_f32_16x16x64_bf16 v[60:63], v[24:27], v[32:39], v112
    v_smfmac_f32_16x16x64_bf16 v[56:59], v[28:31], a[168:175], v112
    s_waitcnt lgkmcnt(2)
    v_smfmac_f32_16x16x64_bf16 v[60:63], v[28:31], v[40:47], v112
    s_waitcnt lgkmcnt(0)
    s_barrier
    v_smfmac_f32_16x16x64_bf16 v[64:67], v[8:11], a[208:215], v112
    ds_read_b128 v[48:51], v114 offset:12288
    v_smfmac_f32_16x16x64_bf16 v[68:71], v[8:11], a[216:223], v112
    ds_read_b128 v[52:55], v114 offset:13312
    v_smfmac_f32_16x16x64_bf16 v[64:67], v[12:15], a[224:231], v112
    ds_read_b128 v[108:111], v114 offset:14336
    v_add_f32 v56, v56, v57
    v_add_f32 v60, v60, v61
    v_add_f32 v58, v58, v59
    v_add_f32 v62, v62, v63
    v_cvt_pk_bf16_f32 v128, v56, v60
    v_cvt_pk_bf16_f32 v129, v58, v62
    ds_write_b32 v119, v128 offset:10240
    ds_write_b32 v119, v129 offset:10256
    v_smfmac_f32_16x16x64_bf16 v[68:71], v[12:15], a[232:239], v112
    ds_read_b128 v[60:63], v114 offset:15360
    v_smfmac_f32_16x16x64_bf16 v[64:67], v[16:19], a[240:247], v112
    ds_read_b128 v[96:99], v120 offset:8192
    v_smfmac_f32_16x16x64_bf16 v[68:71], v[16:19], a[248:255], v112
    ds_read_b128 v[100:103], v120 offset:8704
    v_smfmac_f32_16x16x64_bf16 v[64:67], v[20:23], v[144:151], v112
    s_waitcnt lgkmcnt(6)
    v_add_f32 v48, v48, v52
    s_waitcnt lgkmcnt(3)
    s_barrier
    ds_read_b128 v[88:91], v122 offset:10240
    v_smfmac_f32_16x16x64_bf16 v[68:71], v[20:23], v[152:159], v112
    ds_read_b128 v[92:95], v122 offset:10752
    v_add_f32 v49, v49, v53
    v_smfmac_f32_16x16x64_bf16 v[64:67], v[24:27], v[160:167], v112
    v_add_f32 v50, v50, v54
    v_smfmac_f32_16x16x64_bf16 v[68:71], v[24:27], v[168:175], v112
    v_add_f32 v51, v51, v55
    v_smfmac_f32_16x16x64_bf16 v[64:67], v[28:31], v[176:183], v112
    s_waitcnt lgkmcnt(4)
    v_add_f32 v108, v108, v60
    v_smfmac_f32_16x16x64_bf16 v[68:71], v[28:31], v[184:191], v112
    v_add_f32 v109, v109, v61
    s_waitcnt lgkmcnt(1)
    v_mfma_f32_16x16x32_bf16 v[56:59], v[88:91], v[96:99], 0
    v_add_f32 v110, v110, v62
    s_waitcnt lgkmcnt(0)
    v_mfma_f32_16x16x32_bf16 v[56:59], v[92:95], v[100:103], v[56:59]
    v_add_f32 v111, v111, v63
    s_cmp_eq_u32 s52, 63
    s_cbranch_scc1 L_s_last
    v_add_f32 v104, v48, v108
    ds_read_b128 v[32:35], v113 offset:20480
    v_add_f32 v105, v49, v109
    v_add_f32 v106, v50, v110
    v_add_f32 v107, v51, v111
    v_max3_f32 v108, v104, v105, v106
    ds_read_b128 v[36:39], v113 offset:21504
    v_add_f32_dpp v109, v58, v56 row_ror:8 row_mask:0xf bank_mask:0x3
    v_add_f32_dpp v109, v57, v59 row_ror:8 row_mask:0xf bank_mask:0xc
    v_max3_f32 v108, v108, v107, v109
    v_add_f32 v64, v64, v65
    ds_read_b128 v[40:43], v113 offset:22528
    v_add_f32 v66, v66, v67
    v_max_f32_dpp v108, v108, v108 row_ror:8 row_mask:0xf bank_mask:0xf
    v_mov_b32 v110, v108
    v_cvt_pk_bf16_f32 v130, v64, v66
    ds_read_b128 v[44:47], v113 offset:23552
    v_add_f32 v68, v68, v69
    v_permlane16_swap_b32 v108, v110
    v_max_f32 v108, v108, v110
    v_mov_b32 v110, v108
    v_add_f32 v70, v70, v71
    v_cvt_pk_bf16_f32 v131, v68, v70
    v_permlane32_swap_b32 v108, v110
    v_max_f32 v108, v108, v110
    v_mul_f32 v108, s76, v108
    v_fma_f32 v109, v109, s76, -v108
    v_fma_f32 v104, v104, s76, -v108
    v_fma_f32 v105, v105, s76, -v108
    v_fma_f32 v106, v106, s76, -v108
    v_fma_f32 v107, v107, s76, -v108
    v_exp_f32 v109, v109
    v_exp_f32 v104, v104
    v_exp_f32 v105, v105
    v_exp_f32 v106, v106
    v_exp_f32 v107, v107
    v_cvt_pk_bf16_f32 v60, v104, v105
    v_mov_b32_dpp v110, v109 row_ror:8 row_mask:0xf bank_mask:0xf
    v_cvt_pk_bf16_f32 v61, v106, v107
    v_mov_b32_dpp v62, v60 row_ror:8 row_mask:0xf bank_mask:0xf
    v_cvt_pk_bf16_f32 v132, v109, v110
    v_mov_b32_dpp v63, v61 row_ror:8 row_mask:0xf bank_mask:0xf
    v_cvt_pk_bf16_f32 v135, v109, v110
    s_nop 0
    v_mfma_f32_16x16x32_bf16 v[48:51], v[80:83], v[60:63], 0
    v_mfma_f32_16x16x32_bf16 v[52:55], v[84:87], v[60:63], 0
    v_add_f32 v111, v104, v105
    v_add_f32 v110, v106, v107
    v_add_f32 v111, v111, v109
    s_nop 1
    v_mfma_f32_16x16x16_bf16 v[48:51], v[130:131], v[132:133], v[48:51]
    v_add_f32 v111, v111, v110
    v_mfma_f32_16x16x16_bf16 v[52:55], v[130:131], v[134:135], v[52:55]
    v_mov_b32 v24, 0
    v_mov_b32 v25, 0
    v_add_f32_dpp v111, v111, v111 row_ror:8 row_mask:0xf bank_mask:0xf
    v_mov_b32 v110, v111
    v_mov_b32 v26, 0
    v_mov_b32 v27, 0
    v_permlane16_swap_b32 v111, v110
    v_add_f32 v111, v111, v110
    v_mov_b32 v110, v111
    v_mov_b32 v28, 0
    v_mov_b32 v29, 0
    v_permlane32_swap_b32 v111, v110
    v_add_f32 v111, v111, v110
    v_rcp_f32 v111, v111
    s_nop 0
    v_pk_mul_f32 v[48:49], v[48:49], v[110:111] op_sel:[0,1] op_sel_hi:[1,1]
    v_pk_mul_f32 v[52:53], v[52:53], v[110:111] op_sel:[0,1] op_sel_hi:[1,1]
    v_pk_mul_f32 v[50:51], v[50:51], v[110:111] op_sel:[0,1] op_sel_hi:[1,1]
    v_pk_mul_f32 v[54:55], v[54:55], v[110:111] op_sel:[0,1] op_sel_hi:[1,1]
    v_cvt_pk_bf16_f32 v104, v48, v52
    v_cvt_pk_bf16_f32 v105, v49, v53
    v_cvt_pk_bf16_f32 v106, v50, v54
    v_cvt_pk_bf16_f32 v107, v51, v55
    s_not_b64 exec, s[74:75]
    ds_write_b128 v123, v[104:107] offset:0
    s_mov_b64 exec, -1
    v_mov_b32 v30, 0
    v_mov_b32 v31, 0
    v_mov_b32 v64, 0
    v_mov_b32 v65, 0
    v_mov_b32 v66, 0
    v_mov_b32 v67, 0
    v_mov_b32 v68, 0
    v_mov_b32 v69, 0
    v_mov_b32 v70, 0
    v_mov_b32 v71, 0
    v_mov_b32 v56, 0
    v_mov_b32 v57, 0
    v_mov_b32 v58, 0
    v_mov_b32 v59, 0
    v_mov_b32 v60, 0
    v_mov_b32 v61, 0
    v_mov_b32 v62, 0
    v_mov_b32 v63, 0
    v_mov_b32 v48, 0
    v_mov_b32 v49, 0
    v_mov_b32 v50, 0
    v_mov_b32 v51, 0
    v_mov_b32 v52, 0
    v_mov_b32 v53, 0
    v_mov_b32 v54, 0
    v_mov_b32 v55, 0
    s_waitcnt lgkmcnt(0)
    s_barrier
    ds_read_b128 v[104:107], v114 offset:0
    ds_read_b128 v[108:111], v114 offset:1024
    s_waitcnt lgkmcnt(1)
    v_smfmac_f32_16x16x64_bf16 v[64:67], v[104:107], v[192:199], v112
    ds_read_b128 v[0:3], v113 offset:24576
    s_waitcnt lgkmcnt(1)
    v_smfmac_f32_16x16x64_bf16 v[64:67], v[108:111], v[32:39], v112
    ds_read_b128 v[4:7], v113 offset:25600
    v_smfmac_f32_16x16x64_bf16 v[68:71], v[104:107], v[200:207], v112
    ds_read_b128 v[8:11], v113 offset:26624
    v_smfmac_f32_16x16x64_bf16 v[68:71], v[108:111], v[40:47], v112
    ds_read_b128 v[12:15], v113 offset:27648
    v_smfmac_f32_16x16x64_bf16 v[24:27], v[104:107], v[208:215], v112
    ds_read_b128 v[16:19], v113 offset:28672
    s_nop 0
    v_add_f32 v64, v64, v65
    s_waitcnt lgkmcnt(3)
    v_smfmac_f32_16x16x64_bf16 v[24:27], v[108:111], v[0:7], v112
    ds_read_b128 v[20:23], v113 offset:29696
    v_add_f32 v66, v66, v67
    v_cvt_pk_bf16_f32 v40, v64, v66
    v_or_b32 v40, 1, v40
    v_smfmac_f32_16x16x64_bf16 v[28:31], v[104:107], v[216:223], v112
    ds_read_b128 v[88:91], v113 offset:30720
    v_add_f32 v68, v68, v69
    s_waitcnt lgkmcnt(3)
    v_smfmac_f32_16x16x64_bf16 v[28:31], v[108:111], v[8:15], v112
    ds_read_b128 v[92:95], v113 offset:31744
    v_add_f32 v70, v70, v71
    v_cvt_pk_bf16_f32 v41, v68, v70
    v_or_b32 v41, 1, v41
    v_smfmac_f32_16x16x64_bf16 v[56:59], v[104:107], v[224:231], v112
    ds_read_b128 v[96:99], v113 offset:32768
    v_add_f32 v24, v24, v25
    s_waitcnt lgkmcnt(3)
    v_smfmac_f32_16x16x64_bf16 v[56:59], v[108:111], v[16:23], v112
    ds_read_b128 v[100:103], v113 offset:33792
    v_add_f32 v26, v26, v27
    v_cvt_pk_bf16_f32 v42, v24, v26
    v_or_b32 v42, 1, v42
    v_smfmac_f32_16x16x64_bf16 v[60:63], v[104:107], v[232:239], v112
    ds_read_b128 v[32:35], v113 offset:34816
    v_add_f32 v28, v28, v29
    s_waitcnt lgkmcnt(3)
    v_smfmac_f32_16x16x64_bf16 v[60:63], v[108:111], v[88:95], v112
    ds_read_b128 v[36:39], v113 offset:35840
    v_add_f32 v30, v30, v31
    v_cvt_pk_bf16_f32 v43, v28, v30
    v_or_b32 v43, 1, v43
    buffer_store_dwordx4 v[40:43], v127, s[40:43], s68 offen sc1
    v_smfmac_f32_16x16x64_bf16 v[48:51], v[104:107], v[240:247], v112
    v_add_f32 v56, v56, v57
    s_waitcnt lgkmcnt(2)
    v_smfmac_f32_16x16x64_bf16 v[48:51], v[108:111], v[96:103], v112
    v_add_f32 v58, v58, v59
    v_cvt_pk_bf16_f32 v44, v56, v58
    v_or_b32 v44, 1, v44
    v_smfmac_f32_16x16x64_bf16 v[52:55], v[104:107], v[248:255], v112
    v_add_f32 v60, v60, v61
    s_waitcnt lgkmcnt(0)
    v_smfmac_f32_16x16x64_bf16 v[52:55], v[108:111], v[32:39], v112
    v_add_f32 v62, v62, v63
    v_cvt_pk_bf16_f32 v45, v60, v62
    v_or_b32 v45, 1, v45
    v_add_f32 v48, v48, v49
    v_add_f32 v50, v50, v51
    v_cvt_pk_bf16_f32 v46, v48, v50
    v_or_b32 v46, 1, v46
    s_nop 0
    v_add_f32 v52, v52, v53
    v_add_f32 v54, v54, v55
    v_cvt_pk_bf16_f32 v47, v52, v54
    v_or_b32 v47, 1, v47
    buffer_store_dwordx4 v[44:47], v127, s[40:43], s69 offen sc1
    v_mov_b32 v48, 0
    v_mov_b32 v49, 0
    v_mov_b32 v50, 0
    v_mov_b32 v51, 0
    ds_read_b128 v[32:35], v113 offset:0
    v_mov_b32 v52, 0
    v_mov_b32 v53, 0
    v_mov_b32 v54, 0
    v_mov_b32 v55, 0
    ds_read_b128 v[36:39], v113 offset:1024
    v_mov_b32 v56, 0
    v_mov_b32 v57, 0
    v_mov_b32 v58, 0
    v_mov_b32 v59, 0
    ds_read_b128 v[40:43], v113 offset:2048
    v_mov_b32 v60, 0
    v_mov_b32 v61, 0
    v_mov_b32 v62, 0
    v_mov_b32 v63, 0
    ds_read_b128 v[44:47], v113 offset:3072
    v_mov_b32 v64, 0
    v_mov_b32 v65, 0
    v_mov_b32 v66, 0
    v_mov_b32 v67, 0
    v_mov_b32 v68, 0
    v_mov_b32 v69, 0
    v_mov_b32 v70, 0
    v_mov_b32 v71, 0
    s_sleep 2
    buffer_load_dwordx4 v[88:91], v124, s[40:43], s67 offen sc1
    buffer_load_dwordx4 v[92:95], v124, s[40:43], s67 offen offset:1024 sc1
    s_sleep 2
    buffer_load_dwordx4 v[88:91], v124, s[40:43], s67 offen sc1
    buffer_load_dwordx4 v[92:95], v124, s[40:43], s67 offen offset:1024 sc1
    s_waitcnt vmcnt(2) lgkmcnt(0)
    s_branch L_s1_poll1c
L_s1_poll1:
    s_waitcnt vmcnt(0)
    v_bitop3_b32 v96, v88, v89, v90 bitop3:0x80
    v_bitop3_b32 v97, v91, v92, v93 bitop3:0x80
    v_bitop3_b32 v96, v96, v94, v95 bitop3:0x80
    v_bitop3_b32 v96, v96, v97, 1 bitop3:0x80
    v_cmp_eq_u32 vcc, 0, v96
    s_nop 0
    s_cbranch_vccz L_s1_poll1g
    s_add_u32 s60, s60, 1
    s_cmp_gt_u32 s60, 0x40000
    s_cbranch_scc1 L_exit
    s_mov_b64 exec, vcc
    buffer_load_dwordx4 v[88:91], v124, s[40:43], s67 offen sc1
    buffer_load_dwordx4 v[92:95], v124, s[40:43], s67 offen offset:1024 sc1
    s_mov_b64 exec, -1
    s_branch L_s1_poll1
L_s1_poll1c:
    v_bitop3_b32 v96, v88, v89, v90 bitop3:0x80
    v_bitop3_b32 v97, v91, v92, v93 bitop3:0x80
    v_bitop3_b32 v96, v96, v94, v95 bitop3:0x80
    v_bitop3_b32 v96, v96, v97, 1 bitop3:0x80
    v_cmp_eq_u32 vcc, 0, v96
    s_nop 0
    s_cbranch_vccnz L_s1_poll1
L_s1_poll1g:
    v_mfma_f32_16x16x32_bf16 v[104:107], v[136:139], v[88:91], 0
    v_mfma_f32_16x16x32_bf16 v[104:107], v[136:139], v[92:95], v[104:107]
    s_nop 7
    v_add_f32_dpp v104, v104, v104 row_ror:8 row_mask:0xf bank_mask:0xf
    v_add_f32_dpp v105, v105, v105 row_ror:8 row_mask:0xf bank_mask:0xf
    v_add_f32_dpp v106, v106, v106 row_ror:8 row_mask:0xf bank_mask:0xf
    v_add_f32_dpp v107, v107, v107 row_ror:8 row_mask:0xf bank_mask:0xf
    v_add_f32_dpp v108, v104, v104 row_ror:4 row_mask:0xf bank_mask:0x5
    v_add_f32_dpp v109, v106, v106 row_ror:4 row_mask:0xf bank_mask:0x5
    v_add_f32_dpp v108, v105, v105 row_ror:4 row_mask:0xf bank_mask:0xa
    v_add_f32_dpp v109, v107, v107 row_ror:4 row_mask:0xf bank_mask:0xa
    s_mov_b64 exec, s[72:73]
    v_cvt_pk_bf16_f32 v104, v108, v109
    v_or_b32 v104, 1, v104
    buffer_store_dword v104, v140, s[40:43], s65 offen sc1
    s_mov_b64 exec, -1
    s_add_u32 s53, s70, 0x1000000
    s_sub_u32 s54, s70, 0x0
    buffer_load_dwordx4 v[72:75], v124, s[40:43], s54 offen
    buffer_load_dwordx4 v[76:79], v124, s[40:43], s54 offen offset:1024
    buffer_load_dwordx4 v[80:83], v124, s[40:43], s53 offen
    buffer_load_dwordx4 v[84:87], v124, s[40:43], s53 offen offset:1024
    s_add_u32 s52, s52, 1
    s_add_u32 s70, s70, 0x40000
    s_add_u32 s71, s71, 0x20000
    s_cmp_ge_u32 s80, 64
    s_cbranch_scc1 L_s1_hz
    v_readlane_b32 s80, v126, 0
    s_mul_i32 s80, s80, 7
    v_readlane_b32 s54, v126, 1
    s_mul_i32 s54, s54, 7
    s_add_u32 s54, s54, 1
    s_min_u32 s80, s80, s54
    v_readlane_b32 s54, v126, 2
    s_mul_i32 s54, s54, 7
    s_add_u32 s54, s54, 2
    s_min_u32 s80, s80, s54
    v_readlane_b32 s54, v126, 3
    s_mul_i32 s54, s54, 7
    s_add_u32 s54, s54, 3
    s_min_u32 s80, s80, s54
    v_readlane_b32 s54, v126, 4
    s_mul_i32 s54, s54, 7
    s_add_u32 s54, s54, 4
    s_min_u32 s80, s80, s54
    v_readlane_b32 s54, v126, 5
    s_mul_i32 s54, s54, 7
    s_add_u32 s54, s54, 5
    s_min_u32 s80, s80, s54
    v_readlane_b32 s54, v126, 6
    s_mul_i32 s54, s54, 7
    s_add_u32 s54, s54, 6
    s_min_u32 s80, s80, s54
    s_cmp_ge_u32 s80, 64
    s_cselect_b32 s80, 0x100, s80
    s_add_u32 s53, s52, 3
    s_cmp_lt_u32 s53, s80
    s_cbranch_scc1 L_s1_hz
    v_mbcnt_lo_u32_b32 v96, -1, 0
    v_mbcnt_hi_u32_b32 v96, -1, v96
    v_min_u32 v96, 6, v96
    v_lshlrev_b32 v97, 6, v96
    s_nop 1
L_s1_hzl:
    buffer_load_dword v98, v97, s[40:43], s81 offen sc1
    s_waitcnt vmcnt(0)
    v_mul_u32_u24 v98, 7, v98
    v_add_u32 v98, v98, v96
    s_nop 0
    v_readlane_b32 s80, v98, 0
    v_readlane_b32 s54, v98, 1
    s_min_u32 s80, s80, s54
    v_readlane_b32 s54, v98, 2
    s_min_u32 s80, s80, s54
    v_readlane_b32 s54, v98, 3
    s_min_u32 s80, s80, s54
    v_readlane_b32 s54, v98, 4
    s_min_u32 s80, s80, s54
    v_readlane_b32 s54, v98, 5
    s_min_u32 s80, s80, s54
    v_readlane_b32 s54, v98, 6
    s_min_u32 s80, s80, s54
    s_cmp_ge_u32 s80, 64
    s_cselect_b32 s80, 0x100, s80
    s_add_u32 s53, s52, 3
    s_cmp_lt_u32 s53, s80
    s_cbranch_scc1 L_s1_hzd
    s_add_u32 s60, s60, 1
    s_cmp_gt_u32 s60, 0x40000
    s_cbranch_scc1 L_exit
    s_sleep 4
    s_branch L_s1_hzl
L_s1_hzd:
L_s1_hz:
    s_sleep 4
    buffer_load_dwordx4 v[0:3], v124, s[40:43], s64 offen sc1
    buffer_load_dwordx4 v[4:7], v124, s[40:43], s64 offen offset:1024 sc1
    s_sleep 2
    buffer_load_dwordx4 v[0:3], v124, s[40:43], s64 offen sc1
    buffer_load_dwordx4 v[4:7], v124, s[40:43], s64 offen offset:1024 sc1
    s_branch L_s0_top
L_s_last:
    s_nop 7
    v_add_f32 v64, v64, v65
    v_add_f32 v66, v66, v67
    v_cvt_pk_bf16_f32 v130, v64, v66
    v_add_f32 v68, v68, v69
    v_add_f32 v70, v70, v71
    v_cvt_pk_bf16_f32 v131, v68, v70
    s_waitcnt lgkmcnt(0)
    s_add_u32 s71, s71, 0x20000
    buffer_store_dwordx4 v[128:131], v125, s[40:43], s71 offen sc1
    s_waitcnt vmcnt(0) lgkmcnt(0)
    s_barrier
    v_mov_b32 v110, 64
    v_mov_b32 v111, 0
    s_mov_b64 exec, 1
    buffer_store_dword v110, v111, s[40:43], s66 offen sc1
    s_mov_b64 exec, -1
    s_waitcnt vmcnt(0)
L_chain_done:
    s_branch L_exit
L_exit:
    s_endpgm
.section .rodata,"a"
.p2align 6
.amdhsa_kernel adaLN_cond__memory_aug_recurrent_mem_tr__moe_arch_mod__prompt_kernel
  .amdhsa_next_free_vgpr 512
  .amdhsa_next_free_sgpr 102
  .amdhsa_accum_offset 256
  .amdhsa_group_segment_fixed_size 0
  .amdhsa_kernarg_size 136
  .amdhsa_user_sgpr_count 2
  .amdhsa_user_sgpr_kernarg_segment_ptr 1
  .amdhsa_system_sgpr_workgroup_id_x 1
.end_amdhsa_kernel
```
